```python
import torch

def _softmax(x, axis=-1):
    return torch.softmax(x, dim=axis)

def _gelu(x):
    return torch.nn.functional.gelu(x, approximate='tanh')

def _silu(x):
    return torch.nn.functional.silu(x)

def _sigmoid(x):
    return torch.sigmoid(x)

def _layernorm(x, axis=-1, eps=1e-05):
    m = x.mean(dim=axis, keepdim=True)
    v = x.var(dim=axis, keepdim=True, unbiased=False)
    return (x - m) / torch.sqrt(v + eps)

def _scatter_add(tgt, idx, src, axis=0):
    return tgt.clone().index_add_(axis, idx, src)

def _segment_sum(src, seg, n):
    out = torch.zeros((n,) + src.shape[1:], dtype=src.dtype)
    return out.index_add_(0, seg, src)

def _pad(x, pw):
    flat = tuple((v for pair in reversed(pw) for v in pair))
    return torch.nn.functional.pad(x, flat)
kernel_name = 'interleave_layers__sliding_local_dilated__mixer_gmlp__prompt'

def setup_inputs():

    _w = lambda a: (lambda t: t.to(torch.bfloat16) if t.is_floating_point() else t)(torch.as_tensor(a))

    def _A_setup():
        B, S, D = (1, 2048, 512)
        return {'x': _w((lambda *s: torch.randn(*s, dtype=torch.bfloat16) * 0.05)(B, S, D)), 'wqkv': _w((lambda *s: torch.randn(*s, dtype=torch.bfloat16) * 0.1)(D, 3 * D)), 'wo': _w((lambda *s: torch.randn(*s, dtype=torch.bfloat16) * 0.1)(D, D))}
    _A_in = _A_setup()

    def _B_setup():
        B, S, D, F = (1, 2048, 512, 1376)
        Fh = F // 2
        return {'x': _w((lambda *s: torch.randn(*s, dtype=torch.bfloat16) * 0.05)(B, S, D)), 'w_in': _w((lambda *s: torch.randn(*s, dtype=torch.bfloat16) * 0.4)(D, 2 * Fh)), 'w_sp': _w(0.01 * (lambda *s: torch.randn(*s, dtype=torch.bfloat16) * 0.4)(S, S)), 'b_sp': _w(1.0 + 0.01 * (lambda *s: torch.randn(*s, dtype=torch.bfloat16) * 0.05)(S)), 'w_out': _w((lambda *s: torch.randn(*s, dtype=torch.bfloat16) * 0.05)(Fh, D))}
    _B_in = _B_setup()
    return {'A_x': _A_in['x'], 'A_wqkv': _A_in['wqkv'], 'A_wo': _A_in['wo'], 'B_x': _B_in['x'], 'B_w_in': _B_in['w_in'], 'B_w_sp': _B_in['w_sp'], 'B_b_sp': _B_in['b_sp'], 'B_w_out': _B_in['w_out']}

def reference(A_x, A_wqkv, A_wo, B_x, B_w_in, B_w_sp, B_b_sp, B_w_out):

    def _A_ref(x, wqkv, wo):
        B, S, D = x.shape
        H = 32
        Dh = D // H
        W, dil = (8, 2)
        qkv = (lambda x, *d: x.permute(*d))((x @ wqkv).reshape(B, S, 3, H, Dh), 2, 0, 3, 1, 4)
        q, k, v = (qkv[0], qkv[1], qkv[2])
        scale = Dh ** (-0.5)
        pos = torch.arange(S)
        off = torch.arange(W) * dil
        idx = pos[:, None] - off[None, :]
        mask = idx >= 0
        idx_c = torch.where(mask, idx, 0).reshape(-1)
        kg = k[:, :, idx_c, :].reshape(B, H, S, W, Dh)
        vg = v[:, :, idx_c, :].reshape(B, H, S, W, Dh)
        logits = torch.einsum('bhsd,bhswd->bhsw', q, kg) * scale
        logits = torch.where(mask[None, None, :, :], logits, -1000000000.0)
        attn = _softmax(logits, axis=-1)
        o = torch.einsum('bhsw,bhswd->bhsd', attn, vg)
        return (lambda x, *d: x.permute(*d))(o, 0, 2, 1, 3).reshape(B, S, D) @ wo

    def _B_ref(x, w_in, w_sp, b_sp, w_out):
        B, S, D = x.shape
        F = w_in.shape[-1]
        Fh = F // 2
        z = _gelu(torch.einsum('bsd,df->bsf', x, w_in))
        z1 = z[..., :Fh].clone()
        z2 = _layernorm(z[..., Fh:], axis=-1)
        g = torch.einsum('ts,bsf->btf', w_sp, z2) + b_sp[None, :, None]
        return torch.einsum('bsf,fd->bsd', z1 * g, w_out)
    x = A_x
    x = x + _A_ref(_layernorm(x, axis=-1), A_wqkv, A_wo)
    x = x + _B_ref(_layernorm(x, axis=-1), B_w_in, B_w_sp, B_b_sp, B_w_out)
    x = x + _A_ref(_layernorm(x, axis=-1), A_wqkv, A_wo)
    x = x + _B_ref(_layernorm(x, axis=-1), B_w_in, B_w_sp, B_b_sp, B_w_out)
    return x
```

```asm
; @launch kernel=g1a0_kernel grid=(256,1,1) block=(512,1,1) lds=140288
; @launch kernel=g2r0_kernel grid=(256,1,1) block=(512,1,1) lds=99328
; @launch kernel=g3_kernel grid=(256,1,1) block=(512,1,1) lds=132096
; @launch kernel=ln2_kernel grid=(256,1,1) block=(256,1,1) lds=0
; @launch kernel=g4_kernel grid=(256,1,1) block=(512,1,1) lds=144384
; @launch kernel=g5r0_kernel grid=(256,1,1) block=(512,1,1) lds=99328
; @launch kernel=g1a1_kernel grid=(256,1,1) block=(512,1,1) lds=140288
; @launch kernel=g2r1_kernel grid=(256,1,1) block=(512,1,1) lds=99328
; @launch kernel=g3_kernel grid=(256,1,1) block=(512,1,1) lds=132096
; @launch kernel=ln2_kernel grid=(256,1,1) block=(256,1,1) lds=0
; @launch kernel=g4_kernel grid=(256,1,1) block=(512,1,1) lds=144384
; @launch kernel=g5r1_kernel grid=(256,1,1) block=(512,1,1) lds=99328
.amdgcn_target "amdgcn-amd-amdhsa--gfx950"
.text
.globl g1a0_kernel
.p2align 8
.type g1a0_kernel,@function
g1a0_kernel:
    s_cmp_ge_u32 s2, 256
    s_cbranch_scc1 L_end_g1a0_kernel
    s_load_dwordx16 s[16:31], s[0:1], 0
    s_load_dwordx4 s[32:35], s[0:1], 64
    s_load_dwordx2 s[36:37], s[0:1], 80
    v_and_b32 v1, 63, v0
    v_lshrrev_b32 v5, 6, v0
    v_bfe_u32 v2, v0, 6, 2
    v_and_b32 v3, 15, v0
    v_bfe_u32 v4, v0, 4, 2
    v_readfirstlane_b32 s39, v5
    s_and_b32 s3, s39, 3
    s_lshr_b32 s38, s39, 2
    s_and_b32 s4, s2, 3
    s_lshl_b32 s4, s4, 3
    s_bfe_u32 s12, s2, 0x30003
    s_add_u32 s4, s4, s12
    s_bfe_u32 s5, s2, 0x10002
    s_lshl_b32 s5, s5, 2
    s_lshr_b32 s12, s2, 6
    s_add_u32 s5, s5, s12
    s_lshl_b32 s6, s4, 6
    s_mov_b32 s9, 0x3f803f80
    s_lshl_b32 s10, s5, 7
    s_cmp_eq_u32 s38, 0
    s_cbranch_scc1 L_comp_g1a0_kernel
    s_lshl_b32 s14, s3, 11
    s_mul_i32 s15, s3, 6144
    s_add_u32 s15, s15, 10240
    s_and_b32 s13, s3, 1
    s_lshl_b32 s13, s13, 10
    s_add_u32 s13, s13, 8192
    v_lshrrev_b32 v5, 3, v1
    v_and_b32 v6, 7, v1
    v_xor_b32 v6, v6, v5
    v_lshl_add_u32 v7, v2, 4, v5
    v_add_u32 v7, s6, v7
    v_subrev_u32 v7, 16, v7
    s_mov_b32 s11, 1024
    v_mul_lo_u32 v7, v7, s11
    v_lshl_add_u32 v36, v6, 4, v7
    v_add_u32 v37, 8192, v36
    v_and_b32 v7, 1, v2
    v_lshl_add_u32 v7, v7, 3, v5
    v_add_u32 v7, 48, v7
    v_add_u32 v7, s6, v7
    v_mul_lo_u32 v7, v7, s11
    v_lshl_add_u32 v38, v6, 4, v7
    v_mul_u32_u24 v5, 384, v2
    v_add_u32 v5, v5, v1
    s_mov_b32 s11, 3072
    v_add_u32 v6, 0, v5
    v_mul_u32_u24 v7, 2731, v6
    v_lshrrev_b32 v7, 16, v7
    v_mul_u32_u24 v8, 24, v7
    v_sub_u32 v8, v6, v8
    v_bfe_u32 v9, v7, 1, 1
    v_bfe_u32 v17, v7, 3, 1
    v_lshl_or_b32 v9, v17, 1, v9
    v_lshrrev_b32 v17, 1, v8
    v_xor_b32 v9, v9, v17
    v_and_b32 v8, 1, v8
    v_mul_lo_u32 v7, v7, s11
    v_lshl_add_u32 v7, v8, 4, v7
    v_lshrrev_b32 v17, 2, v9
    v_lshl_add_u32 v7, v17, 10, v7
    v_and_b32 v9, 3, v9
    v_lshl_add_u32 v7, v9, 5, v7
    v_add_u32 v40, s10, v7
    v_add_u32 v6, 64, v5
    v_mul_u32_u24 v7, 2731, v6
    v_lshrrev_b32 v7, 16, v7
    v_mul_u32_u24 v8, 24, v7
    v_sub_u32 v8, v6, v8
    v_bfe_u32 v9, v7, 1, 1
    v_bfe_u32 v17, v7, 3, 1
    v_lshl_or_b32 v9, v17, 1, v9
    v_lshrrev_b32 v17, 1, v8
    v_xor_b32 v9, v9, v17
    v_and_b32 v8, 1, v8
    v_mul_lo_u32 v7, v7, s11
    v_lshl_add_u32 v7, v8, 4, v7
    v_lshrrev_b32 v17, 2, v9
    v_lshl_add_u32 v7, v17, 10, v7
    v_and_b32 v9, 3, v9
    v_lshl_add_u32 v7, v9, 5, v7
    v_add_u32 v41, s10, v7
    v_add_u32 v6, 128, v5
    v_mul_u32_u24 v7, 2731, v6
    v_lshrrev_b32 v7, 16, v7
    v_mul_u32_u24 v8, 24, v7
    v_sub_u32 v8, v6, v8
    v_bfe_u32 v9, v7, 1, 1
    v_bfe_u32 v17, v7, 3, 1
    v_lshl_or_b32 v9, v17, 1, v9
    v_lshrrev_b32 v17, 1, v8
    v_xor_b32 v9, v9, v17
    v_and_b32 v8, 1, v8
    v_mul_lo_u32 v7, v7, s11
    v_lshl_add_u32 v7, v8, 4, v7
    v_lshrrev_b32 v17, 2, v9
    v_lshl_add_u32 v7, v17, 10, v7
    v_and_b32 v9, 3, v9
    v_lshl_add_u32 v7, v9, 5, v7
    v_add_u32 v42, s10, v7
    v_add_u32 v6, 192, v5
    v_mul_u32_u24 v7, 2731, v6
    v_lshrrev_b32 v7, 16, v7
    v_mul_u32_u24 v8, 24, v7
    v_sub_u32 v8, v6, v8
    v_bfe_u32 v9, v7, 1, 1
    v_bfe_u32 v17, v7, 3, 1
    v_lshl_or_b32 v9, v17, 1, v9
    v_lshrrev_b32 v17, 1, v8
    v_xor_b32 v9, v9, v17
    v_and_b32 v8, 1, v8
    v_mul_lo_u32 v7, v7, s11
    v_lshl_add_u32 v7, v8, 4, v7
    v_lshrrev_b32 v17, 2, v9
    v_lshl_add_u32 v7, v17, 10, v7
    v_and_b32 v9, 3, v9
    v_lshl_add_u32 v7, v9, 5, v7
    v_add_u32 v43, s10, v7
    v_add_u32 v6, 256, v5
    v_mul_u32_u24 v7, 2731, v6
    v_lshrrev_b32 v7, 16, v7
    v_mul_u32_u24 v8, 24, v7
    v_sub_u32 v8, v6, v8
    v_bfe_u32 v9, v7, 1, 1
    v_bfe_u32 v17, v7, 3, 1
    v_lshl_or_b32 v9, v17, 1, v9
    v_lshrrev_b32 v17, 1, v8
    v_xor_b32 v9, v9, v17
    v_and_b32 v8, 1, v8
    v_mul_lo_u32 v7, v7, s11
    v_lshl_add_u32 v7, v8, 4, v7
    v_lshrrev_b32 v17, 2, v9
    v_lshl_add_u32 v7, v17, 10, v7
    v_and_b32 v9, 3, v9
    v_lshl_add_u32 v7, v9, 5, v7
    v_add_u32 v44, s10, v7
    v_add_u32 v6, 320, v5
    v_mul_u32_u24 v7, 2731, v6
    v_lshrrev_b32 v7, 16, v7
    v_mul_u32_u24 v8, 24, v7
    v_sub_u32 v8, v6, v8
    v_bfe_u32 v9, v7, 1, 1
    v_bfe_u32 v17, v7, 3, 1
    v_lshl_or_b32 v9, v17, 1, v9
    v_lshrrev_b32 v17, 1, v8
    v_xor_b32 v9, v9, v17
    v_and_b32 v8, 1, v8
    v_mul_lo_u32 v7, v7, s11
    v_lshl_add_u32 v7, v8, 4, v7
    v_lshrrev_b32 v17, 2, v9
    v_lshl_add_u32 v7, v17, 10, v7
    v_and_b32 v9, 3, v9
    v_lshl_add_u32 v7, v9, 5, v7
    v_add_u32 v45, s10, v7
    s_waitcnt lgkmcnt(0)
    s_mov_b32 s40, s16
    s_mov_b32 s41, s17
    s_mov_b32 s42, 2097152
    s_mov_b32 s43, 0x00020000
    s_mov_b32 s44, s18
    s_mov_b32 s45, s19
    s_mov_b32 s46, 1572864
    s_mov_b32 s47, 0x00020000
    s_mov_b32 s7, 0
    s_mov_b32 s8, 0
    s_add_u32 m0, s15, 0
    s_nop 0
    buffer_load_dwordx4 v40, s[44:47], s8 offen lds
    s_add_u32 m0, s15, 1024
    s_nop 0
    buffer_load_dwordx4 v41, s[44:47], s8 offen lds
    s_add_u32 m0, s15, 2048
    s_nop 0
    buffer_load_dwordx4 v42, s[44:47], s8 offen lds
    s_add_u32 m0, s15, 3072
    s_nop 0
    buffer_load_dwordx4 v43, s[44:47], s8 offen lds
    s_add_u32 m0, s15, 4096
    s_nop 0
    buffer_load_dwordx4 v44, s[44:47], s8 offen lds
    s_add_u32 m0, s15, 5120
    s_nop 0
    buffer_load_dwordx4 v45, s[44:47], s8 offen lds
    s_add_u32 m0, s14, 0
    s_nop 0
    buffer_load_dwordx4 v36, s[40:43], s7 offen lds
    s_add_u32 m0, s14, 1024
    s_nop 0
    buffer_load_dwordx4 v37, s[40:43], s7 offen lds
    s_add_u32 m0, s13, 0
    s_nop 0
    buffer_load_dwordx4 v38, s[40:43], s7 offen lds
    s_mov_b32 s7, 128
    s_mov_b32 s8, 196608
    s_add_u32 m0, s15, 34816
    s_nop 0
    buffer_load_dwordx4 v40, s[44:47], s8 offen lds
    s_add_u32 m0, s15, 35840
    s_nop 0
    buffer_load_dwordx4 v41, s[44:47], s8 offen lds
    s_add_u32 m0, s15, 36864
    s_nop 0
    buffer_load_dwordx4 v42, s[44:47], s8 offen lds
    s_add_u32 m0, s15, 37888
    s_nop 0
    buffer_load_dwordx4 v43, s[44:47], s8 offen lds
    s_add_u32 m0, s15, 38912
    s_nop 0
    buffer_load_dwordx4 v44, s[44:47], s8 offen lds
    s_add_u32 m0, s15, 39936
    s_nop 0
    buffer_load_dwordx4 v45, s[44:47], s8 offen lds
    s_add_u32 m0, s14, 34816
    s_nop 0
    buffer_load_dwordx4 v36, s[40:43], s7 offen lds
    s_add_u32 m0, s14, 35840
    s_nop 0
    buffer_load_dwordx4 v37, s[40:43], s7 offen lds
    s_add_u32 m0, s13, 34816
    s_nop 0
    buffer_load_dwordx4 v38, s[40:43], s7 offen lds
    s_waitcnt vmcnt(9)
    s_barrier
    s_mov_b32 s7, 256
    s_mov_b32 s8, 393216
    s_add_u32 m0, s15, 69632
    s_nop 0
    buffer_load_dwordx4 v40, s[44:47], s8 offen lds
    s_add_u32 m0, s15, 70656
    s_nop 0
    buffer_load_dwordx4 v41, s[44:47], s8 offen lds
    s_add_u32 m0, s15, 71680
    s_nop 0
    buffer_load_dwordx4 v42, s[44:47], s8 offen lds
    s_add_u32 m0, s15, 72704
    s_nop 0
    buffer_load_dwordx4 v43, s[44:47], s8 offen lds
    s_add_u32 m0, s15, 73728
    s_nop 0
    buffer_load_dwordx4 v44, s[44:47], s8 offen lds
    s_add_u32 m0, s15, 74752
    s_nop 0
    buffer_load_dwordx4 v45, s[44:47], s8 offen lds
    s_add_u32 m0, s14, 69632
    s_nop 0
    buffer_load_dwordx4 v36, s[40:43], s7 offen lds
    s_add_u32 m0, s14, 70656
    s_nop 0
    buffer_load_dwordx4 v37, s[40:43], s7 offen lds
    s_add_u32 m0, s13, 69632
    s_nop 0
    buffer_load_dwordx4 v38, s[40:43], s7 offen lds
    s_mov_b32 s7, 384
    s_mov_b32 s8, 589824
    s_add_u32 m0, s15, 104448
    s_nop 0
    buffer_load_dwordx4 v40, s[44:47], s8 offen lds
    s_add_u32 m0, s15, 105472
    s_nop 0
    buffer_load_dwordx4 v41, s[44:47], s8 offen lds
    s_add_u32 m0, s15, 106496
    s_nop 0
    buffer_load_dwordx4 v42, s[44:47], s8 offen lds
    s_add_u32 m0, s15, 107520
    s_nop 0
    buffer_load_dwordx4 v43, s[44:47], s8 offen lds
    s_add_u32 m0, s15, 108544
    s_nop 0
    buffer_load_dwordx4 v44, s[44:47], s8 offen lds
    s_add_u32 m0, s15, 109568
    s_nop 0
    buffer_load_dwordx4 v45, s[44:47], s8 offen lds
    s_add_u32 m0, s14, 104448
    s_nop 0
    buffer_load_dwordx4 v36, s[40:43], s7 offen lds
    s_add_u32 m0, s14, 105472
    s_nop 0
    buffer_load_dwordx4 v37, s[40:43], s7 offen lds
    s_add_u32 m0, s13, 104448
    s_nop 0
    buffer_load_dwordx4 v38, s[40:43], s7 offen lds
    s_waitcnt vmcnt(9)
    s_barrier
    s_mov_b32 s7, 512
    s_mov_b32 s8, 786432
    s_add_u32 m0, s15, 0
    s_nop 0
    buffer_load_dwordx4 v40, s[44:47], s8 offen lds
    s_add_u32 m0, s15, 1024
    s_nop 0
    buffer_load_dwordx4 v41, s[44:47], s8 offen lds
    s_add_u32 m0, s15, 2048
    s_nop 0
    buffer_load_dwordx4 v42, s[44:47], s8 offen lds
    s_add_u32 m0, s15, 3072
    s_nop 0
    buffer_load_dwordx4 v43, s[44:47], s8 offen lds
    s_add_u32 m0, s15, 4096
    s_nop 0
    buffer_load_dwordx4 v44, s[44:47], s8 offen lds
    s_add_u32 m0, s15, 5120
    s_nop 0
    buffer_load_dwordx4 v45, s[44:47], s8 offen lds
    s_add_u32 m0, s14, 0
    s_nop 0
    buffer_load_dwordx4 v36, s[40:43], s7 offen lds
    s_add_u32 m0, s14, 1024
    s_nop 0
    buffer_load_dwordx4 v37, s[40:43], s7 offen lds
    s_add_u32 m0, s13, 0
    s_nop 0
    buffer_load_dwordx4 v38, s[40:43], s7 offen lds
    s_waitcnt vmcnt(9)
    s_barrier
    s_mov_b32 s7, 640
    s_mov_b32 s8, 983040
    s_add_u32 m0, s15, 34816
    s_nop 0
    buffer_load_dwordx4 v40, s[44:47], s8 offen lds
    s_add_u32 m0, s15, 35840
    s_nop 0
    buffer_load_dwordx4 v41, s[44:47], s8 offen lds
    s_add_u32 m0, s15, 36864
    s_nop 0
    buffer_load_dwordx4 v42, s[44:47], s8 offen lds
    s_add_u32 m0, s15, 37888
    s_nop 0
    buffer_load_dwordx4 v43, s[44:47], s8 offen lds
    s_add_u32 m0, s15, 38912
    s_nop 0
    buffer_load_dwordx4 v44, s[44:47], s8 offen lds
    s_add_u32 m0, s15, 39936
    s_nop 0
    buffer_load_dwordx4 v45, s[44:47], s8 offen lds
    s_add_u32 m0, s14, 34816
    s_nop 0
    buffer_load_dwordx4 v36, s[40:43], s7 offen lds
    s_add_u32 m0, s14, 35840
    s_nop 0
    buffer_load_dwordx4 v37, s[40:43], s7 offen lds
    s_add_u32 m0, s13, 34816
    s_nop 0
    buffer_load_dwordx4 v38, s[40:43], s7 offen lds
    s_waitcnt vmcnt(9)
    s_barrier
    s_mov_b32 s7, 768
    s_mov_b32 s8, 1179648
    s_add_u32 m0, s15, 69632
    s_nop 0
    buffer_load_dwordx4 v40, s[44:47], s8 offen lds
    s_add_u32 m0, s15, 70656
    s_nop 0
    buffer_load_dwordx4 v41, s[44:47], s8 offen lds
    s_add_u32 m0, s15, 71680
    s_nop 0
    buffer_load_dwordx4 v42, s[44:47], s8 offen lds
    s_add_u32 m0, s15, 72704
    s_nop 0
    buffer_load_dwordx4 v43, s[44:47], s8 offen lds
    s_add_u32 m0, s15, 73728
    s_nop 0
    buffer_load_dwordx4 v44, s[44:47], s8 offen lds
    s_add_u32 m0, s15, 74752
    s_nop 0
    buffer_load_dwordx4 v45, s[44:47], s8 offen lds
    s_add_u32 m0, s14, 69632
    s_nop 0
    buffer_load_dwordx4 v36, s[40:43], s7 offen lds
    s_add_u32 m0, s14, 70656
    s_nop 0
    buffer_load_dwordx4 v37, s[40:43], s7 offen lds
    s_add_u32 m0, s13, 69632
    s_nop 0
    buffer_load_dwordx4 v38, s[40:43], s7 offen lds
    s_waitcnt vmcnt(9)
    s_barrier
    s_mov_b32 s7, 896
    s_mov_b32 s8, 1376256
    s_add_u32 m0, s15, 104448
    s_nop 0
    buffer_load_dwordx4 v40, s[44:47], s8 offen lds
    s_add_u32 m0, s15, 105472
    s_nop 0
    buffer_load_dwordx4 v41, s[44:47], s8 offen lds
    s_add_u32 m0, s15, 106496
    s_nop 0
    buffer_load_dwordx4 v42, s[44:47], s8 offen lds
    s_add_u32 m0, s15, 107520
    s_nop 0
    buffer_load_dwordx4 v43, s[44:47], s8 offen lds
    s_add_u32 m0, s15, 108544
    s_nop 0
    buffer_load_dwordx4 v44, s[44:47], s8 offen lds
    s_add_u32 m0, s15, 109568
    s_nop 0
    buffer_load_dwordx4 v45, s[44:47], s8 offen lds
    s_add_u32 m0, s14, 104448
    s_nop 0
    buffer_load_dwordx4 v36, s[40:43], s7 offen lds
    s_add_u32 m0, s14, 105472
    s_nop 0
    buffer_load_dwordx4 v37, s[40:43], s7 offen lds
    s_add_u32 m0, s13, 104448
    s_nop 0
    buffer_load_dwordx4 v38, s[40:43], s7 offen lds
    s_waitcnt vmcnt(9)
    s_barrier
    s_waitcnt vmcnt(0)
    s_barrier
    s_waitcnt vmcnt(0)
    s_barrier
    s_endpgm
L_comp_g1a0_kernel:
    s_waitcnt lgkmcnt(0)
    s_mov_b32 s52, s36
    s_mov_b32 s53, s37
    s_mov_b32 s54, 2097152
    s_mov_b32 s55, 0x00020000
    v_and_b32 v5, 255, v0
    v_lshlrev_b32 v5, 4, v5
    s_mov_b32 s76, s20
    s_mov_b32 s77, s21
    s_mov_b32 s78, 524288
    s_mov_b32 s79, 0x00020000
    s_mul_i32 s12, s2, 4096
    v_add_u32 v6, s12, v5
    s_mov_b32 s13, 0
    buffer_load_dwordx4 v[252:255], v6, s[76:79], s13 offen
    s_mov_b32 s76, s24
    s_mov_b32 s77, s25
    s_mov_b32 s78, 1409024
    s_mov_b32 s79, 0x00020000
    s_mul_i32 s12, s2, 8192
    v_add_u32 v6, s12, v5
    s_mov_b32 s13, 0
    buffer_load_dwordx4 v[252:255], v6, s[76:79], s13 offen
    s_mov_b32 s13, 4096
    buffer_load_dwordx4 v[252:255], v6, s[76:79], s13 offen
    s_mov_b32 s76, s26
    s_mov_b32 s77, s27
    s_mov_b32 s78, 8388608
    s_mov_b32 s79, 0x00020000
    s_mul_i32 s12, s2, 32768
    v_add_u32 v6, s12, v5
    s_mov_b32 s13, 0
    buffer_load_dwordx4 v[252:255], v6, s[76:79], s13 offen
    s_mov_b32 s13, 4096
    buffer_load_dwordx4 v[252:255], v6, s[76:79], s13 offen
    s_mov_b32 s13, 8192
    buffer_load_dwordx4 v[252:255], v6, s[76:79], s13 offen
    s_mov_b32 s13, 12288
    buffer_load_dwordx4 v[252:255], v6, s[76:79], s13 offen
    s_mov_b32 s13, 16384
    buffer_load_dwordx4 v[252:255], v6, s[76:79], s13 offen
    s_mov_b32 s13, 20480
    buffer_load_dwordx4 v[252:255], v6, s[76:79], s13 offen
    s_mov_b32 s13, 24576
    buffer_load_dwordx4 v[252:255], v6, s[76:79], s13 offen
    s_mov_b32 s13, 28672
    buffer_load_dwordx4 v[252:255], v6, s[76:79], s13 offen
    s_mov_b32 s76, s30
    s_mov_b32 s77, s31
    s_mov_b32 s78, 704512
    s_mov_b32 s79, 0x00020000
    s_mul_i32 s12, s2, 4096
    v_add_u32 v6, s12, v5
    s_mov_b32 s13, 0
    buffer_load_dwordx4 v[252:255], v6, s[76:79], s13 offen
    v_add_u32 v7, 0, v4
    v_and_b32 v17, 7, v3
    v_xor_b32 v7, v7, v17
    v_lshlrev_b32 v7, 4, v7
    v_lshl_add_u32 v14, v3, 7, v7
    v_add_u32 v7, 4, v4
    v_and_b32 v17, 7, v3
    v_xor_b32 v7, v7, v17
    v_lshlrev_b32 v7, 4, v7
    v_lshl_add_u32 v15, v3, 7, v7
    v_mov_b32 v9, v2
    v_lshrrev_b32 v5, 2, v3
    v_lshl_add_u32 v5, v4, 3, v5
    v_bfe_u32 v6, v5, 1, 1
    v_bfe_u32 v7, v5, 3, 1
    v_lshl_or_b32 v6, v7, 1, v6
    v_xor_b32 v6, v6, v9
    v_mul_u32_u24 v5, 384, v5
    v_lshl_add_u32 v5, v6, 5, v5
    v_and_b32 v6, 3, v3
    v_lshl_add_u32 v5, v6, 3, v5
    v_add_u32 v16, 10240, v5
    v_add_u32 v212, 34816, v14
    v_add_u32 v213, 34816, v15
    v_add_u32 v214, 34816, v16
    v_add_u32 v217, 69632, v14
    v_add_u32 v218, 69632, v15
    v_add_u32 v219, 69632, v16
    v_add_u32 v222, 104448, v14
    v_add_u32 v223, 104448, v15
    v_add_u32 v224, 104448, v16
    v_mov_b32 v120, 0
    v_mov_b32 v121, 0
    v_mov_b32 v122, 0
    v_mov_b32 v123, 0
    v_mov_b32 v124, 0
    v_mov_b32 v125, 0
    v_mov_b32 v126, 0
    v_mov_b32 v127, 0
    v_mov_b32 v128, 0
    v_mov_b32 v129, 0
    v_mov_b32 v130, 0
    v_mov_b32 v131, 0
    v_mov_b32 v132, 0
    v_mov_b32 v133, 0
    v_mov_b32 v134, 0
    v_mov_b32 v135, 0
    v_mov_b32 v136, 0
    v_mov_b32 v137, 0
    v_mov_b32 v138, 0
    v_mov_b32 v139, 0
    v_mov_b32 v140, 0
    v_mov_b32 v141, 0
    v_mov_b32 v142, 0
    v_mov_b32 v143, 0
    v_mov_b32 v144, 0
    v_mov_b32 v145, 0
    v_mov_b32 v146, 0
    v_mov_b32 v147, 0
    v_mov_b32 v148, 0
    v_mov_b32 v149, 0
    v_mov_b32 v150, 0
    v_mov_b32 v151, 0
    v_mov_b32 v152, 0
    v_mov_b32 v153, 0
    v_mov_b32 v154, 0
    v_mov_b32 v155, 0
    v_mov_b32 v156, 0
    v_mov_b32 v157, 0
    v_mov_b32 v158, 0
    v_mov_b32 v159, 0
    v_mov_b32 v160, 0
    v_mov_b32 v161, 0
    v_mov_b32 v162, 0
    v_mov_b32 v163, 0
    v_mov_b32 v164, 0
    v_mov_b32 v165, 0
    v_mov_b32 v166, 0
    v_mov_b32 v167, 0
    v_mov_b32 v168, 0
    v_mov_b32 v169, 0
    v_mov_b32 v170, 0
    v_mov_b32 v171, 0
    v_mov_b32 v172, 0
    v_mov_b32 v173, 0
    v_mov_b32 v174, 0
    v_mov_b32 v175, 0
    v_mov_b32 v176, 0
    v_mov_b32 v177, 0
    v_mov_b32 v178, 0
    v_mov_b32 v179, 0
    v_mov_b32 v180, 0
    v_mov_b32 v181, 0
    v_mov_b32 v182, 0
    v_mov_b32 v183, 0
    v_mov_b32 v184, 0
    v_mov_b32 v185, 0
    v_mov_b32 v186, 0
    v_mov_b32 v187, 0
    v_mov_b32 v188, s9
    v_mov_b32 v189, s9
    v_mov_b32 v190, s9
    v_mov_b32 v191, s9
    v_mov_b32 v32, 0
    v_mov_b32 v33, 0
    v_mov_b32 v34, 0
    v_mov_b32 v35, 0
    v_mov_b32 v36, 0
    v_mov_b32 v37, 0
    v_mov_b32 v38, 0
    v_mov_b32 v39, 0
    v_mov_b32 v40, 0
    v_mov_b32 v41, 0
    v_mov_b32 v42, 0
    v_mov_b32 v43, 0
    v_mov_b32 v44, 0
    v_mov_b32 v45, 0
    v_mov_b32 v46, 0
    v_mov_b32 v47, 0
    v_lshlrev_b32 v30, 11, v2
    s_barrier
    ds_read_b64_tr_b16 v[76:77], v16 offset:0
    ds_read_b64_tr_b16 v[78:79], v16 offset:1536
    ds_read_b64_tr_b16 v[80:81], v16 offset:128
    ds_read_b64_tr_b16 v[82:83], v16 offset:1664
    ds_read_b64_tr_b16 v[84:85], v16 offset:256
    ds_read_b64_tr_b16 v[86:87], v16 offset:1792
    ds_read_b128 v[56:59], v14 offset:0
    ds_read_b128 v[60:63], v14 offset:2048
    ds_read_b128 v[64:67], v14 offset:4096
    ds_read_b128 v[68:71], v14 offset:6144
    ds_read_b128 v[72:75], v14 offset:8192
    v_add_u32 v31, v30, v14
    ds_read_b128 v[196:199], v31
    s_waitcnt lgkmcnt(0)
    v_mfma_f32_16x16x32_bf16 v[176:179], v[76:79], v[188:191], v[176:179]
    ds_read_b64_tr_b16 v[108:109], v16 offset:12288
    ds_read_b64_tr_b16 v[110:111], v16 offset:13824
    v_mfma_f32_16x16x32_bf16 v[180:183], v[80:83], v[188:191], v[180:183]
    ds_read_b64_tr_b16 v[112:113], v16 offset:12416
    ds_read_b64_tr_b16 v[114:115], v16 offset:13952
    v_mfma_f32_16x16x32_bf16 v[184:187], v[188:191], v[84:87], v[184:187]
    ds_read_b64_tr_b16 v[116:117], v16 offset:12544
    ds_read_b64_tr_b16 v[118:119], v16 offset:14080
    v_mfma_f32_16x16x32_bf16 v[136:139], v[80:83], v[56:59], v[136:139]
    ds_read_b128 v[88:91], v15 offset:0
    ds_read_b128 v[92:95], v15 offset:2048
    v_mfma_f32_16x16x32_bf16 v[156:159], v[56:59], v[84:87], v[156:159]
    ds_read_b128 v[96:99], v15 offset:4096
    ds_read_b128 v[100:103], v15 offset:6144
    v_mfma_f32_16x16x32_bf16 v[120:123], v[76:79], v[60:63], v[120:123]
    ds_read_b128 v[104:107], v15 offset:8192
    v_add_u32 v31, v30, v15
    v_mfma_f32_16x16x32_bf16 v[140:143], v[80:83], v[60:63], v[140:143]
    ds_read_b128 v[200:203], v31
    v_mfma_f32_16x16x32_bf16 v[160:163], v[60:63], v[84:87], v[160:163]
    v_mfma_f32_16x16x32_bf16 v[124:127], v[76:79], v[64:67], v[124:127]
    v_mfma_f32_16x16x32_bf16 v[144:147], v[80:83], v[64:67], v[144:147]
    v_mfma_f32_16x16x32_bf16 v[164:167], v[64:67], v[84:87], v[164:167]
    v_mfma_f32_16x16x32_bf16 v[128:131], v[76:79], v[68:71], v[128:131]
    v_mfma_f32_16x16x32_bf16 v[148:151], v[80:83], v[68:71], v[148:151]
    v_mfma_f32_16x16x32_bf16 v[168:171], v[68:71], v[84:87], v[168:171]
    v_mfma_f32_16x16x32_bf16 v[132:135], v[76:79], v[72:75], v[132:135]
    v_mfma_f32_16x16x32_bf16 v[152:155], v[80:83], v[72:75], v[152:155]
    v_mfma_f32_16x16x32_bf16 v[172:175], v[72:75], v[84:87], v[172:175]
    v_mfma_f32_16x16x32_bf16 v[32:35], v[188:191], v[196:199], v[32:35]
    v_mfma_f32_16x16x32_bf16 v[36:39], v[196:199], v[196:199], v[36:39]
    v_mfma_f32_16x16x32_bf16 v[40:43], v[188:191], v[72:75], v[40:43]
    v_mfma_f32_16x16x32_bf16 v[44:47], v[72:75], v[72:75], v[44:47]
    s_waitcnt lgkmcnt(0)
    v_mfma_f32_16x16x32_bf16 v[176:179], v[108:111], v[188:191], v[176:179]
    v_mfma_f32_16x16x32_bf16 v[180:183], v[112:115], v[188:191], v[180:183]
    v_mfma_f32_16x16x32_bf16 v[184:187], v[188:191], v[116:119], v[184:187]
    v_mfma_f32_16x16x32_bf16 v[136:139], v[112:115], v[88:91], v[136:139]
    v_mfma_f32_16x16x32_bf16 v[156:159], v[88:91], v[116:119], v[156:159]
    v_mfma_f32_16x16x32_bf16 v[120:123], v[108:111], v[92:95], v[120:123]
    v_mfma_f32_16x16x32_bf16 v[140:143], v[112:115], v[92:95], v[140:143]
    v_mfma_f32_16x16x32_bf16 v[160:163], v[92:95], v[116:119], v[160:163]
    v_mfma_f32_16x16x32_bf16 v[124:127], v[108:111], v[96:99], v[124:127]
    v_mfma_f32_16x16x32_bf16 v[144:147], v[112:115], v[96:99], v[144:147]
    v_mfma_f32_16x16x32_bf16 v[164:167], v[96:99], v[116:119], v[164:167]
    v_mfma_f32_16x16x32_bf16 v[128:131], v[108:111], v[100:103], v[128:131]
    v_mfma_f32_16x16x32_bf16 v[148:151], v[112:115], v[100:103], v[148:151]
    v_mfma_f32_16x16x32_bf16 v[168:171], v[100:103], v[116:119], v[168:171]
    v_mfma_f32_16x16x32_bf16 v[132:135], v[108:111], v[104:107], v[132:135]
    v_mfma_f32_16x16x32_bf16 v[152:155], v[112:115], v[104:107], v[152:155]
    v_mfma_f32_16x16x32_bf16 v[172:175], v[104:107], v[116:119], v[172:175]
    v_mfma_f32_16x16x32_bf16 v[32:35], v[188:191], v[200:203], v[32:35]
    v_mfma_f32_16x16x32_bf16 v[36:39], v[200:203], v[200:203], v[36:39]
    v_mfma_f32_16x16x32_bf16 v[40:43], v[188:191], v[104:107], v[40:43]
    v_mfma_f32_16x16x32_bf16 v[44:47], v[104:107], v[104:107], v[44:47]
    s_barrier
    ds_read_b64_tr_b16 v[76:77], v214 offset:0
    ds_read_b64_tr_b16 v[78:79], v214 offset:1536
    ds_read_b64_tr_b16 v[80:81], v214 offset:128
    ds_read_b64_tr_b16 v[82:83], v214 offset:1664
    ds_read_b64_tr_b16 v[84:85], v214 offset:256
    ds_read_b64_tr_b16 v[86:87], v214 offset:1792
    ds_read_b128 v[56:59], v212 offset:0
    ds_read_b128 v[60:63], v212 offset:2048
    ds_read_b128 v[64:67], v212 offset:4096
    ds_read_b128 v[68:71], v212 offset:6144
    ds_read_b128 v[72:75], v212 offset:8192
    v_add_u32 v31, v30, v212
    ds_read_b128 v[196:199], v31
    s_waitcnt lgkmcnt(0)
    v_mfma_f32_16x16x32_bf16 v[176:179], v[76:79], v[188:191], v[176:179]
    ds_read_b64_tr_b16 v[108:109], v214 offset:12288
    ds_read_b64_tr_b16 v[110:111], v214 offset:13824
    v_mfma_f32_16x16x32_bf16 v[180:183], v[80:83], v[188:191], v[180:183]
    ds_read_b64_tr_b16 v[112:113], v214 offset:12416
    ds_read_b64_tr_b16 v[114:115], v214 offset:13952
    v_mfma_f32_16x16x32_bf16 v[184:187], v[188:191], v[84:87], v[184:187]
    ds_read_b64_tr_b16 v[116:117], v214 offset:12544
    ds_read_b64_tr_b16 v[118:119], v214 offset:14080
    v_mfma_f32_16x16x32_bf16 v[136:139], v[80:83], v[56:59], v[136:139]
    ds_read_b128 v[88:91], v213 offset:0
    ds_read_b128 v[92:95], v213 offset:2048
    v_mfma_f32_16x16x32_bf16 v[156:159], v[56:59], v[84:87], v[156:159]
    ds_read_b128 v[96:99], v213 offset:4096
    ds_read_b128 v[100:103], v213 offset:6144
    v_mfma_f32_16x16x32_bf16 v[120:123], v[76:79], v[60:63], v[120:123]
    ds_read_b128 v[104:107], v213 offset:8192
    v_add_u32 v31, v30, v213
    v_mfma_f32_16x16x32_bf16 v[140:143], v[80:83], v[60:63], v[140:143]
    ds_read_b128 v[200:203], v31
    v_mfma_f32_16x16x32_bf16 v[160:163], v[60:63], v[84:87], v[160:163]
    v_mfma_f32_16x16x32_bf16 v[124:127], v[76:79], v[64:67], v[124:127]
    v_mfma_f32_16x16x32_bf16 v[144:147], v[80:83], v[64:67], v[144:147]
    v_mfma_f32_16x16x32_bf16 v[164:167], v[64:67], v[84:87], v[164:167]
    v_mfma_f32_16x16x32_bf16 v[128:131], v[76:79], v[68:71], v[128:131]
    v_mfma_f32_16x16x32_bf16 v[148:151], v[80:83], v[68:71], v[148:151]
    v_mfma_f32_16x16x32_bf16 v[168:171], v[68:71], v[84:87], v[168:171]
    v_mfma_f32_16x16x32_bf16 v[132:135], v[76:79], v[72:75], v[132:135]
    v_mfma_f32_16x16x32_bf16 v[152:155], v[80:83], v[72:75], v[152:155]
    v_mfma_f32_16x16x32_bf16 v[172:175], v[72:75], v[84:87], v[172:175]
    v_mfma_f32_16x16x32_bf16 v[32:35], v[188:191], v[196:199], v[32:35]
    v_mfma_f32_16x16x32_bf16 v[36:39], v[196:199], v[196:199], v[36:39]
    v_mfma_f32_16x16x32_bf16 v[40:43], v[188:191], v[72:75], v[40:43]
    v_mfma_f32_16x16x32_bf16 v[44:47], v[72:75], v[72:75], v[44:47]
    s_waitcnt lgkmcnt(0)
    v_mfma_f32_16x16x32_bf16 v[176:179], v[108:111], v[188:191], v[176:179]
    ds_read_b64_tr_b16 v[76:77], v219 offset:0
    ds_read_b64_tr_b16 v[78:79], v219 offset:1536
    v_mfma_f32_16x16x32_bf16 v[180:183], v[112:115], v[188:191], v[180:183]
    ds_read_b64_tr_b16 v[80:81], v219 offset:128
    ds_read_b64_tr_b16 v[82:83], v219 offset:1664
    v_mfma_f32_16x16x32_bf16 v[184:187], v[188:191], v[116:119], v[184:187]
    ds_read_b64_tr_b16 v[84:85], v219 offset:256
    ds_read_b64_tr_b16 v[86:87], v219 offset:1792
    v_mfma_f32_16x16x32_bf16 v[136:139], v[112:115], v[88:91], v[136:139]
    ds_read_b128 v[56:59], v217 offset:0
    ds_read_b128 v[60:63], v217 offset:2048
    v_mfma_f32_16x16x32_bf16 v[156:159], v[88:91], v[116:119], v[156:159]
    ds_read_b128 v[64:67], v217 offset:4096
    ds_read_b128 v[68:71], v217 offset:6144
    v_mfma_f32_16x16x32_bf16 v[120:123], v[108:111], v[92:95], v[120:123]
    ds_read_b128 v[72:75], v217 offset:8192
    v_add_u32 v31, v30, v217
    v_mfma_f32_16x16x32_bf16 v[140:143], v[112:115], v[92:95], v[140:143]
    ds_read_b128 v[196:199], v31
    v_mfma_f32_16x16x32_bf16 v[160:163], v[92:95], v[116:119], v[160:163]
    v_mfma_f32_16x16x32_bf16 v[124:127], v[108:111], v[96:99], v[124:127]
    v_mfma_f32_16x16x32_bf16 v[144:147], v[112:115], v[96:99], v[144:147]
    v_mfma_f32_16x16x32_bf16 v[164:167], v[96:99], v[116:119], v[164:167]
    v_mfma_f32_16x16x32_bf16 v[128:131], v[108:111], v[100:103], v[128:131]
    v_mfma_f32_16x16x32_bf16 v[148:151], v[112:115], v[100:103], v[148:151]
    v_mfma_f32_16x16x32_bf16 v[168:171], v[100:103], v[116:119], v[168:171]
    v_mfma_f32_16x16x32_bf16 v[132:135], v[108:111], v[104:107], v[132:135]
    v_mfma_f32_16x16x32_bf16 v[152:155], v[112:115], v[104:107], v[152:155]
    v_mfma_f32_16x16x32_bf16 v[172:175], v[104:107], v[116:119], v[172:175]
    v_mfma_f32_16x16x32_bf16 v[32:35], v[188:191], v[200:203], v[32:35]
    v_mfma_f32_16x16x32_bf16 v[36:39], v[200:203], v[200:203], v[36:39]
    v_mfma_f32_16x16x32_bf16 v[40:43], v[188:191], v[104:107], v[40:43]
    v_mfma_f32_16x16x32_bf16 v[44:47], v[104:107], v[104:107], v[44:47]
    s_barrier
    s_waitcnt lgkmcnt(0)
    v_mfma_f32_16x16x32_bf16 v[176:179], v[76:79], v[188:191], v[176:179]
    ds_read_b64_tr_b16 v[108:109], v219 offset:12288
    ds_read_b64_tr_b16 v[110:111], v219 offset:13824
    v_mfma_f32_16x16x32_bf16 v[180:183], v[80:83], v[188:191], v[180:183]
    ds_read_b64_tr_b16 v[112:113], v219 offset:12416
    ds_read_b64_tr_b16 v[114:115], v219 offset:13952
    v_mfma_f32_16x16x32_bf16 v[184:187], v[188:191], v[84:87], v[184:187]
    ds_read_b64_tr_b16 v[116:117], v219 offset:12544
    ds_read_b64_tr_b16 v[118:119], v219 offset:14080
    v_mfma_f32_16x16x32_bf16 v[136:139], v[80:83], v[56:59], v[136:139]
    ds_read_b128 v[88:91], v218 offset:0
    ds_read_b128 v[92:95], v218 offset:2048
    v_mfma_f32_16x16x32_bf16 v[156:159], v[56:59], v[84:87], v[156:159]
    ds_read_b128 v[96:99], v218 offset:4096
    ds_read_b128 v[100:103], v218 offset:6144
    v_mfma_f32_16x16x32_bf16 v[120:123], v[76:79], v[60:63], v[120:123]
    ds_read_b128 v[104:107], v218 offset:8192
    v_add_u32 v31, v30, v218
    v_mfma_f32_16x16x32_bf16 v[140:143], v[80:83], v[60:63], v[140:143]
    ds_read_b128 v[200:203], v31
    v_mfma_f32_16x16x32_bf16 v[160:163], v[60:63], v[84:87], v[160:163]
    v_mfma_f32_16x16x32_bf16 v[124:127], v[76:79], v[64:67], v[124:127]
    v_mfma_f32_16x16x32_bf16 v[144:147], v[80:83], v[64:67], v[144:147]
    v_mfma_f32_16x16x32_bf16 v[164:167], v[64:67], v[84:87], v[164:167]
    v_mfma_f32_16x16x32_bf16 v[128:131], v[76:79], v[68:71], v[128:131]
    v_mfma_f32_16x16x32_bf16 v[148:151], v[80:83], v[68:71], v[148:151]
    v_mfma_f32_16x16x32_bf16 v[168:171], v[68:71], v[84:87], v[168:171]
    v_mfma_f32_16x16x32_bf16 v[132:135], v[76:79], v[72:75], v[132:135]
    v_mfma_f32_16x16x32_bf16 v[152:155], v[80:83], v[72:75], v[152:155]
    v_mfma_f32_16x16x32_bf16 v[172:175], v[72:75], v[84:87], v[172:175]
    v_mfma_f32_16x16x32_bf16 v[32:35], v[188:191], v[196:199], v[32:35]
    v_mfma_f32_16x16x32_bf16 v[36:39], v[196:199], v[196:199], v[36:39]
    v_mfma_f32_16x16x32_bf16 v[40:43], v[188:191], v[72:75], v[40:43]
    v_mfma_f32_16x16x32_bf16 v[44:47], v[72:75], v[72:75], v[44:47]
    s_waitcnt lgkmcnt(0)
    v_mfma_f32_16x16x32_bf16 v[176:179], v[108:111], v[188:191], v[176:179]
    ds_read_b64_tr_b16 v[76:77], v224 offset:0
    ds_read_b64_tr_b16 v[78:79], v224 offset:1536
    v_mfma_f32_16x16x32_bf16 v[180:183], v[112:115], v[188:191], v[180:183]
    ds_read_b64_tr_b16 v[80:81], v224 offset:128
    ds_read_b64_tr_b16 v[82:83], v224 offset:1664
    v_mfma_f32_16x16x32_bf16 v[184:187], v[188:191], v[116:119], v[184:187]
    ds_read_b64_tr_b16 v[84:85], v224 offset:256
    ds_read_b64_tr_b16 v[86:87], v224 offset:1792
    v_mfma_f32_16x16x32_bf16 v[136:139], v[112:115], v[88:91], v[136:139]
    ds_read_b128 v[56:59], v222 offset:0
    ds_read_b128 v[60:63], v222 offset:2048
    v_mfma_f32_16x16x32_bf16 v[156:159], v[88:91], v[116:119], v[156:159]
    ds_read_b128 v[64:67], v222 offset:4096
    ds_read_b128 v[68:71], v222 offset:6144
    v_mfma_f32_16x16x32_bf16 v[120:123], v[108:111], v[92:95], v[120:123]
    ds_read_b128 v[72:75], v222 offset:8192
    v_add_u32 v31, v30, v222
    v_mfma_f32_16x16x32_bf16 v[140:143], v[112:115], v[92:95], v[140:143]
    ds_read_b128 v[196:199], v31
    v_mfma_f32_16x16x32_bf16 v[160:163], v[92:95], v[116:119], v[160:163]
    v_mfma_f32_16x16x32_bf16 v[124:127], v[108:111], v[96:99], v[124:127]
    v_mfma_f32_16x16x32_bf16 v[144:147], v[112:115], v[96:99], v[144:147]
    v_mfma_f32_16x16x32_bf16 v[164:167], v[96:99], v[116:119], v[164:167]
    v_mfma_f32_16x16x32_bf16 v[128:131], v[108:111], v[100:103], v[128:131]
    v_mfma_f32_16x16x32_bf16 v[148:151], v[112:115], v[100:103], v[148:151]
    v_mfma_f32_16x16x32_bf16 v[168:171], v[100:103], v[116:119], v[168:171]
    v_mfma_f32_16x16x32_bf16 v[132:135], v[108:111], v[104:107], v[132:135]
    v_mfma_f32_16x16x32_bf16 v[152:155], v[112:115], v[104:107], v[152:155]
    v_mfma_f32_16x16x32_bf16 v[172:175], v[104:107], v[116:119], v[172:175]
    v_mfma_f32_16x16x32_bf16 v[32:35], v[188:191], v[200:203], v[32:35]
    v_mfma_f32_16x16x32_bf16 v[36:39], v[200:203], v[200:203], v[36:39]
    v_mfma_f32_16x16x32_bf16 v[40:43], v[188:191], v[104:107], v[40:43]
    v_mfma_f32_16x16x32_bf16 v[44:47], v[104:107], v[104:107], v[44:47]
    s_barrier
    s_waitcnt lgkmcnt(0)
    v_mfma_f32_16x16x32_bf16 v[176:179], v[76:79], v[188:191], v[176:179]
    ds_read_b64_tr_b16 v[108:109], v224 offset:12288
    ds_read_b64_tr_b16 v[110:111], v224 offset:13824
    v_mfma_f32_16x16x32_bf16 v[180:183], v[80:83], v[188:191], v[180:183]
    ds_read_b64_tr_b16 v[112:113], v224 offset:12416
    ds_read_b64_tr_b16 v[114:115], v224 offset:13952
    v_mfma_f32_16x16x32_bf16 v[184:187], v[188:191], v[84:87], v[184:187]
    ds_read_b64_tr_b16 v[116:117], v224 offset:12544
    ds_read_b64_tr_b16 v[118:119], v224 offset:14080
    v_mfma_f32_16x16x32_bf16 v[136:139], v[80:83], v[56:59], v[136:139]
    ds_read_b128 v[88:91], v223 offset:0
    ds_read_b128 v[92:95], v223 offset:2048
    v_mfma_f32_16x16x32_bf16 v[156:159], v[56:59], v[84:87], v[156:159]
    ds_read_b128 v[96:99], v223 offset:4096
    ds_read_b128 v[100:103], v223 offset:6144
    v_mfma_f32_16x16x32_bf16 v[120:123], v[76:79], v[60:63], v[120:123]
    ds_read_b128 v[104:107], v223 offset:8192
    v_add_u32 v31, v30, v223
    v_mfma_f32_16x16x32_bf16 v[140:143], v[80:83], v[60:63], v[140:143]
    ds_read_b128 v[200:203], v31
    v_mfma_f32_16x16x32_bf16 v[160:163], v[60:63], v[84:87], v[160:163]
    v_mfma_f32_16x16x32_bf16 v[124:127], v[76:79], v[64:67], v[124:127]
    v_mfma_f32_16x16x32_bf16 v[144:147], v[80:83], v[64:67], v[144:147]
    v_mfma_f32_16x16x32_bf16 v[164:167], v[64:67], v[84:87], v[164:167]
    v_mfma_f32_16x16x32_bf16 v[128:131], v[76:79], v[68:71], v[128:131]
    v_mfma_f32_16x16x32_bf16 v[148:151], v[80:83], v[68:71], v[148:151]
    v_mfma_f32_16x16x32_bf16 v[168:171], v[68:71], v[84:87], v[168:171]
    v_mfma_f32_16x16x32_bf16 v[132:135], v[76:79], v[72:75], v[132:135]
    v_mfma_f32_16x16x32_bf16 v[152:155], v[80:83], v[72:75], v[152:155]
    v_mfma_f32_16x16x32_bf16 v[172:175], v[72:75], v[84:87], v[172:175]
    v_mfma_f32_16x16x32_bf16 v[32:35], v[188:191], v[196:199], v[32:35]
    v_mfma_f32_16x16x32_bf16 v[36:39], v[196:199], v[196:199], v[36:39]
    v_mfma_f32_16x16x32_bf16 v[40:43], v[188:191], v[72:75], v[40:43]
    v_mfma_f32_16x16x32_bf16 v[44:47], v[72:75], v[72:75], v[44:47]
    s_waitcnt lgkmcnt(0)
    v_mfma_f32_16x16x32_bf16 v[176:179], v[108:111], v[188:191], v[176:179]
    ds_read_b64_tr_b16 v[76:77], v16 offset:0
    ds_read_b64_tr_b16 v[78:79], v16 offset:1536
    v_mfma_f32_16x16x32_bf16 v[180:183], v[112:115], v[188:191], v[180:183]
    ds_read_b64_tr_b16 v[80:81], v16 offset:128
    ds_read_b64_tr_b16 v[82:83], v16 offset:1664
    v_mfma_f32_16x16x32_bf16 v[184:187], v[188:191], v[116:119], v[184:187]
    ds_read_b64_tr_b16 v[84:85], v16 offset:256
    ds_read_b64_tr_b16 v[86:87], v16 offset:1792
    v_mfma_f32_16x16x32_bf16 v[136:139], v[112:115], v[88:91], v[136:139]
    ds_read_b128 v[56:59], v14 offset:0
    ds_read_b128 v[60:63], v14 offset:2048
    v_mfma_f32_16x16x32_bf16 v[156:159], v[88:91], v[116:119], v[156:159]
    ds_read_b128 v[64:67], v14 offset:4096
    ds_read_b128 v[68:71], v14 offset:6144
    v_mfma_f32_16x16x32_bf16 v[120:123], v[108:111], v[92:95], v[120:123]
    ds_read_b128 v[72:75], v14 offset:8192
    v_add_u32 v31, v30, v14
    v_mfma_f32_16x16x32_bf16 v[140:143], v[112:115], v[92:95], v[140:143]
    ds_read_b128 v[196:199], v31
    v_mfma_f32_16x16x32_bf16 v[160:163], v[92:95], v[116:119], v[160:163]
    v_mfma_f32_16x16x32_bf16 v[124:127], v[108:111], v[96:99], v[124:127]
    v_mfma_f32_16x16x32_bf16 v[144:147], v[112:115], v[96:99], v[144:147]
    v_mfma_f32_16x16x32_bf16 v[164:167], v[96:99], v[116:119], v[164:167]
    v_mfma_f32_16x16x32_bf16 v[128:131], v[108:111], v[100:103], v[128:131]
    v_mfma_f32_16x16x32_bf16 v[148:151], v[112:115], v[100:103], v[148:151]
    v_mfma_f32_16x16x32_bf16 v[168:171], v[100:103], v[116:119], v[168:171]
    v_mfma_f32_16x16x32_bf16 v[132:135], v[108:111], v[104:107], v[132:135]
    v_mfma_f32_16x16x32_bf16 v[152:155], v[112:115], v[104:107], v[152:155]
    v_mfma_f32_16x16x32_bf16 v[172:175], v[104:107], v[116:119], v[172:175]
    v_mfma_f32_16x16x32_bf16 v[32:35], v[188:191], v[200:203], v[32:35]
    v_mfma_f32_16x16x32_bf16 v[36:39], v[200:203], v[200:203], v[36:39]
    v_mfma_f32_16x16x32_bf16 v[40:43], v[188:191], v[104:107], v[40:43]
    v_mfma_f32_16x16x32_bf16 v[44:47], v[104:107], v[104:107], v[44:47]
    s_barrier
    s_waitcnt lgkmcnt(0)
    v_mfma_f32_16x16x32_bf16 v[176:179], v[76:79], v[188:191], v[176:179]
    ds_read_b64_tr_b16 v[108:109], v16 offset:12288
    ds_read_b64_tr_b16 v[110:111], v16 offset:13824
    v_mfma_f32_16x16x32_bf16 v[180:183], v[80:83], v[188:191], v[180:183]
    ds_read_b64_tr_b16 v[112:113], v16 offset:12416
    ds_read_b64_tr_b16 v[114:115], v16 offset:13952
    v_mfma_f32_16x16x32_bf16 v[184:187], v[188:191], v[84:87], v[184:187]
    ds_read_b64_tr_b16 v[116:117], v16 offset:12544
    ds_read_b64_tr_b16 v[118:119], v16 offset:14080
    v_mfma_f32_16x16x32_bf16 v[136:139], v[80:83], v[56:59], v[136:139]
    ds_read_b128 v[88:91], v15 offset:0
    ds_read_b128 v[92:95], v15 offset:2048
    v_mfma_f32_16x16x32_bf16 v[156:159], v[56:59], v[84:87], v[156:159]
    ds_read_b128 v[96:99], v15 offset:4096
    ds_read_b128 v[100:103], v15 offset:6144
    v_mfma_f32_16x16x32_bf16 v[120:123], v[76:79], v[60:63], v[120:123]
    ds_read_b128 v[104:107], v15 offset:8192
    v_add_u32 v31, v30, v15
    v_mfma_f32_16x16x32_bf16 v[140:143], v[80:83], v[60:63], v[140:143]
    ds_read_b128 v[200:203], v31
    v_mfma_f32_16x16x32_bf16 v[160:163], v[60:63], v[84:87], v[160:163]
    v_mfma_f32_16x16x32_bf16 v[124:127], v[76:79], v[64:67], v[124:127]
    v_mfma_f32_16x16x32_bf16 v[144:147], v[80:83], v[64:67], v[144:147]
    v_mfma_f32_16x16x32_bf16 v[164:167], v[64:67], v[84:87], v[164:167]
    v_mfma_f32_16x16x32_bf16 v[128:131], v[76:79], v[68:71], v[128:131]
    v_mfma_f32_16x16x32_bf16 v[148:151], v[80:83], v[68:71], v[148:151]
    v_mfma_f32_16x16x32_bf16 v[168:171], v[68:71], v[84:87], v[168:171]
    v_mfma_f32_16x16x32_bf16 v[132:135], v[76:79], v[72:75], v[132:135]
    v_mfma_f32_16x16x32_bf16 v[152:155], v[80:83], v[72:75], v[152:155]
    v_mfma_f32_16x16x32_bf16 v[172:175], v[72:75], v[84:87], v[172:175]
    v_mfma_f32_16x16x32_bf16 v[32:35], v[188:191], v[196:199], v[32:35]
    v_mfma_f32_16x16x32_bf16 v[36:39], v[196:199], v[196:199], v[36:39]
    v_mfma_f32_16x16x32_bf16 v[40:43], v[188:191], v[72:75], v[40:43]
    v_mfma_f32_16x16x32_bf16 v[44:47], v[72:75], v[72:75], v[44:47]
    s_waitcnt lgkmcnt(0)
    v_mfma_f32_16x16x32_bf16 v[176:179], v[108:111], v[188:191], v[176:179]
    ds_read_b64_tr_b16 v[76:77], v214 offset:0
    ds_read_b64_tr_b16 v[78:79], v214 offset:1536
    v_mfma_f32_16x16x32_bf16 v[180:183], v[112:115], v[188:191], v[180:183]
    ds_read_b64_tr_b16 v[80:81], v214 offset:128
    ds_read_b64_tr_b16 v[82:83], v214 offset:1664
    v_mfma_f32_16x16x32_bf16 v[184:187], v[188:191], v[116:119], v[184:187]
    ds_read_b64_tr_b16 v[84:85], v214 offset:256
    ds_read_b64_tr_b16 v[86:87], v214 offset:1792
    v_mfma_f32_16x16x32_bf16 v[136:139], v[112:115], v[88:91], v[136:139]
    ds_read_b128 v[56:59], v212 offset:0
    ds_read_b128 v[60:63], v212 offset:2048
    v_mfma_f32_16x16x32_bf16 v[156:159], v[88:91], v[116:119], v[156:159]
    ds_read_b128 v[64:67], v212 offset:4096
    ds_read_b128 v[68:71], v212 offset:6144
    v_mfma_f32_16x16x32_bf16 v[120:123], v[108:111], v[92:95], v[120:123]
    ds_read_b128 v[72:75], v212 offset:8192
    v_add_u32 v31, v30, v212
    v_mfma_f32_16x16x32_bf16 v[140:143], v[112:115], v[92:95], v[140:143]
    ds_read_b128 v[196:199], v31
    v_mfma_f32_16x16x32_bf16 v[160:163], v[92:95], v[116:119], v[160:163]
    v_mfma_f32_16x16x32_bf16 v[124:127], v[108:111], v[96:99], v[124:127]
    v_mfma_f32_16x16x32_bf16 v[144:147], v[112:115], v[96:99], v[144:147]
    v_mfma_f32_16x16x32_bf16 v[164:167], v[96:99], v[116:119], v[164:167]
    v_mfma_f32_16x16x32_bf16 v[128:131], v[108:111], v[100:103], v[128:131]
    v_mfma_f32_16x16x32_bf16 v[148:151], v[112:115], v[100:103], v[148:151]
    v_mfma_f32_16x16x32_bf16 v[168:171], v[100:103], v[116:119], v[168:171]
    v_mfma_f32_16x16x32_bf16 v[132:135], v[108:111], v[104:107], v[132:135]
    v_mfma_f32_16x16x32_bf16 v[152:155], v[112:115], v[104:107], v[152:155]
    v_mfma_f32_16x16x32_bf16 v[172:175], v[104:107], v[116:119], v[172:175]
    v_mfma_f32_16x16x32_bf16 v[32:35], v[188:191], v[200:203], v[32:35]
    v_mfma_f32_16x16x32_bf16 v[36:39], v[200:203], v[200:203], v[36:39]
    v_mfma_f32_16x16x32_bf16 v[40:43], v[188:191], v[104:107], v[40:43]
    v_mfma_f32_16x16x32_bf16 v[44:47], v[104:107], v[104:107], v[44:47]
    s_barrier
    s_waitcnt lgkmcnt(0)
    v_mfma_f32_16x16x32_bf16 v[176:179], v[76:79], v[188:191], v[176:179]
    ds_read_b64_tr_b16 v[108:109], v214 offset:12288
    ds_read_b64_tr_b16 v[110:111], v214 offset:13824
    v_mfma_f32_16x16x32_bf16 v[180:183], v[80:83], v[188:191], v[180:183]
    ds_read_b64_tr_b16 v[112:113], v214 offset:12416
    ds_read_b64_tr_b16 v[114:115], v214 offset:13952
    v_mfma_f32_16x16x32_bf16 v[184:187], v[188:191], v[84:87], v[184:187]
    ds_read_b64_tr_b16 v[116:117], v214 offset:12544
    ds_read_b64_tr_b16 v[118:119], v214 offset:14080
    v_mfma_f32_16x16x32_bf16 v[136:139], v[80:83], v[56:59], v[136:139]
    ds_read_b128 v[88:91], v213 offset:0
    ds_read_b128 v[92:95], v213 offset:2048
    v_mfma_f32_16x16x32_bf16 v[156:159], v[56:59], v[84:87], v[156:159]
    ds_read_b128 v[96:99], v213 offset:4096
    ds_read_b128 v[100:103], v213 offset:6144
    v_mfma_f32_16x16x32_bf16 v[120:123], v[76:79], v[60:63], v[120:123]
    ds_read_b128 v[104:107], v213 offset:8192
    v_add_u32 v31, v30, v213
    v_mfma_f32_16x16x32_bf16 v[140:143], v[80:83], v[60:63], v[140:143]
    ds_read_b128 v[200:203], v31
    v_mfma_f32_16x16x32_bf16 v[160:163], v[60:63], v[84:87], v[160:163]
    v_mfma_f32_16x16x32_bf16 v[124:127], v[76:79], v[64:67], v[124:127]
    v_mfma_f32_16x16x32_bf16 v[144:147], v[80:83], v[64:67], v[144:147]
    v_mfma_f32_16x16x32_bf16 v[164:167], v[64:67], v[84:87], v[164:167]
    v_mfma_f32_16x16x32_bf16 v[128:131], v[76:79], v[68:71], v[128:131]
    v_mfma_f32_16x16x32_bf16 v[148:151], v[80:83], v[68:71], v[148:151]
    v_mfma_f32_16x16x32_bf16 v[168:171], v[68:71], v[84:87], v[168:171]
    v_mfma_f32_16x16x32_bf16 v[132:135], v[76:79], v[72:75], v[132:135]
    v_mfma_f32_16x16x32_bf16 v[152:155], v[80:83], v[72:75], v[152:155]
    v_mfma_f32_16x16x32_bf16 v[172:175], v[72:75], v[84:87], v[172:175]
    v_mfma_f32_16x16x32_bf16 v[32:35], v[188:191], v[196:199], v[32:35]
    v_mfma_f32_16x16x32_bf16 v[36:39], v[196:199], v[196:199], v[36:39]
    v_mfma_f32_16x16x32_bf16 v[40:43], v[188:191], v[72:75], v[40:43]
    v_mfma_f32_16x16x32_bf16 v[44:47], v[72:75], v[72:75], v[44:47]
    s_waitcnt lgkmcnt(0)
    v_mfma_f32_16x16x32_bf16 v[176:179], v[108:111], v[188:191], v[176:179]
    ds_read_b64_tr_b16 v[76:77], v219 offset:0
    ds_read_b64_tr_b16 v[78:79], v219 offset:1536
    v_mfma_f32_16x16x32_bf16 v[180:183], v[112:115], v[188:191], v[180:183]
    ds_read_b64_tr_b16 v[80:81], v219 offset:128
    ds_read_b64_tr_b16 v[82:83], v219 offset:1664
    v_mfma_f32_16x16x32_bf16 v[184:187], v[188:191], v[116:119], v[184:187]
    ds_read_b64_tr_b16 v[84:85], v219 offset:256
    ds_read_b64_tr_b16 v[86:87], v219 offset:1792
    v_mfma_f32_16x16x32_bf16 v[136:139], v[112:115], v[88:91], v[136:139]
    ds_read_b128 v[56:59], v217 offset:0
    ds_read_b128 v[60:63], v217 offset:2048
    v_mfma_f32_16x16x32_bf16 v[156:159], v[88:91], v[116:119], v[156:159]
    ds_read_b128 v[64:67], v217 offset:4096
    ds_read_b128 v[68:71], v217 offset:6144
    v_mfma_f32_16x16x32_bf16 v[120:123], v[108:111], v[92:95], v[120:123]
    ds_read_b128 v[72:75], v217 offset:8192
    v_add_u32 v31, v30, v217
    v_mfma_f32_16x16x32_bf16 v[140:143], v[112:115], v[92:95], v[140:143]
    ds_read_b128 v[196:199], v31
    v_mfma_f32_16x16x32_bf16 v[160:163], v[92:95], v[116:119], v[160:163]
    v_mfma_f32_16x16x32_bf16 v[124:127], v[108:111], v[96:99], v[124:127]
    v_mfma_f32_16x16x32_bf16 v[144:147], v[112:115], v[96:99], v[144:147]
    v_mfma_f32_16x16x32_bf16 v[164:167], v[96:99], v[116:119], v[164:167]
    v_mfma_f32_16x16x32_bf16 v[128:131], v[108:111], v[100:103], v[128:131]
    v_mfma_f32_16x16x32_bf16 v[148:151], v[112:115], v[100:103], v[148:151]
    v_mfma_f32_16x16x32_bf16 v[168:171], v[100:103], v[116:119], v[168:171]
    v_mfma_f32_16x16x32_bf16 v[132:135], v[108:111], v[104:107], v[132:135]
    v_mfma_f32_16x16x32_bf16 v[152:155], v[112:115], v[104:107], v[152:155]
    v_mfma_f32_16x16x32_bf16 v[172:175], v[104:107], v[116:119], v[172:175]
    v_mfma_f32_16x16x32_bf16 v[32:35], v[188:191], v[200:203], v[32:35]
    v_mfma_f32_16x16x32_bf16 v[36:39], v[200:203], v[200:203], v[36:39]
    v_mfma_f32_16x16x32_bf16 v[40:43], v[188:191], v[104:107], v[40:43]
    v_mfma_f32_16x16x32_bf16 v[44:47], v[104:107], v[104:107], v[44:47]
    s_barrier
    s_waitcnt lgkmcnt(0)
    v_mfma_f32_16x16x32_bf16 v[176:179], v[76:79], v[188:191], v[176:179]
    ds_read_b64_tr_b16 v[108:109], v219 offset:12288
    ds_read_b64_tr_b16 v[110:111], v219 offset:13824
    v_mfma_f32_16x16x32_bf16 v[180:183], v[80:83], v[188:191], v[180:183]
    ds_read_b64_tr_b16 v[112:113], v219 offset:12416
    ds_read_b64_tr_b16 v[114:115], v219 offset:13952
    v_mfma_f32_16x16x32_bf16 v[184:187], v[188:191], v[84:87], v[184:187]
    ds_read_b64_tr_b16 v[116:117], v219 offset:12544
    ds_read_b64_tr_b16 v[118:119], v219 offset:14080
    v_mfma_f32_16x16x32_bf16 v[136:139], v[80:83], v[56:59], v[136:139]
    ds_read_b128 v[88:91], v218 offset:0
    ds_read_b128 v[92:95], v218 offset:2048
    v_mfma_f32_16x16x32_bf16 v[156:159], v[56:59], v[84:87], v[156:159]
    ds_read_b128 v[96:99], v218 offset:4096
    ds_read_b128 v[100:103], v218 offset:6144
    v_mfma_f32_16x16x32_bf16 v[120:123], v[76:79], v[60:63], v[120:123]
    ds_read_b128 v[104:107], v218 offset:8192
    v_add_u32 v31, v30, v218
    v_mfma_f32_16x16x32_bf16 v[140:143], v[80:83], v[60:63], v[140:143]
    ds_read_b128 v[200:203], v31
    v_mfma_f32_16x16x32_bf16 v[160:163], v[60:63], v[84:87], v[160:163]
    v_mfma_f32_16x16x32_bf16 v[124:127], v[76:79], v[64:67], v[124:127]
    v_mfma_f32_16x16x32_bf16 v[144:147], v[80:83], v[64:67], v[144:147]
    v_mfma_f32_16x16x32_bf16 v[164:167], v[64:67], v[84:87], v[164:167]
    v_mfma_f32_16x16x32_bf16 v[128:131], v[76:79], v[68:71], v[128:131]
    v_mfma_f32_16x16x32_bf16 v[148:151], v[80:83], v[68:71], v[148:151]
    v_mfma_f32_16x16x32_bf16 v[168:171], v[68:71], v[84:87], v[168:171]
    v_mfma_f32_16x16x32_bf16 v[132:135], v[76:79], v[72:75], v[132:135]
    v_mfma_f32_16x16x32_bf16 v[152:155], v[80:83], v[72:75], v[152:155]
    v_mfma_f32_16x16x32_bf16 v[172:175], v[72:75], v[84:87], v[172:175]
    v_mfma_f32_16x16x32_bf16 v[32:35], v[188:191], v[196:199], v[32:35]
    v_mfma_f32_16x16x32_bf16 v[36:39], v[196:199], v[196:199], v[36:39]
    v_mfma_f32_16x16x32_bf16 v[40:43], v[188:191], v[72:75], v[40:43]
    v_mfma_f32_16x16x32_bf16 v[44:47], v[72:75], v[72:75], v[44:47]
    s_waitcnt lgkmcnt(0)
    v_mfma_f32_16x16x32_bf16 v[176:179], v[108:111], v[188:191], v[176:179]
    ds_read_b64_tr_b16 v[76:77], v224 offset:0
    ds_read_b64_tr_b16 v[78:79], v224 offset:1536
    v_mfma_f32_16x16x32_bf16 v[180:183], v[112:115], v[188:191], v[180:183]
    ds_read_b64_tr_b16 v[80:81], v224 offset:128
    ds_read_b64_tr_b16 v[82:83], v224 offset:1664
    v_mfma_f32_16x16x32_bf16 v[184:187], v[188:191], v[116:119], v[184:187]
    ds_read_b64_tr_b16 v[84:85], v224 offset:256
    ds_read_b64_tr_b16 v[86:87], v224 offset:1792
    v_mfma_f32_16x16x32_bf16 v[136:139], v[112:115], v[88:91], v[136:139]
    ds_read_b128 v[56:59], v222 offset:0
    ds_read_b128 v[60:63], v222 offset:2048
    v_mfma_f32_16x16x32_bf16 v[156:159], v[88:91], v[116:119], v[156:159]
    ds_read_b128 v[64:67], v222 offset:4096
    ds_read_b128 v[68:71], v222 offset:6144
    v_mfma_f32_16x16x32_bf16 v[120:123], v[108:111], v[92:95], v[120:123]
    ds_read_b128 v[72:75], v222 offset:8192
    v_add_u32 v31, v30, v222
    v_mfma_f32_16x16x32_bf16 v[140:143], v[112:115], v[92:95], v[140:143]
    ds_read_b128 v[196:199], v31
    v_mfma_f32_16x16x32_bf16 v[160:163], v[92:95], v[116:119], v[160:163]
    v_mfma_f32_16x16x32_bf16 v[124:127], v[108:111], v[96:99], v[124:127]
    v_mfma_f32_16x16x32_bf16 v[144:147], v[112:115], v[96:99], v[144:147]
    v_mfma_f32_16x16x32_bf16 v[164:167], v[96:99], v[116:119], v[164:167]
    v_mfma_f32_16x16x32_bf16 v[128:131], v[108:111], v[100:103], v[128:131]
    v_mfma_f32_16x16x32_bf16 v[148:151], v[112:115], v[100:103], v[148:151]
    v_mfma_f32_16x16x32_bf16 v[168:171], v[100:103], v[116:119], v[168:171]
    v_mfma_f32_16x16x32_bf16 v[132:135], v[108:111], v[104:107], v[132:135]
    v_mfma_f32_16x16x32_bf16 v[152:155], v[112:115], v[104:107], v[152:155]
    v_mfma_f32_16x16x32_bf16 v[172:175], v[104:107], v[116:119], v[172:175]
    v_mfma_f32_16x16x32_bf16 v[32:35], v[188:191], v[200:203], v[32:35]
    v_mfma_f32_16x16x32_bf16 v[36:39], v[200:203], v[200:203], v[36:39]
    v_mfma_f32_16x16x32_bf16 v[40:43], v[188:191], v[104:107], v[40:43]
    v_mfma_f32_16x16x32_bf16 v[44:47], v[104:107], v[104:107], v[44:47]
    s_barrier
    s_waitcnt lgkmcnt(0)
    v_mfma_f32_16x16x32_bf16 v[176:179], v[76:79], v[188:191], v[176:179]
    ds_read_b64_tr_b16 v[108:109], v224 offset:12288
    ds_read_b64_tr_b16 v[110:111], v224 offset:13824
    v_mfma_f32_16x16x32_bf16 v[180:183], v[80:83], v[188:191], v[180:183]
    ds_read_b64_tr_b16 v[112:113], v224 offset:12416
    ds_read_b64_tr_b16 v[114:115], v224 offset:13952
    v_mfma_f32_16x16x32_bf16 v[184:187], v[188:191], v[84:87], v[184:187]
    ds_read_b64_tr_b16 v[116:117], v224 offset:12544
    ds_read_b64_tr_b16 v[118:119], v224 offset:14080
    v_mfma_f32_16x16x32_bf16 v[136:139], v[80:83], v[56:59], v[136:139]
    ds_read_b128 v[88:91], v223 offset:0
    ds_read_b128 v[92:95], v223 offset:2048
    v_mfma_f32_16x16x32_bf16 v[156:159], v[56:59], v[84:87], v[156:159]
    ds_read_b128 v[96:99], v223 offset:4096
    ds_read_b128 v[100:103], v223 offset:6144
    v_mfma_f32_16x16x32_bf16 v[120:123], v[76:79], v[60:63], v[120:123]
    ds_read_b128 v[104:107], v223 offset:8192
    v_add_u32 v31, v30, v223
    v_mfma_f32_16x16x32_bf16 v[140:143], v[80:83], v[60:63], v[140:143]
    ds_read_b128 v[200:203], v31
    v_mfma_f32_16x16x32_bf16 v[160:163], v[60:63], v[84:87], v[160:163]
    v_mfma_f32_16x16x32_bf16 v[124:127], v[76:79], v[64:67], v[124:127]
    v_mfma_f32_16x16x32_bf16 v[144:147], v[80:83], v[64:67], v[144:147]
    v_mfma_f32_16x16x32_bf16 v[164:167], v[64:67], v[84:87], v[164:167]
    v_mfma_f32_16x16x32_bf16 v[128:131], v[76:79], v[68:71], v[128:131]
    v_mfma_f32_16x16x32_bf16 v[148:151], v[80:83], v[68:71], v[148:151]
    v_mfma_f32_16x16x32_bf16 v[168:171], v[68:71], v[84:87], v[168:171]
    v_mfma_f32_16x16x32_bf16 v[132:135], v[76:79], v[72:75], v[132:135]
    v_mfma_f32_16x16x32_bf16 v[152:155], v[80:83], v[72:75], v[152:155]
    v_mfma_f32_16x16x32_bf16 v[172:175], v[72:75], v[84:87], v[172:175]
    v_mfma_f32_16x16x32_bf16 v[32:35], v[188:191], v[196:199], v[32:35]
    v_mfma_f32_16x16x32_bf16 v[36:39], v[196:199], v[196:199], v[36:39]
    v_mfma_f32_16x16x32_bf16 v[40:43], v[188:191], v[72:75], v[40:43]
    v_mfma_f32_16x16x32_bf16 v[44:47], v[72:75], v[72:75], v[44:47]
    s_waitcnt lgkmcnt(0)
    v_mfma_f32_16x16x32_bf16 v[176:179], v[108:111], v[188:191], v[176:179]
    v_mfma_f32_16x16x32_bf16 v[180:183], v[112:115], v[188:191], v[180:183]
    v_mfma_f32_16x16x32_bf16 v[184:187], v[188:191], v[116:119], v[184:187]
    v_mfma_f32_16x16x32_bf16 v[136:139], v[112:115], v[88:91], v[136:139]
    v_mfma_f32_16x16x32_bf16 v[156:159], v[88:91], v[116:119], v[156:159]
    v_mfma_f32_16x16x32_bf16 v[120:123], v[108:111], v[92:95], v[120:123]
    v_mfma_f32_16x16x32_bf16 v[140:143], v[112:115], v[92:95], v[140:143]
    v_mfma_f32_16x16x32_bf16 v[160:163], v[92:95], v[116:119], v[160:163]
    v_mfma_f32_16x16x32_bf16 v[124:127], v[108:111], v[96:99], v[124:127]
    v_mfma_f32_16x16x32_bf16 v[144:147], v[112:115], v[96:99], v[144:147]
    v_mfma_f32_16x16x32_bf16 v[164:167], v[96:99], v[116:119], v[164:167]
    v_mfma_f32_16x16x32_bf16 v[128:131], v[108:111], v[100:103], v[128:131]
    v_mfma_f32_16x16x32_bf16 v[148:151], v[112:115], v[100:103], v[148:151]
    v_mfma_f32_16x16x32_bf16 v[168:171], v[100:103], v[116:119], v[168:171]
    v_mfma_f32_16x16x32_bf16 v[132:135], v[108:111], v[104:107], v[132:135]
    v_mfma_f32_16x16x32_bf16 v[152:155], v[112:115], v[104:107], v[152:155]
    v_mfma_f32_16x16x32_bf16 v[172:175], v[104:107], v[116:119], v[172:175]
    v_mfma_f32_16x16x32_bf16 v[32:35], v[188:191], v[200:203], v[32:35]
    v_mfma_f32_16x16x32_bf16 v[36:39], v[200:203], v[200:203], v[36:39]
    v_mfma_f32_16x16x32_bf16 v[40:43], v[188:191], v[104:107], v[40:43]
    v_mfma_f32_16x16x32_bf16 v[44:47], v[104:107], v[104:107], v[44:47]
    s_nop 7
    v_lshrrev_b32 v5, 2, v3
    v_and_b32 v6, 3, v3
    v_cmp_eq_u32 s[60:61], v5, v4
    v_cmp_eq_u32 s[62:63], 1, v6
    v_cmp_eq_u32 s[64:65], 2, v6
    v_cmp_eq_u32 s[66:67], 3, v6
    s_nop 1
    v_cndmask_b32 v36, v36, v37, s[62:63]
    v_cndmask_b32 v36, v36, v38, s[64:65]
    v_cndmask_b32 v36, v36, v39, s[66:67]
    v_cndmask_b32 v36, 0, v36, s[60:61]
    v_mov_b32 v208, v36
    s_nop 1
    v_permlane16_swap_b32 v36, v208
    s_nop 0
    v_add_f32 v36, v36, v208
    v_mov_b32 v208, v36
    s_nop 1
    v_permlane32_swap_b32 v36, v208
    s_nop 0
    v_add_f32 v36, v36, v208
    v_mul_f32 v32, 0x3b000000, v32
    v_mul_f32 v36, 0x3b000000, v36
    v_fma_f32 v36, -v32, v32, v36
    v_max_f32 v36, 0, v36
    v_cvt_pk_bf16_f32 v208, v32, v32
    v_lshlrev_b32 v32, 16, v208
    v_cvt_pk_bf16_f32 v208, v36, v36
    v_lshlrev_b32 v36, 16, v208
    v_add_f32 v36, 0x3727c5ac, v36
    v_cvt_pk_bf16_f32 v208, v36, v36
    v_lshlrev_b32 v36, 16, v208
    v_sqrt_f32 v36, v36
    s_nop 0
    v_cvt_pk_bf16_f32 v208, v36, v36
    v_lshlrev_b32 v36, 16, v208
    v_rcp_f32 v52, v36
    s_nop 0
    v_mov_b32 v53, v52
    v_mul_f32 v54, v32, v52
    v_sub_f32 v54, 0, v54
    v_mov_b32 v55, v54
    v_mov_b32 v53, v54
    v_lshl_add_u32 v5, v2, 4, v3
    v_lshlrev_b32 v5, 3, v5
    v_add_u32 v5, 139264, v5
    ds_write_b64 v5, v[52:53]
    v_cndmask_b32 v44, v44, v45, s[62:63]
    v_cndmask_b32 v44, v44, v46, s[64:65]
    v_cndmask_b32 v44, v44, v47, s[66:67]
    v_cndmask_b32 v44, 0, v44, s[60:61]
    v_mov_b32 v208, v44
    s_nop 1
    v_permlane16_swap_b32 v44, v208
    s_nop 0
    v_add_f32 v44, v44, v208
    v_mov_b32 v208, v44
    s_nop 1
    v_permlane32_swap_b32 v44, v208
    s_nop 0
    v_add_f32 v44, v44, v208
    v_mul_f32 v40, 0x3b000000, v40
    v_mul_f32 v44, 0x3b000000, v44
    v_fma_f32 v44, -v40, v40, v44
    v_max_f32 v44, 0, v44
    v_cvt_pk_bf16_f32 v208, v40, v40
    v_lshlrev_b32 v40, 16, v208
    v_cvt_pk_bf16_f32 v208, v44, v44
    v_lshlrev_b32 v44, 16, v208
    v_add_f32 v44, 0x3727c5ac, v44
    v_cvt_pk_bf16_f32 v208, v44, v44
    v_lshlrev_b32 v44, 16, v208
    v_sqrt_f32 v44, v44
    s_nop 0
    v_cvt_pk_bf16_f32 v208, v44, v44
    v_lshlrev_b32 v44, 16, v208
    v_rcp_f32 v52, v44
    s_nop 0
    v_mov_b32 v53, v52
    v_mul_f32 v54, v40, v52
    v_sub_f32 v54, 0, v54
    v_mov_b32 v55, v54
    v_mov_b32 v53, v54
    v_add_u32 v5, 64, v3
    v_lshlrev_b32 v5, 3, v5
    v_add_u32 v5, 139264, v5
    ds_write_b64 v5, v[52:53]
    s_waitcnt lgkmcnt(0)
    s_barrier
    v_lshlrev_b32 v5, 3, v3
    v_lshlrev_b32 v6, 5, v4
    v_add_u32 v5, 139264, v5
    v_add_u32 v6, 139264, v6
    ds_read_b64 v[56:57], v5 offset:0
    ds_read_b64 v[58:59], v5 offset:128
    ds_read_b64 v[60:61], v5 offset:256
    ds_read_b64 v[62:63], v5 offset:384
    ds_read_b64 v[64:65], v5 offset:512
    ds_read_b128 v[68:71], v6 offset:0
    ds_read_b128 v[72:75], v6 offset:16
    ds_read_b128 v[76:79], v6 offset:128
    ds_read_b128 v[80:83], v6 offset:144
    ds_read_b128 v[84:87], v6 offset:256
    ds_read_b128 v[88:91], v6 offset:272
    ds_read_b128 v[92:95], v6 offset:384
    ds_read_b128 v[96:99], v6 offset:400
    ds_read_b128 v[100:103], v6 offset:512
    ds_read_b128 v[104:107], v6 offset:528
    s_waitcnt lgkmcnt(0)
    s_nop 5
    v_mul_f32 v136, v136, v56
    v_fmac_f32 v136, v180, v57
    v_mul_f32 v156, v156, v68
    v_fmac_f32 v156, v184, v69
    v_mul_f32 v137, v137, v56
    v_fmac_f32 v137, v181, v57
    v_mul_f32 v157, v157, v70
    v_fmac_f32 v157, v184, v71
    v_mul_f32 v138, v138, v56
    v_fmac_f32 v138, v182, v57
    v_mul_f32 v158, v158, v72
    v_fmac_f32 v158, v184, v73
    v_mul_f32 v139, v139, v56
    v_fmac_f32 v139, v183, v57
    v_mul_f32 v159, v159, v74
    v_fmac_f32 v159, v184, v75
    v_mul_f32 v120, v120, v58
    v_fmac_f32 v120, v176, v59
    v_mul_f32 v140, v140, v58
    v_fmac_f32 v140, v180, v59
    v_mul_f32 v160, v160, v76
    v_fmac_f32 v160, v184, v77
    v_mul_f32 v121, v121, v58
    v_fmac_f32 v121, v177, v59
    v_mul_f32 v141, v141, v58
    v_fmac_f32 v141, v181, v59
    v_mul_f32 v161, v161, v78
    v_fmac_f32 v161, v184, v79
    v_mul_f32 v122, v122, v58
    v_fmac_f32 v122, v178, v59
    v_mul_f32 v142, v142, v58
    v_fmac_f32 v142, v182, v59
    v_mul_f32 v162, v162, v80
    v_fmac_f32 v162, v184, v81
    v_mul_f32 v123, v123, v58
    v_fmac_f32 v123, v179, v59
    v_mul_f32 v143, v143, v58
    v_fmac_f32 v143, v183, v59
    v_mul_f32 v163, v163, v82
    v_fmac_f32 v163, v184, v83
    v_mul_f32 v124, v124, v60
    v_fmac_f32 v124, v176, v61
    v_mul_f32 v144, v144, v60
    v_fmac_f32 v144, v180, v61
    v_mul_f32 v164, v164, v84
    v_fmac_f32 v164, v184, v85
    v_mul_f32 v125, v125, v60
    v_fmac_f32 v125, v177, v61
    v_mul_f32 v145, v145, v60
    v_fmac_f32 v145, v181, v61
    v_mul_f32 v165, v165, v86
    v_fmac_f32 v165, v184, v87
    v_mul_f32 v126, v126, v60
    v_fmac_f32 v126, v178, v61
    v_mul_f32 v146, v146, v60
    v_fmac_f32 v146, v182, v61
    v_mul_f32 v166, v166, v88
    v_fmac_f32 v166, v184, v89
    v_mul_f32 v127, v127, v60
    v_fmac_f32 v127, v179, v61
    v_mul_f32 v147, v147, v60
    v_fmac_f32 v147, v183, v61
    v_mul_f32 v167, v167, v90
    v_fmac_f32 v167, v184, v91
    v_mul_f32 v128, v128, v62
    v_fmac_f32 v128, v176, v63
    v_mul_f32 v148, v148, v62
    v_fmac_f32 v148, v180, v63
    v_mul_f32 v168, v168, v92
    v_fmac_f32 v168, v184, v93
    v_mul_f32 v129, v129, v62
    v_fmac_f32 v129, v177, v63
    v_mul_f32 v149, v149, v62
    v_fmac_f32 v149, v181, v63
    v_mul_f32 v169, v169, v94
    v_fmac_f32 v169, v184, v95
    v_mul_f32 v130, v130, v62
    v_fmac_f32 v130, v178, v63
    v_mul_f32 v150, v150, v62
    v_fmac_f32 v150, v182, v63
    v_mul_f32 v170, v170, v96
    v_fmac_f32 v170, v184, v97
    v_mul_f32 v131, v131, v62
    v_fmac_f32 v131, v179, v63
    v_mul_f32 v151, v151, v62
    v_fmac_f32 v151, v183, v63
    v_mul_f32 v171, v171, v98
    v_fmac_f32 v171, v184, v99
    v_mul_f32 v132, v132, v64
    v_fmac_f32 v132, v176, v65
    v_mul_f32 v152, v152, v64
    v_fmac_f32 v152, v180, v65
    v_mul_f32 v172, v172, v100
    v_fmac_f32 v172, v184, v101
    v_mul_f32 v133, v133, v64
    v_fmac_f32 v133, v177, v65
    v_mul_f32 v153, v153, v64
    v_fmac_f32 v153, v181, v65
    v_mul_f32 v173, v173, v102
    v_fmac_f32 v173, v184, v103
    v_mul_f32 v134, v134, v64
    v_fmac_f32 v134, v178, v65
    v_mul_f32 v154, v154, v64
    v_fmac_f32 v154, v182, v65
    v_mul_f32 v174, v174, v104
    v_fmac_f32 v174, v184, v105
    v_mul_f32 v135, v135, v64
    v_fmac_f32 v135, v179, v65
    v_mul_f32 v155, v155, v64
    v_fmac_f32 v155, v183, v65
    v_mul_f32 v175, v175, v106
    v_fmac_f32 v175, v184, v107
    v_cvt_pk_bf16_f32 v56, v120, v121
    v_cvt_pk_bf16_f32 v57, v122, v123
    v_cvt_pk_bf16_f32 v58, v124, v125
    v_cvt_pk_bf16_f32 v59, v126, v127
    v_cvt_pk_bf16_f32 v60, v128, v129
    v_cvt_pk_bf16_f32 v61, v130, v131
    v_cvt_pk_bf16_f32 v62, v132, v133
    v_cvt_pk_bf16_f32 v63, v134, v135
    v_cvt_pk_bf16_f32 v64, v136, v137
    v_cvt_pk_bf16_f32 v74, v156, v157
    v_cvt_pk_bf16_f32 v65, v138, v139
    v_cvt_pk_bf16_f32 v75, v158, v159
    v_cvt_pk_bf16_f32 v66, v140, v141
    v_cvt_pk_bf16_f32 v76, v160, v161
    v_cvt_pk_bf16_f32 v67, v142, v143
    v_cvt_pk_bf16_f32 v77, v162, v163
    v_cvt_pk_bf16_f32 v68, v144, v145
    v_cvt_pk_bf16_f32 v78, v164, v165
    v_cvt_pk_bf16_f32 v69, v146, v147
    v_cvt_pk_bf16_f32 v79, v166, v167
    v_cvt_pk_bf16_f32 v70, v148, v149
    v_cvt_pk_bf16_f32 v80, v168, v169
    v_cvt_pk_bf16_f32 v71, v150, v151
    v_cvt_pk_bf16_f32 v81, v170, v171
    v_cvt_pk_bf16_f32 v72, v152, v153
    v_cvt_pk_bf16_f32 v82, v172, v173
    v_cvt_pk_bf16_f32 v73, v154, v155
    v_cvt_pk_bf16_f32 v83, v174, v175
    s_nop 1
    v_mfma_f32_16x16x16_bf16 v[120:123], v[64:65], v[56:57], 0
    v_mfma_f32_16x16x16_bf16 v[124:127], v[66:67], v[56:57], 0
    v_mfma_f32_16x16x16_bf16 v[128:131], v[66:67], v[58:59], 0
    v_mfma_f32_16x16x16_bf16 v[132:135], v[68:69], v[58:59], 0
    v_mfma_f32_16x16x16_bf16 v[136:139], v[68:69], v[60:61], 0
    v_mfma_f32_16x16x16_bf16 v[140:143], v[70:71], v[60:61], 0
    v_mfma_f32_16x16x16_bf16 v[144:147], v[70:71], v[62:63], 0
    v_mfma_f32_16x16x16_bf16 v[148:151], v[72:73], v[62:63], 0
    v_mov_b32 v7, 0xce6e6b28
    v_lshlrev_b32 v5, 2, v4
    v_sub_u32 v5, v3, v5
    v_add_u32 v6, 16, v5
    v_and_b32 v8, 0xfffffff1, v6
    v_cmp_eq_u32 vcc, 0, v8
    s_nop 1
    v_cndmask_b32 v20, v7, 0, vcc
    v_add_u32 v6, 15, v5
    v_and_b32 v8, 0xfffffff1, v6
    v_cmp_eq_u32 vcc, 0, v8
    s_nop 1
    v_cndmask_b32 v21, v7, 0, vcc
    v_add_u32 v6, 14, v5
    v_and_b32 v8, 0xfffffff1, v6
    v_cmp_eq_u32 vcc, 0, v8
    s_nop 1
    v_cndmask_b32 v22, v7, 0, vcc
    v_add_u32 v6, 13, v5
    v_and_b32 v8, 0xfffffff1, v6
    v_cmp_eq_u32 vcc, 0, v8
    s_nop 1
    v_cndmask_b32 v23, v7, 0, vcc
    v_add_u32 v6, 0, v5
    v_and_b32 v8, 0xfffffff1, v6
    v_cmp_eq_u32 vcc, 0, v8
    s_nop 1
    v_cndmask_b32 v24, v7, 0, vcc
    v_add_u32 v6, 4294967295, v5
    v_and_b32 v8, 0xfffffff1, v6
    v_cmp_eq_u32 vcc, 0, v8
    s_nop 1
    v_cndmask_b32 v25, v7, 0, vcc
    v_add_u32 v6, 4294967294, v5
    v_and_b32 v8, 0xfffffff1, v6
    v_cmp_eq_u32 vcc, 0, v8
    s_nop 1
    v_cndmask_b32 v26, v7, 0, vcc
    v_add_u32 v6, 4294967293, v5
    v_and_b32 v8, 0xfffffff1, v6
    v_cmp_eq_u32 vcc, 0, v8
    s_nop 1
    v_cndmask_b32 v27, v7, 0, vcc
    s_cmp_eq_u32 s4, 0
    s_cselect_b32 s12, 0xce6e6b28, 0
    s_lshl_b32 s13, s5, 2
    s_add_u32 s13, s13, s3
    s_lshl_b32 s13, s13, 5
    v_add_u32 v5, s6, v3
    v_lshlrev_b32 v5, 10, v5
    v_lshl_add_u32 v5, v4, 3, v5
    v_add_u32 v28, s13, v5
    s_mov_b32 s14, 0x3eb8aa3b
    v_cvt_pk_bf16_f32 v96, v120, v121
    v_cvt_pk_bf16_f32 v97, v128, v129
    v_cvt_pk_bf16_f32 v98, v136, v137
    v_cvt_pk_bf16_f32 v99, v144, v145
    v_lshlrev_b32 v120, 16, v96
    v_and_b32 v121, 0xffff0000, v96
    v_lshlrev_b32 v128, 16, v97
    v_and_b32 v129, 0xffff0000, v97
    v_lshlrev_b32 v136, 16, v98
    v_and_b32 v137, 0xffff0000, v98
    v_lshlrev_b32 v144, 16, v99
    v_and_b32 v145, 0xffff0000, v99
    v_cvt_pk_bf16_f32 v96, v122, v123
    v_cvt_pk_bf16_f32 v97, v130, v131
    v_cvt_pk_bf16_f32 v98, v138, v139
    v_cvt_pk_bf16_f32 v99, v146, v147
    v_lshlrev_b32 v122, 16, v96
    v_and_b32 v123, 0xffff0000, v96
    v_lshlrev_b32 v130, 16, v97
    v_and_b32 v131, 0xffff0000, v97
    v_lshlrev_b32 v138, 16, v98
    v_and_b32 v139, 0xffff0000, v98
    v_lshlrev_b32 v146, 16, v99
    v_and_b32 v147, 0xffff0000, v99
    v_cvt_pk_bf16_f32 v96, v124, v125
    v_cvt_pk_bf16_f32 v97, v132, v133
    v_cvt_pk_bf16_f32 v98, v140, v141
    v_cvt_pk_bf16_f32 v99, v148, v149
    v_lshlrev_b32 v124, 16, v96
    v_and_b32 v125, 0xffff0000, v96
    v_lshlrev_b32 v132, 16, v97
    v_and_b32 v133, 0xffff0000, v97
    v_lshlrev_b32 v140, 16, v98
    v_and_b32 v141, 0xffff0000, v98
    v_lshlrev_b32 v148, 16, v99
    v_and_b32 v149, 0xffff0000, v99
    v_cvt_pk_bf16_f32 v96, v126, v127
    v_cvt_pk_bf16_f32 v97, v134, v135
    v_cvt_pk_bf16_f32 v98, v142, v143
    v_cvt_pk_bf16_f32 v99, v150, v151
    v_lshlrev_b32 v126, 16, v96
    v_and_b32 v127, 0xffff0000, v96
    v_lshlrev_b32 v134, 16, v97
    v_and_b32 v135, 0xffff0000, v97
    v_lshlrev_b32 v142, 16, v98
    v_and_b32 v143, 0xffff0000, v98
    v_lshlrev_b32 v150, 16, v99
    v_and_b32 v151, 0xffff0000, v99
    v_fma_f32 v120, v120, s14, v20
    v_fma_f32 v128, v128, s14, v20
    v_fma_f32 v136, v136, s14, v20
    v_fma_f32 v144, v144, s14, v20
    v_fma_f32 v121, v121, s14, v21
    v_fma_f32 v129, v129, s14, v21
    v_fma_f32 v137, v137, s14, v21
    v_fma_f32 v145, v145, s14, v21
    v_fma_f32 v122, v122, s14, v22
    v_fma_f32 v130, v130, s14, v22
    v_fma_f32 v138, v138, s14, v22
    v_fma_f32 v146, v146, s14, v22
    v_fma_f32 v123, v123, s14, v23
    v_fma_f32 v131, v131, s14, v23
    v_fma_f32 v139, v139, s14, v23
    v_fma_f32 v147, v147, s14, v23
    v_fma_f32 v124, v124, s14, v24
    v_fma_f32 v132, v132, s14, v24
    v_fma_f32 v140, v140, s14, v24
    v_fma_f32 v148, v148, s14, v24
    v_fma_f32 v125, v125, s14, v25
    v_fma_f32 v133, v133, s14, v25
    v_fma_f32 v141, v141, s14, v25
    v_fma_f32 v149, v149, s14, v25
    v_fma_f32 v126, v126, s14, v26
    v_fma_f32 v134, v134, s14, v26
    v_fma_f32 v142, v142, s14, v26
    v_fma_f32 v150, v150, s14, v26
    v_fma_f32 v127, v127, s14, v27
    v_fma_f32 v135, v135, s14, v27
    v_fma_f32 v143, v143, s14, v27
    v_fma_f32 v151, v151, s14, v27
    v_add_f32 v120, s12, v120
    v_add_f32 v121, s12, v121
    v_add_f32 v122, s12, v122
    v_add_f32 v123, s12, v123
    v_max3_f32 v88, v120, v121, v122
    v_max3_f32 v89, v128, v129, v130
    v_max3_f32 v90, v136, v137, v138
    v_max3_f32 v91, v144, v145, v146
    v_max3_f32 v88, v88, v123, v124
    v_max3_f32 v89, v89, v131, v132
    v_max3_f32 v90, v90, v139, v140
    v_max3_f32 v91, v91, v147, v148
    v_max3_f32 v88, v88, v125, v126
    v_max3_f32 v89, v89, v133, v134
    v_max3_f32 v90, v90, v141, v142
    v_max3_f32 v91, v91, v149, v150
    v_max_f32 v88, v88, v127
    v_max_f32 v89, v89, v135
    v_max_f32 v90, v90, v143
    v_max_f32 v91, v91, v151
    v_mov_b32 v92, v88
    v_mov_b32 v93, v89
    v_mov_b32 v94, v90
    v_mov_b32 v95, v91
    s_nop 0
    v_permlane16_swap_b32 v88, v92
    v_permlane16_swap_b32 v89, v93
    v_permlane16_swap_b32 v90, v94
    v_permlane16_swap_b32 v91, v95
    s_nop 0
    v_max_f32 v88, v88, v92
    v_max_f32 v89, v89, v93
    v_max_f32 v90, v90, v94
    v_max_f32 v91, v91, v95
    v_mov_b32 v92, v88
    v_mov_b32 v93, v89
    v_mov_b32 v94, v90
    v_mov_b32 v95, v91
    s_nop 0
    v_permlane32_swap_b32 v88, v92
    v_permlane32_swap_b32 v89, v93
    v_permlane32_swap_b32 v90, v94
    v_permlane32_swap_b32 v91, v95
    s_nop 0
    v_max_f32 v88, v88, v92
    v_max_f32 v89, v89, v93
    v_max_f32 v90, v90, v94
    v_max_f32 v91, v91, v95
    v_sub_f32 v120, v120, v88
    v_sub_f32 v128, v128, v89
    v_sub_f32 v136, v136, v90
    v_sub_f32 v144, v144, v91
    v_sub_f32 v121, v121, v88
    v_sub_f32 v129, v129, v89
    v_sub_f32 v137, v137, v90
    v_sub_f32 v145, v145, v91
    v_sub_f32 v122, v122, v88
    v_sub_f32 v130, v130, v89
    v_sub_f32 v138, v138, v90
    v_sub_f32 v146, v146, v91
    v_sub_f32 v123, v123, v88
    v_sub_f32 v131, v131, v89
    v_sub_f32 v139, v139, v90
    v_sub_f32 v147, v147, v91
    v_sub_f32 v124, v124, v88
    v_sub_f32 v132, v132, v89
    v_sub_f32 v140, v140, v90
    v_sub_f32 v148, v148, v91
    v_sub_f32 v125, v125, v88
    v_sub_f32 v133, v133, v89
    v_sub_f32 v141, v141, v90
    v_sub_f32 v149, v149, v91
    v_sub_f32 v126, v126, v88
    v_sub_f32 v134, v134, v89
    v_sub_f32 v142, v142, v90
    v_sub_f32 v150, v150, v91
    v_sub_f32 v127, v127, v88
    v_sub_f32 v135, v135, v89
    v_sub_f32 v143, v143, v90
    v_sub_f32 v151, v151, v91
    v_exp_f32 v120, v120
    v_exp_f32 v128, v128
    v_exp_f32 v136, v136
    v_exp_f32 v144, v144
    v_exp_f32 v121, v121
    v_exp_f32 v129, v129
    v_exp_f32 v137, v137
    v_exp_f32 v145, v145
    v_exp_f32 v122, v122
    v_exp_f32 v130, v130
    v_exp_f32 v138, v138
    v_exp_f32 v146, v146
    v_exp_f32 v123, v123
    v_exp_f32 v131, v131
    v_exp_f32 v139, v139
    v_exp_f32 v147, v147
    v_exp_f32 v124, v124
    v_exp_f32 v132, v132
    v_exp_f32 v140, v140
    v_exp_f32 v148, v148
    v_exp_f32 v125, v125
    v_exp_f32 v133, v133
    v_exp_f32 v141, v141
    v_exp_f32 v149, v149
    v_exp_f32 v126, v126
    v_exp_f32 v134, v134
    v_exp_f32 v142, v142
    v_exp_f32 v150, v150
    v_exp_f32 v127, v127
    v_exp_f32 v135, v135
    v_exp_f32 v143, v143
    v_exp_f32 v151, v151
    s_nop 0
    v_add_f32 v88, v120, v121
    v_add_f32 v89, v128, v129
    v_add_f32 v90, v136, v137
    v_add_f32 v91, v144, v145
    v_add_f32 v88, v88, v122
    v_add_f32 v89, v89, v130
    v_add_f32 v90, v90, v138
    v_add_f32 v91, v91, v146
    v_add_f32 v88, v88, v123
    v_add_f32 v89, v89, v131
    v_add_f32 v90, v90, v139
    v_add_f32 v91, v91, v147
    v_add_f32 v88, v88, v124
    v_add_f32 v89, v89, v132
    v_add_f32 v90, v90, v140
    v_add_f32 v91, v91, v148
    v_add_f32 v88, v88, v125
    v_add_f32 v89, v89, v133
    v_add_f32 v90, v90, v141
    v_add_f32 v91, v91, v149
    v_add_f32 v88, v88, v126
    v_add_f32 v89, v89, v134
    v_add_f32 v90, v90, v142
    v_add_f32 v91, v91, v150
    v_add_f32 v88, v88, v127
    v_add_f32 v89, v89, v135
    v_add_f32 v90, v90, v143
    v_add_f32 v91, v91, v151
    v_mov_b32 v92, v88
    v_mov_b32 v93, v89
    v_mov_b32 v94, v90
    v_mov_b32 v95, v91
    s_nop 0
    v_permlane16_swap_b32 v88, v92
    v_permlane16_swap_b32 v89, v93
    v_permlane16_swap_b32 v90, v94
    v_permlane16_swap_b32 v91, v95
    s_nop 0
    v_add_f32 v88, v88, v92
    v_add_f32 v89, v89, v93
    v_add_f32 v90, v90, v94
    v_add_f32 v91, v91, v95
    v_mov_b32 v92, v88
    v_mov_b32 v93, v89
    v_mov_b32 v94, v90
    v_mov_b32 v95, v91
    s_nop 0
    v_permlane32_swap_b32 v88, v92
    v_permlane32_swap_b32 v89, v93
    v_permlane32_swap_b32 v90, v94
    v_permlane32_swap_b32 v91, v95
    s_nop 0
    v_add_f32 v88, v88, v92
    v_add_f32 v89, v89, v93
    v_add_f32 v90, v90, v94
    v_add_f32 v91, v91, v95
    v_rcp_f32 v88, v88
    v_rcp_f32 v89, v89
    v_rcp_f32 v90, v90
    v_rcp_f32 v91, v91
    s_nop 0
    v_mul_f32 v120, v120, v88
    v_mul_f32 v128, v128, v89
    v_mul_f32 v136, v136, v90
    v_mul_f32 v144, v144, v91
    v_mul_f32 v121, v121, v88
    v_mul_f32 v129, v129, v89
    v_mul_f32 v137, v137, v90
    v_mul_f32 v145, v145, v91
    v_mul_f32 v122, v122, v88
    v_mul_f32 v130, v130, v89
    v_mul_f32 v138, v138, v90
    v_mul_f32 v146, v146, v91
    v_mul_f32 v123, v123, v88
    v_mul_f32 v131, v131, v89
    v_mul_f32 v139, v139, v90
    v_mul_f32 v147, v147, v91
    v_mul_f32 v124, v124, v88
    v_mul_f32 v132, v132, v89
    v_mul_f32 v140, v140, v90
    v_mul_f32 v148, v148, v91
    v_mul_f32 v125, v125, v88
    v_mul_f32 v133, v133, v89
    v_mul_f32 v141, v141, v90
    v_mul_f32 v149, v149, v91
    v_mul_f32 v126, v126, v88
    v_mul_f32 v134, v134, v89
    v_mul_f32 v142, v142, v90
    v_mul_f32 v150, v150, v91
    v_mul_f32 v127, v127, v88
    v_mul_f32 v135, v135, v89
    v_mul_f32 v143, v143, v90
    v_mul_f32 v151, v151, v91
    v_cvt_pk_bf16_f32 v96, v120, v121
    v_cvt_pk_bf16_f32 v100, v128, v129
    v_cvt_pk_bf16_f32 v104, v136, v137
    v_cvt_pk_bf16_f32 v108, v144, v145
    v_cvt_pk_bf16_f32 v97, v122, v123
    v_cvt_pk_bf16_f32 v101, v130, v131
    v_cvt_pk_bf16_f32 v105, v138, v139
    v_cvt_pk_bf16_f32 v109, v146, v147
    v_cvt_pk_bf16_f32 v98, v124, v125
    v_cvt_pk_bf16_f32 v102, v132, v133
    v_cvt_pk_bf16_f32 v106, v140, v141
    v_cvt_pk_bf16_f32 v110, v148, v149
    v_cvt_pk_bf16_f32 v99, v126, v127
    v_cvt_pk_bf16_f32 v103, v134, v135
    v_cvt_pk_bf16_f32 v107, v142, v143
    v_cvt_pk_bf16_f32 v111, v150, v151
    s_nop 1
    v_mfma_f32_16x16x16_bf16 v[152:155], v[74:75], v[96:97], 0
    v_mfma_f32_16x16x16_bf16 v[156:159], v[76:77], v[100:101], 0
    v_mfma_f32_16x16x16_bf16 v[160:163], v[78:79], v[104:105], 0
    v_mfma_f32_16x16x16_bf16 v[164:167], v[80:81], v[108:109], 0
    v_mfma_f32_16x16x16_bf16 v[152:155], v[76:77], v[98:99], v[152:155]
    v_mfma_f32_16x16x16_bf16 v[156:159], v[78:79], v[102:103], v[156:159]
    v_mfma_f32_16x16x16_bf16 v[160:163], v[80:81], v[106:107], v[160:163]
    v_mfma_f32_16x16x16_bf16 v[164:167], v[82:83], v[110:111], v[164:167]
    s_nop 9
    v_cvt_pk_bf16_f32 v88, v152, v153
    v_cvt_pk_bf16_f32 v89, v154, v155
    v_cvt_pk_bf16_f32 v90, v156, v157
    v_cvt_pk_bf16_f32 v91, v158, v159
    v_cvt_pk_bf16_f32 v92, v160, v161
    v_cvt_pk_bf16_f32 v93, v162, v163
    v_cvt_pk_bf16_f32 v94, v164, v165
    v_cvt_pk_bf16_f32 v95, v166, v167
    s_mov_b32 s13, 0
    buffer_store_dwordx2 v[88:89], v28, s[52:55], s13 offen
    s_mov_b32 s13, 16384
    buffer_store_dwordx2 v[90:91], v28, s[52:55], s13 offen
    s_mov_b32 s13, 32768
    buffer_store_dwordx2 v[92:93], v28, s[52:55], s13 offen
    s_mov_b32 s13, 49152
    buffer_store_dwordx2 v[94:95], v28, s[52:55], s13 offen
L_end_g1a0_kernel:
    s_endpgm
.globl g2r0_kernel
.p2align 8
.type g2r0_kernel,@function
g2r0_kernel:
    s_cmp_ge_u32 s2, 256
    s_cbranch_scc1 L_end_g2r0_kernel
    s_load_dwordx16 s[16:31], s[0:1], 0
    s_load_dwordx4 s[32:35], s[0:1], 64
    s_load_dwordx2 s[36:37], s[0:1], 80
    v_and_b32 v1, 63, v0
    v_lshrrev_b32 v5, 6, v0
    v_bfe_u32 v2, v0, 6, 2
    v_and_b32 v3, 15, v0
    v_bfe_u32 v4, v0, 4, 2
    v_readfirstlane_b32 s39, v5
    s_and_b32 s3, s39, 3
    s_lshr_b32 s38, s39, 2
    s_and_b32 s4, s2, 3
    s_lshl_b32 s4, s4, 3
    s_bfe_u32 s12, s2, 0x30003
    s_add_u32 s4, s4, s12
    s_bfe_u32 s5, s2, 0x10002
    s_lshl_b32 s5, s5, 2
    s_lshr_b32 s12, s2, 6
    s_add_u32 s5, s5, s12
    s_lshl_b32 s6, s4, 6
    s_mov_b32 s9, 0x3f803f80
    s_mul_i32 s10, s5, 128
    s_cmp_eq_u32 s38, 0
    s_cbranch_scc1 L_comp_g2r0_kernel
    s_lshl_b32 s14, s3, 11
    s_mul_i32 s15, s3, 2048
    s_add_u32 s15, s15, 8192
    s_and_b32 s13, s3, 1
    s_lshl_b32 s13, s13, 10
    s_add_u32 s13, s13, 8192
    v_lshrrev_b32 v5, 3, v1
    v_and_b32 v6, 7, v1
    v_xor_b32 v6, v6, v5
    v_lshl_add_u32 v7, v2, 4, v5
    v_add_u32 v7, s6, v7
    s_mov_b32 s11, 1024
    v_mul_lo_u32 v7, v7, s11
    v_lshl_add_u32 v36, v6, 4, v7
    v_add_u32 v37, 8192, v36
    v_mul_u32_u24 v5, 128, v2
    v_add_u32 v5, v5, v1
    s_mov_b32 s11, 1024
    v_add_u32 v6, 0, v5
    v_mul_u32_u24 v7, 8192, v6
    v_lshrrev_b32 v7, 16, v7
    v_mul_u32_u24 v8, 8, v7
    v_sub_u32 v8, v6, v8
    v_bfe_u32 v9, v7, 1, 1
    v_bfe_u32 v17, v7, 3, 1
    v_lshl_or_b32 v9, v17, 1, v9
    v_lshrrev_b32 v17, 1, v8
    v_xor_b32 v9, v9, v17
    v_and_b32 v8, 1, v8
    v_mul_lo_u32 v7, v7, s11
    v_lshl_add_u32 v7, v8, 4, v7
    v_lshl_add_u32 v7, v9, 5, v7
    v_add_u32 v40, s10, v7
    v_add_u32 v6, 64, v5
    v_mul_u32_u24 v7, 8192, v6
    v_lshrrev_b32 v7, 16, v7
    v_mul_u32_u24 v8, 8, v7
    v_sub_u32 v8, v6, v8
    v_bfe_u32 v9, v7, 1, 1
    v_bfe_u32 v17, v7, 3, 1
    v_lshl_or_b32 v9, v17, 1, v9
    v_lshrrev_b32 v17, 1, v8
    v_xor_b32 v9, v9, v17
    v_and_b32 v8, 1, v8
    v_mul_lo_u32 v7, v7, s11
    v_lshl_add_u32 v7, v8, 4, v7
    v_lshl_add_u32 v7, v9, 5, v7
    v_add_u32 v41, s10, v7
    s_waitcnt lgkmcnt(0)
    s_mov_b32 s40, s36
    s_mov_b32 s41, s37
    s_mov_b32 s42, 2097152
    s_mov_b32 s43, 0x00020000
    s_mov_b32 s44, s20
    s_mov_b32 s45, s21
    s_mov_b32 s46, 524288
    s_mov_b32 s47, 0x00020000
    s_mov_b32 s7, 0
    s_mov_b32 s8, 0
    s_add_u32 m0, s15, 0
    s_nop 0
    buffer_load_dwordx4 v40, s[44:47], s8 offen lds
    s_add_u32 m0, s15, 1024
    s_nop 0
    buffer_load_dwordx4 v41, s[44:47], s8 offen lds
    s_add_u32 m0, s14, 0
    s_nop 0
    buffer_load_dwordx4 v36, s[40:43], s7 offen lds
    s_add_u32 m0, s14, 1024
    s_nop 0
    buffer_load_dwordx4 v37, s[40:43], s7 offen lds
    s_mov_b32 s7, 128
    s_mov_b32 s8, 65536
    s_add_u32 m0, s15, 16384
    s_nop 0
    buffer_load_dwordx4 v40, s[44:47], s8 offen lds
    s_add_u32 m0, s15, 17408
    s_nop 0
    buffer_load_dwordx4 v41, s[44:47], s8 offen lds
    s_add_u32 m0, s14, 16384
    s_nop 0
    buffer_load_dwordx4 v36, s[40:43], s7 offen lds
    s_add_u32 m0, s14, 17408
    s_nop 0
    buffer_load_dwordx4 v37, s[40:43], s7 offen lds
    s_waitcnt vmcnt(4)
    s_barrier
    s_mov_b32 s7, 256
    s_mov_b32 s8, 131072
    s_add_u32 m0, s15, 32768
    s_nop 0
    buffer_load_dwordx4 v40, s[44:47], s8 offen lds
    s_add_u32 m0, s15, 33792
    s_nop 0
    buffer_load_dwordx4 v41, s[44:47], s8 offen lds
    s_add_u32 m0, s14, 32768
    s_nop 0
    buffer_load_dwordx4 v36, s[40:43], s7 offen lds
    s_add_u32 m0, s14, 33792
    s_nop 0
    buffer_load_dwordx4 v37, s[40:43], s7 offen lds
    s_mov_b32 s7, 384
    s_mov_b32 s8, 196608
    s_add_u32 m0, s15, 49152
    s_nop 0
    buffer_load_dwordx4 v40, s[44:47], s8 offen lds
    s_add_u32 m0, s15, 50176
    s_nop 0
    buffer_load_dwordx4 v41, s[44:47], s8 offen lds
    s_add_u32 m0, s14, 49152
    s_nop 0
    buffer_load_dwordx4 v36, s[40:43], s7 offen lds
    s_add_u32 m0, s14, 50176
    s_nop 0
    buffer_load_dwordx4 v37, s[40:43], s7 offen lds
    s_waitcnt vmcnt(4)
    s_barrier
    s_mov_b32 s7, 512
    s_mov_b32 s8, 262144
    s_add_u32 m0, s15, 65536
    s_nop 0
    buffer_load_dwordx4 v40, s[44:47], s8 offen lds
    s_add_u32 m0, s15, 66560
    s_nop 0
    buffer_load_dwordx4 v41, s[44:47], s8 offen lds
    s_add_u32 m0, s14, 65536
    s_nop 0
    buffer_load_dwordx4 v36, s[40:43], s7 offen lds
    s_add_u32 m0, s14, 66560
    s_nop 0
    buffer_load_dwordx4 v37, s[40:43], s7 offen lds
    s_mov_b32 s7, 640
    s_mov_b32 s8, 327680
    s_add_u32 m0, s15, 81920
    s_nop 0
    buffer_load_dwordx4 v40, s[44:47], s8 offen lds
    s_add_u32 m0, s15, 82944
    s_nop 0
    buffer_load_dwordx4 v41, s[44:47], s8 offen lds
    s_add_u32 m0, s14, 81920
    s_nop 0
    buffer_load_dwordx4 v36, s[40:43], s7 offen lds
    s_add_u32 m0, s14, 82944
    s_nop 0
    buffer_load_dwordx4 v37, s[40:43], s7 offen lds
    s_waitcnt vmcnt(8)
    s_barrier
    s_mov_b32 s7, 768
    s_mov_b32 s8, 393216
    s_add_u32 m0, s15, 0
    s_nop 0
    buffer_load_dwordx4 v40, s[44:47], s8 offen lds
    s_add_u32 m0, s15, 1024
    s_nop 0
    buffer_load_dwordx4 v41, s[44:47], s8 offen lds
    s_add_u32 m0, s14, 0
    s_nop 0
    buffer_load_dwordx4 v36, s[40:43], s7 offen lds
    s_add_u32 m0, s14, 1024
    s_nop 0
    buffer_load_dwordx4 v37, s[40:43], s7 offen lds
    s_mov_b32 s7, 896
    s_mov_b32 s8, 458752
    s_add_u32 m0, s15, 16384
    s_nop 0
    buffer_load_dwordx4 v40, s[44:47], s8 offen lds
    s_add_u32 m0, s15, 17408
    s_nop 0
    buffer_load_dwordx4 v41, s[44:47], s8 offen lds
    s_add_u32 m0, s14, 16384
    s_nop 0
    buffer_load_dwordx4 v36, s[40:43], s7 offen lds
    s_add_u32 m0, s14, 17408
    s_nop 0
    buffer_load_dwordx4 v37, s[40:43], s7 offen lds
    s_waitcnt vmcnt(12)
    s_barrier
    s_waitcnt vmcnt(8)
    s_barrier
    s_waitcnt vmcnt(4)
    s_barrier
    s_waitcnt vmcnt(0)
    s_barrier
    s_waitcnt vmcnt(0)
    s_barrier
    s_endpgm
L_comp_g2r0_kernel:
    s_waitcnt lgkmcnt(0)
    s_mov_b32 s48, s16
    s_mov_b32 s49, s17
    s_mov_b32 s50, 2097152
    s_mov_b32 s51, 0x00020000
    s_add_u32 s52, s36, 2097152
    s_addc_u32 s53, s37, 0
    s_mov_b32 s54, 2097152
    s_mov_b32 s55, 0x00020000
    v_lshrrev_b32 v5, 1, v2
    v_and_b32 v6, 1, v2
    v_lshl_add_u32 v5, v5, 5, v3
    v_add_u32 v5, s6, v5
    s_mul_i32 s12, s5, 64
    v_mul_u32_u24 v6, 32, v6
    v_lshl_add_u32 v6, v4, 2, v6
    v_add_u32 v6, s12, v6
    v_lshlrev_b32 v20, 10, v5
    v_lshl_add_u32 v20, v6, 1, v20
    v_add_u32 v21, 16384, v20
    buffer_load_dwordx2 v[40:41], v20, s[48:51], 0 offen offset:0
    buffer_load_dwordx2 v[42:43], v20, s[48:51], 0 offen offset:32
    buffer_load_dwordx2 v[44:45], v21, s[48:51], 0 offen offset:0
    buffer_load_dwordx2 v[46:47], v21, s[48:51], 0 offen offset:32
    v_lshrrev_b32 v9, 1, v2
    v_add_u32 v7, 0, v4
    v_and_b32 v17, 7, v3
    v_xor_b32 v7, v7, v17
    v_lshlrev_b32 v7, 4, v7
    v_lshl_add_u32 v14, v3, 7, v7
    v_lshl_add_u32 v14, v9, 12, v14
    v_add_u32 v7, 4, v4
    v_and_b32 v17, 7, v3
    v_xor_b32 v7, v7, v17
    v_lshlrev_b32 v7, 4, v7
    v_lshl_add_u32 v15, v3, 7, v7
    v_lshl_add_u32 v15, v9, 12, v15
    v_and_b32 v9, 1, v2
    v_mul_u32_u24 v9, 2, v9
    v_add_u32 v9, 0, v9
    v_lshrrev_b32 v5, 2, v3
    v_lshl_add_u32 v5, v4, 3, v5
    v_bfe_u32 v6, v5, 1, 1
    v_bfe_u32 v7, v5, 3, 1
    v_lshl_or_b32 v6, v7, 1, v6
    v_xor_b32 v6, v6, v9
    v_mul_u32_u24 v5, 128, v5
    v_lshl_add_u32 v5, v6, 5, v5
    v_and_b32 v6, 3, v3
    v_lshl_add_u32 v5, v6, 3, v5
    v_add_u32 v16, 8192, v5
    v_and_b32 v9, 1, v2
    v_mul_u32_u24 v9, 2, v9
    v_add_u32 v9, 1, v9
    v_lshrrev_b32 v5, 2, v3
    v_lshl_add_u32 v5, v4, 3, v5
    v_bfe_u32 v6, v5, 1, 1
    v_bfe_u32 v7, v5, 3, 1
    v_lshl_or_b32 v6, v7, 1, v6
    v_xor_b32 v6, v6, v9
    v_mul_u32_u24 v5, 128, v5
    v_lshl_add_u32 v5, v6, 5, v5
    v_and_b32 v6, 3, v3
    v_lshl_add_u32 v5, v6, 3, v5
    v_add_u32 v17, 8192, v5
    v_add_u32 v212, 16384, v14
    v_add_u32 v213, 16384, v15
    v_add_u32 v214, 16384, v16
    v_add_u32 v215, 16384, v17
    v_add_u32 v217, 32768, v14
    v_add_u32 v218, 32768, v15
    v_add_u32 v219, 32768, v16
    v_add_u32 v220, 32768, v17
    v_add_u32 v222, 49152, v14
    v_add_u32 v223, 49152, v15
    v_add_u32 v224, 49152, v16
    v_add_u32 v225, 49152, v17
    v_add_u32 v227, 65536, v14
    v_add_u32 v228, 65536, v15
    v_add_u32 v229, 65536, v16
    v_add_u32 v230, 65536, v17
    v_add_u32 v232, 81920, v14
    v_add_u32 v233, 81920, v15
    v_add_u32 v234, 81920, v16
    v_add_u32 v235, 81920, v17
    v_mov_b32 v120, 0
    v_mov_b32 v121, 0
    v_mov_b32 v122, 0
    v_mov_b32 v123, 0
    v_mov_b32 v124, 0
    v_mov_b32 v125, 0
    v_mov_b32 v126, 0
    v_mov_b32 v127, 0
    v_mov_b32 v128, 0
    v_mov_b32 v129, 0
    v_mov_b32 v130, 0
    v_mov_b32 v131, 0
    v_mov_b32 v132, 0
    v_mov_b32 v133, 0
    v_mov_b32 v134, 0
    v_mov_b32 v135, 0
    s_barrier
    ds_read_b64_tr_b16 v[76:77], v16 offset:0
    ds_read_b64_tr_b16 v[78:79], v16 offset:512
    ds_read_b64_tr_b16 v[80:81], v17 offset:0
    ds_read_b64_tr_b16 v[82:83], v17 offset:512
    ds_read_b128 v[56:59], v14 offset:0
    ds_read_b128 v[60:63], v14 offset:2048
    s_waitcnt lgkmcnt(0)
    v_mfma_f32_16x16x32_bf16 v[120:123], v[76:79], v[56:59], v[120:123]
    ds_read_b64_tr_b16 v[108:109], v16 offset:4096
    ds_read_b64_tr_b16 v[110:111], v16 offset:4608
    v_mfma_f32_16x16x32_bf16 v[124:127], v[80:83], v[56:59], v[124:127]
    ds_read_b64_tr_b16 v[112:113], v17 offset:4096
    ds_read_b64_tr_b16 v[114:115], v17 offset:4608
    v_mfma_f32_16x16x32_bf16 v[128:131], v[76:79], v[60:63], v[128:131]
    ds_read_b128 v[88:91], v15 offset:0
    ds_read_b128 v[92:95], v15 offset:2048
    v_mfma_f32_16x16x32_bf16 v[132:135], v[80:83], v[60:63], v[132:135]
    s_waitcnt lgkmcnt(0)
    v_mfma_f32_16x16x32_bf16 v[120:123], v[108:111], v[88:91], v[120:123]
    v_mfma_f32_16x16x32_bf16 v[124:127], v[112:115], v[88:91], v[124:127]
    v_mfma_f32_16x16x32_bf16 v[128:131], v[108:111], v[92:95], v[128:131]
    v_mfma_f32_16x16x32_bf16 v[132:135], v[112:115], v[92:95], v[132:135]
    s_barrier
    ds_read_b64_tr_b16 v[76:77], v214 offset:0
    ds_read_b64_tr_b16 v[78:79], v214 offset:512
    ds_read_b64_tr_b16 v[80:81], v215 offset:0
    ds_read_b64_tr_b16 v[82:83], v215 offset:512
    ds_read_b128 v[56:59], v212 offset:0
    ds_read_b128 v[60:63], v212 offset:2048
    s_waitcnt lgkmcnt(0)
    v_mfma_f32_16x16x32_bf16 v[120:123], v[76:79], v[56:59], v[120:123]
    ds_read_b64_tr_b16 v[108:109], v214 offset:4096
    ds_read_b64_tr_b16 v[110:111], v214 offset:4608
    v_mfma_f32_16x16x32_bf16 v[124:127], v[80:83], v[56:59], v[124:127]
    ds_read_b64_tr_b16 v[112:113], v215 offset:4096
    ds_read_b64_tr_b16 v[114:115], v215 offset:4608
    v_mfma_f32_16x16x32_bf16 v[128:131], v[76:79], v[60:63], v[128:131]
    ds_read_b128 v[88:91], v213 offset:0
    ds_read_b128 v[92:95], v213 offset:2048
    v_mfma_f32_16x16x32_bf16 v[132:135], v[80:83], v[60:63], v[132:135]
    s_waitcnt lgkmcnt(0)
    v_mfma_f32_16x16x32_bf16 v[120:123], v[108:111], v[88:91], v[120:123]
    ds_read_b64_tr_b16 v[76:77], v219 offset:0
    ds_read_b64_tr_b16 v[78:79], v219 offset:512
    v_mfma_f32_16x16x32_bf16 v[124:127], v[112:115], v[88:91], v[124:127]
    ds_read_b64_tr_b16 v[80:81], v220 offset:0
    ds_read_b64_tr_b16 v[82:83], v220 offset:512
    v_mfma_f32_16x16x32_bf16 v[128:131], v[108:111], v[92:95], v[128:131]
    ds_read_b128 v[56:59], v217 offset:0
    ds_read_b128 v[60:63], v217 offset:2048
    v_mfma_f32_16x16x32_bf16 v[132:135], v[112:115], v[92:95], v[132:135]
    s_barrier
    s_waitcnt lgkmcnt(0)
    v_mfma_f32_16x16x32_bf16 v[120:123], v[76:79], v[56:59], v[120:123]
    ds_read_b64_tr_b16 v[108:109], v219 offset:4096
    ds_read_b64_tr_b16 v[110:111], v219 offset:4608
    v_mfma_f32_16x16x32_bf16 v[124:127], v[80:83], v[56:59], v[124:127]
    ds_read_b64_tr_b16 v[112:113], v220 offset:4096
    ds_read_b64_tr_b16 v[114:115], v220 offset:4608
    v_mfma_f32_16x16x32_bf16 v[128:131], v[76:79], v[60:63], v[128:131]
    ds_read_b128 v[88:91], v218 offset:0
    ds_read_b128 v[92:95], v218 offset:2048
    v_mfma_f32_16x16x32_bf16 v[132:135], v[80:83], v[60:63], v[132:135]
    s_waitcnt lgkmcnt(0)
    v_mfma_f32_16x16x32_bf16 v[120:123], v[108:111], v[88:91], v[120:123]
    ds_read_b64_tr_b16 v[76:77], v224 offset:0
    ds_read_b64_tr_b16 v[78:79], v224 offset:512
    v_mfma_f32_16x16x32_bf16 v[124:127], v[112:115], v[88:91], v[124:127]
    ds_read_b64_tr_b16 v[80:81], v225 offset:0
    ds_read_b64_tr_b16 v[82:83], v225 offset:512
    v_mfma_f32_16x16x32_bf16 v[128:131], v[108:111], v[92:95], v[128:131]
    ds_read_b128 v[56:59], v222 offset:0
    ds_read_b128 v[60:63], v222 offset:2048
    v_mfma_f32_16x16x32_bf16 v[132:135], v[112:115], v[92:95], v[132:135]
    s_barrier
    s_waitcnt lgkmcnt(0)
    v_mfma_f32_16x16x32_bf16 v[120:123], v[76:79], v[56:59], v[120:123]
    ds_read_b64_tr_b16 v[108:109], v224 offset:4096
    ds_read_b64_tr_b16 v[110:111], v224 offset:4608
    v_mfma_f32_16x16x32_bf16 v[124:127], v[80:83], v[56:59], v[124:127]
    ds_read_b64_tr_b16 v[112:113], v225 offset:4096
    ds_read_b64_tr_b16 v[114:115], v225 offset:4608
    v_mfma_f32_16x16x32_bf16 v[128:131], v[76:79], v[60:63], v[128:131]
    ds_read_b128 v[88:91], v223 offset:0
    ds_read_b128 v[92:95], v223 offset:2048
    v_mfma_f32_16x16x32_bf16 v[132:135], v[80:83], v[60:63], v[132:135]
    s_waitcnt lgkmcnt(0)
    v_mfma_f32_16x16x32_bf16 v[120:123], v[108:111], v[88:91], v[120:123]
    ds_read_b64_tr_b16 v[76:77], v229 offset:0
    ds_read_b64_tr_b16 v[78:79], v229 offset:512
    v_mfma_f32_16x16x32_bf16 v[124:127], v[112:115], v[88:91], v[124:127]
    ds_read_b64_tr_b16 v[80:81], v230 offset:0
    ds_read_b64_tr_b16 v[82:83], v230 offset:512
    v_mfma_f32_16x16x32_bf16 v[128:131], v[108:111], v[92:95], v[128:131]
    ds_read_b128 v[56:59], v227 offset:0
    ds_read_b128 v[60:63], v227 offset:2048
    v_mfma_f32_16x16x32_bf16 v[132:135], v[112:115], v[92:95], v[132:135]
    s_barrier
    s_waitcnt lgkmcnt(0)
    v_mfma_f32_16x16x32_bf16 v[120:123], v[76:79], v[56:59], v[120:123]
    ds_read_b64_tr_b16 v[108:109], v229 offset:4096
    ds_read_b64_tr_b16 v[110:111], v229 offset:4608
    v_mfma_f32_16x16x32_bf16 v[124:127], v[80:83], v[56:59], v[124:127]
    ds_read_b64_tr_b16 v[112:113], v230 offset:4096
    ds_read_b64_tr_b16 v[114:115], v230 offset:4608
    v_mfma_f32_16x16x32_bf16 v[128:131], v[76:79], v[60:63], v[128:131]
    ds_read_b128 v[88:91], v228 offset:0
    ds_read_b128 v[92:95], v228 offset:2048
    v_mfma_f32_16x16x32_bf16 v[132:135], v[80:83], v[60:63], v[132:135]
    s_waitcnt lgkmcnt(0)
    v_mfma_f32_16x16x32_bf16 v[120:123], v[108:111], v[88:91], v[120:123]
    ds_read_b64_tr_b16 v[76:77], v234 offset:0
    ds_read_b64_tr_b16 v[78:79], v234 offset:512
    v_mfma_f32_16x16x32_bf16 v[124:127], v[112:115], v[88:91], v[124:127]
    ds_read_b64_tr_b16 v[80:81], v235 offset:0
    ds_read_b64_tr_b16 v[82:83], v235 offset:512
    v_mfma_f32_16x16x32_bf16 v[128:131], v[108:111], v[92:95], v[128:131]
    ds_read_b128 v[56:59], v232 offset:0
    ds_read_b128 v[60:63], v232 offset:2048
    v_mfma_f32_16x16x32_bf16 v[132:135], v[112:115], v[92:95], v[132:135]
    s_barrier
    s_waitcnt lgkmcnt(0)
    v_mfma_f32_16x16x32_bf16 v[120:123], v[76:79], v[56:59], v[120:123]
    ds_read_b64_tr_b16 v[108:109], v234 offset:4096
    ds_read_b64_tr_b16 v[110:111], v234 offset:4608
    v_mfma_f32_16x16x32_bf16 v[124:127], v[80:83], v[56:59], v[124:127]
    ds_read_b64_tr_b16 v[112:113], v235 offset:4096
    ds_read_b64_tr_b16 v[114:115], v235 offset:4608
    v_mfma_f32_16x16x32_bf16 v[128:131], v[76:79], v[60:63], v[128:131]
    ds_read_b128 v[88:91], v233 offset:0
    ds_read_b128 v[92:95], v233 offset:2048
    v_mfma_f32_16x16x32_bf16 v[132:135], v[80:83], v[60:63], v[132:135]
    s_waitcnt lgkmcnt(0)
    v_mfma_f32_16x16x32_bf16 v[120:123], v[108:111], v[88:91], v[120:123]
    ds_read_b64_tr_b16 v[76:77], v16 offset:0
    ds_read_b64_tr_b16 v[78:79], v16 offset:512
    v_mfma_f32_16x16x32_bf16 v[124:127], v[112:115], v[88:91], v[124:127]
    ds_read_b64_tr_b16 v[80:81], v17 offset:0
    ds_read_b64_tr_b16 v[82:83], v17 offset:512
    v_mfma_f32_16x16x32_bf16 v[128:131], v[108:111], v[92:95], v[128:131]
    ds_read_b128 v[56:59], v14 offset:0
    ds_read_b128 v[60:63], v14 offset:2048
    v_mfma_f32_16x16x32_bf16 v[132:135], v[112:115], v[92:95], v[132:135]
    s_barrier
    s_waitcnt lgkmcnt(0)
    v_mfma_f32_16x16x32_bf16 v[120:123], v[76:79], v[56:59], v[120:123]
    ds_read_b64_tr_b16 v[108:109], v16 offset:4096
    ds_read_b64_tr_b16 v[110:111], v16 offset:4608
    v_mfma_f32_16x16x32_bf16 v[124:127], v[80:83], v[56:59], v[124:127]
    ds_read_b64_tr_b16 v[112:113], v17 offset:4096
    ds_read_b64_tr_b16 v[114:115], v17 offset:4608
    v_mfma_f32_16x16x32_bf16 v[128:131], v[76:79], v[60:63], v[128:131]
    ds_read_b128 v[88:91], v15 offset:0
    ds_read_b128 v[92:95], v15 offset:2048
    v_mfma_f32_16x16x32_bf16 v[132:135], v[80:83], v[60:63], v[132:135]
    s_waitcnt lgkmcnt(0)
    v_mfma_f32_16x16x32_bf16 v[120:123], v[108:111], v[88:91], v[120:123]
    ds_read_b64_tr_b16 v[76:77], v214 offset:0
    ds_read_b64_tr_b16 v[78:79], v214 offset:512
    v_mfma_f32_16x16x32_bf16 v[124:127], v[112:115], v[88:91], v[124:127]
    ds_read_b64_tr_b16 v[80:81], v215 offset:0
    ds_read_b64_tr_b16 v[82:83], v215 offset:512
    v_mfma_f32_16x16x32_bf16 v[128:131], v[108:111], v[92:95], v[128:131]
    ds_read_b128 v[56:59], v212 offset:0
    ds_read_b128 v[60:63], v212 offset:2048
    v_mfma_f32_16x16x32_bf16 v[132:135], v[112:115], v[92:95], v[132:135]
    s_barrier
    s_waitcnt lgkmcnt(0)
    v_mfma_f32_16x16x32_bf16 v[120:123], v[76:79], v[56:59], v[120:123]
    ds_read_b64_tr_b16 v[108:109], v214 offset:4096
    ds_read_b64_tr_b16 v[110:111], v214 offset:4608
    v_mfma_f32_16x16x32_bf16 v[124:127], v[80:83], v[56:59], v[124:127]
    ds_read_b64_tr_b16 v[112:113], v215 offset:4096
    ds_read_b64_tr_b16 v[114:115], v215 offset:4608
    v_mfma_f32_16x16x32_bf16 v[128:131], v[76:79], v[60:63], v[128:131]
    ds_read_b128 v[88:91], v213 offset:0
    ds_read_b128 v[92:95], v213 offset:2048
    v_mfma_f32_16x16x32_bf16 v[132:135], v[80:83], v[60:63], v[132:135]
    s_waitcnt lgkmcnt(0)
    v_mfma_f32_16x16x32_bf16 v[120:123], v[108:111], v[88:91], v[120:123]
    v_mfma_f32_16x16x32_bf16 v[124:127], v[112:115], v[88:91], v[124:127]
    v_mfma_f32_16x16x32_bf16 v[128:131], v[108:111], v[92:95], v[128:131]
    v_mfma_f32_16x16x32_bf16 v[132:135], v[112:115], v[92:95], v[132:135]
    s_waitcnt vmcnt(0)
    s_nop 9
    v_cvt_pk_bf16_f32 v56, v120, v121
    v_lshlrev_b32 v120, 16, v56
    v_and_b32 v121, 0xffff0000, v56
    v_lshlrev_b32 v57, 16, v40
    v_and_b32 v58, 0xffff0000, v40
    v_add_f32 v120, v120, v57
    v_add_f32 v121, v121, v58
    v_cvt_pk_bf16_f32 v56, v122, v123
    v_lshlrev_b32 v122, 16, v56
    v_and_b32 v123, 0xffff0000, v56
    v_lshlrev_b32 v57, 16, v41
    v_and_b32 v58, 0xffff0000, v41
    v_add_f32 v122, v122, v57
    v_add_f32 v123, v123, v58
    v_cvt_pk_bf16_f32 v120, v120, v121
    v_cvt_pk_bf16_f32 v121, v122, v123
    buffer_store_dwordx2 v[120:121], v20, s[52:55], 0 offen offset:0
    v_cvt_pk_bf16_f32 v56, v124, v125
    v_lshlrev_b32 v124, 16, v56
    v_and_b32 v125, 0xffff0000, v56
    v_lshlrev_b32 v57, 16, v42
    v_and_b32 v58, 0xffff0000, v42
    v_add_f32 v124, v124, v57
    v_add_f32 v125, v125, v58
    v_cvt_pk_bf16_f32 v56, v126, v127
    v_lshlrev_b32 v126, 16, v56
    v_and_b32 v127, 0xffff0000, v56
    v_lshlrev_b32 v57, 16, v43
    v_and_b32 v58, 0xffff0000, v43
    v_add_f32 v126, v126, v57
    v_add_f32 v127, v127, v58
    v_cvt_pk_bf16_f32 v124, v124, v125
    v_cvt_pk_bf16_f32 v125, v126, v127
    buffer_store_dwordx2 v[124:125], v20, s[52:55], 0 offen offset:32
    v_cvt_pk_bf16_f32 v56, v128, v129
    v_lshlrev_b32 v128, 16, v56
    v_and_b32 v129, 0xffff0000, v56
    v_lshlrev_b32 v57, 16, v44
    v_and_b32 v58, 0xffff0000, v44
    v_add_f32 v128, v128, v57
    v_add_f32 v129, v129, v58
    v_cvt_pk_bf16_f32 v56, v130, v131
    v_lshlrev_b32 v130, 16, v56
    v_and_b32 v131, 0xffff0000, v56
    v_lshlrev_b32 v57, 16, v45
    v_and_b32 v58, 0xffff0000, v45
    v_add_f32 v130, v130, v57
    v_add_f32 v131, v131, v58
    v_cvt_pk_bf16_f32 v128, v128, v129
    v_cvt_pk_bf16_f32 v129, v130, v131
    buffer_store_dwordx2 v[128:129], v21, s[52:55], 0 offen offset:0
    v_cvt_pk_bf16_f32 v56, v132, v133
    v_lshlrev_b32 v132, 16, v56
    v_and_b32 v133, 0xffff0000, v56
    v_lshlrev_b32 v57, 16, v46
    v_and_b32 v58, 0xffff0000, v46
    v_add_f32 v132, v132, v57
    v_add_f32 v133, v133, v58
    v_cvt_pk_bf16_f32 v56, v134, v135
    v_lshlrev_b32 v134, 16, v56
    v_and_b32 v135, 0xffff0000, v56
    v_lshlrev_b32 v57, 16, v47
    v_and_b32 v58, 0xffff0000, v47
    v_add_f32 v134, v134, v57
    v_add_f32 v135, v135, v58
    v_cvt_pk_bf16_f32 v132, v132, v133
    v_cvt_pk_bf16_f32 v133, v134, v135
    buffer_store_dwordx2 v[132:133], v21, s[52:55], 0 offen offset:32
L_end_g2r0_kernel:
    s_endpgm
.globl g3_kernel
.p2align 8
.type g3_kernel,@function
g3_kernel:
    s_cmp_ge_u32 s2, 256
    s_cbranch_scc1 L_end_g3_kernel
    s_load_dwordx16 s[16:31], s[0:1], 0
    s_load_dwordx4 s[32:35], s[0:1], 64
    s_load_dwordx2 s[36:37], s[0:1], 80
    v_and_b32 v1, 63, v0
    v_lshrrev_b32 v5, 6, v0
    v_bfe_u32 v2, v0, 6, 2
    v_and_b32 v3, 15, v0
    v_bfe_u32 v4, v0, 4, 2
    v_readfirstlane_b32 s39, v5
    s_and_b32 s3, s39, 3
    s_lshr_b32 s38, s39, 2
    s_and_b32 s4, s2, 3
    s_lshl_b32 s4, s4, 3
    s_bfe_u32 s12, s2, 0x30003
    s_add_u32 s4, s4, s12
    s_bfe_u32 s5, s2, 0x10002
    s_lshl_b32 s5, s5, 2
    s_lshr_b32 s12, s2, 6
    s_add_u32 s5, s5, s12
    s_lshl_b32 s6, s4, 6
    s_mov_b32 s9, 0x3f803f80
    s_lshr_b32 s10, s5, 2
    s_mul_i32 s10, s10, 1376
    s_and_b32 s12, s5, 3
    s_mul_i32 s12, s12, 384
    s_add_u32 s10, s10, s12
    s_cmp_eq_u32 s38, 0
    s_cbranch_scc1 L_comp_g3_kernel
    s_lshl_b32 s14, s3, 11
    s_mul_i32 s15, s3, 6144
    s_add_u32 s15, s15, 8192
    s_and_b32 s13, s3, 1
    s_lshl_b32 s13, s13, 10
    s_add_u32 s13, s13, 8192
    v_lshrrev_b32 v5, 3, v1
    v_and_b32 v6, 7, v1
    v_xor_b32 v6, v6, v5
    v_lshl_add_u32 v7, v2, 4, v5
    v_add_u32 v7, s6, v7
    s_mov_b32 s11, 1024
    v_mul_lo_u32 v7, v7, s11
    v_lshl_add_u32 v36, v6, 4, v7
    v_add_u32 v37, 8192, v36
    v_mul_u32_u24 v5, 384, v2
    v_add_u32 v5, v5, v1
    s_mov_b32 s11, 2752
    v_add_u32 v6, 0, v5
    v_mul_u32_u24 v7, 2731, v6
    v_lshrrev_b32 v7, 16, v7
    v_mul_u32_u24 v8, 24, v7
    v_sub_u32 v8, v6, v8
    v_bfe_u32 v9, v7, 1, 1
    v_bfe_u32 v17, v7, 3, 1
    v_lshl_or_b32 v9, v17, 1, v9
    v_lshrrev_b32 v17, 1, v8
    v_xor_b32 v9, v9, v17
    v_and_b32 v8, 1, v8
    v_mul_lo_u32 v7, v7, s11
    v_lshl_add_u32 v7, v8, 4, v7
    v_lshl_add_u32 v7, v9, 5, v7
    v_add_u32 v40, s10, v7
    v_add_u32 v6, 64, v5
    v_mul_u32_u24 v7, 2731, v6
    v_lshrrev_b32 v7, 16, v7
    v_mul_u32_u24 v8, 24, v7
    v_sub_u32 v8, v6, v8
    v_bfe_u32 v9, v7, 1, 1
    v_bfe_u32 v17, v7, 3, 1
    v_lshl_or_b32 v9, v17, 1, v9
    v_lshrrev_b32 v17, 1, v8
    v_xor_b32 v9, v9, v17
    v_and_b32 v8, 1, v8
    v_mul_lo_u32 v7, v7, s11
    v_lshl_add_u32 v7, v8, 4, v7
    v_lshl_add_u32 v7, v9, 5, v7
    v_add_u32 v41, s10, v7
    v_add_u32 v6, 128, v5
    v_mul_u32_u24 v7, 2731, v6
    v_lshrrev_b32 v7, 16, v7
    v_mul_u32_u24 v8, 24, v7
    v_sub_u32 v8, v6, v8
    v_bfe_u32 v9, v7, 1, 1
    v_bfe_u32 v17, v7, 3, 1
    v_lshl_or_b32 v9, v17, 1, v9
    v_lshrrev_b32 v17, 1, v8
    v_xor_b32 v9, v9, v17
    v_and_b32 v8, 1, v8
    v_mul_lo_u32 v7, v7, s11
    v_lshl_add_u32 v7, v8, 4, v7
    v_lshl_add_u32 v7, v9, 5, v7
    v_add_u32 v42, s10, v7
    v_add_u32 v6, 192, v5
    v_mul_u32_u24 v7, 2731, v6
    v_lshrrev_b32 v7, 16, v7
    v_mul_u32_u24 v8, 24, v7
    v_sub_u32 v8, v6, v8
    v_bfe_u32 v9, v7, 1, 1
    v_bfe_u32 v17, v7, 3, 1
    v_lshl_or_b32 v9, v17, 1, v9
    v_lshrrev_b32 v17, 1, v8
    v_xor_b32 v9, v9, v17
    v_and_b32 v8, 1, v8
    v_mul_lo_u32 v7, v7, s11
    v_lshl_add_u32 v7, v8, 4, v7
    v_lshl_add_u32 v7, v9, 5, v7
    v_add_u32 v43, s10, v7
    v_add_u32 v6, 256, v5
    v_mul_u32_u24 v7, 2731, v6
    v_lshrrev_b32 v7, 16, v7
    v_mul_u32_u24 v8, 24, v7
    v_sub_u32 v8, v6, v8
    v_bfe_u32 v9, v7, 1, 1
    v_bfe_u32 v17, v7, 3, 1
    v_lshl_or_b32 v9, v17, 1, v9
    v_lshrrev_b32 v17, 1, v8
    v_xor_b32 v9, v9, v17
    v_and_b32 v8, 1, v8
    v_mul_lo_u32 v7, v7, s11
    v_lshl_add_u32 v7, v8, 4, v7
    v_lshl_add_u32 v7, v9, 5, v7
    v_add_u32 v44, s10, v7
    v_add_u32 v6, 320, v5
    v_mul_u32_u24 v7, 2731, v6
    v_lshrrev_b32 v7, 16, v7
    v_mul_u32_u24 v8, 24, v7
    v_sub_u32 v8, v6, v8
    v_bfe_u32 v9, v7, 1, 1
    v_bfe_u32 v17, v7, 3, 1
    v_lshl_or_b32 v9, v17, 1, v9
    v_lshrrev_b32 v17, 1, v8
    v_xor_b32 v9, v9, v17
    v_and_b32 v8, 1, v8
    v_mul_lo_u32 v7, v7, s11
    v_lshl_add_u32 v7, v8, 4, v7
    v_lshl_add_u32 v7, v9, 5, v7
    v_add_u32 v45, s10, v7
    s_waitcnt lgkmcnt(0)
    s_add_u32 s40, s36, 2097152
    s_addc_u32 s41, s37, 0
    s_mov_b32 s42, 2097152
    s_mov_b32 s43, 0x00020000
    s_mov_b32 s44, s24
    s_mov_b32 s45, s25
    s_mov_b32 s46, 1409024
    s_mov_b32 s47, 0x00020000
    s_mov_b32 s7, 0
    s_mov_b32 s8, 0
    s_add_u32 m0, s15, 0
    s_nop 0
    buffer_load_dwordx4 v40, s[44:47], s8 offen lds
    s_add_u32 m0, s15, 1024
    s_nop 0
    buffer_load_dwordx4 v41, s[44:47], s8 offen lds
    s_add_u32 m0, s15, 2048
    s_nop 0
    buffer_load_dwordx4 v42, s[44:47], s8 offen lds
    s_add_u32 m0, s15, 3072
    s_nop 0
    buffer_load_dwordx4 v43, s[44:47], s8 offen lds
    s_add_u32 m0, s15, 4096
    s_nop 0
    buffer_load_dwordx4 v44, s[44:47], s8 offen lds
    s_add_u32 m0, s15, 5120
    s_nop 0
    buffer_load_dwordx4 v45, s[44:47], s8 offen lds
    s_add_u32 m0, s14, 0
    s_nop 0
    buffer_load_dwordx4 v36, s[40:43], s7 offen lds
    s_add_u32 m0, s14, 1024
    s_nop 0
    buffer_load_dwordx4 v37, s[40:43], s7 offen lds
    s_mov_b32 s7, 128
    s_mov_b32 s8, 176128
    s_add_u32 m0, s15, 32768
    s_nop 0
    buffer_load_dwordx4 v40, s[44:47], s8 offen lds
    s_add_u32 m0, s15, 33792
    s_nop 0
    buffer_load_dwordx4 v41, s[44:47], s8 offen lds
    s_add_u32 m0, s15, 34816
    s_nop 0
    buffer_load_dwordx4 v42, s[44:47], s8 offen lds
    s_add_u32 m0, s15, 35840
    s_nop 0
    buffer_load_dwordx4 v43, s[44:47], s8 offen lds
    s_add_u32 m0, s15, 36864
    s_nop 0
    buffer_load_dwordx4 v44, s[44:47], s8 offen lds
    s_add_u32 m0, s15, 37888
    s_nop 0
    buffer_load_dwordx4 v45, s[44:47], s8 offen lds
    s_add_u32 m0, s14, 32768
    s_nop 0
    buffer_load_dwordx4 v36, s[40:43], s7 offen lds
    s_add_u32 m0, s14, 33792
    s_nop 0
    buffer_load_dwordx4 v37, s[40:43], s7 offen lds
    s_waitcnt vmcnt(8)
    s_barrier
    s_mov_b32 s7, 256
    s_mov_b32 s8, 352256
    s_add_u32 m0, s15, 65536
    s_nop 0
    buffer_load_dwordx4 v40, s[44:47], s8 offen lds
    s_add_u32 m0, s15, 66560
    s_nop 0
    buffer_load_dwordx4 v41, s[44:47], s8 offen lds
    s_add_u32 m0, s15, 67584
    s_nop 0
    buffer_load_dwordx4 v42, s[44:47], s8 offen lds
    s_add_u32 m0, s15, 68608
    s_nop 0
    buffer_load_dwordx4 v43, s[44:47], s8 offen lds
    s_add_u32 m0, s15, 69632
    s_nop 0
    buffer_load_dwordx4 v44, s[44:47], s8 offen lds
    s_add_u32 m0, s15, 70656
    s_nop 0
    buffer_load_dwordx4 v45, s[44:47], s8 offen lds
    s_add_u32 m0, s14, 65536
    s_nop 0
    buffer_load_dwordx4 v36, s[40:43], s7 offen lds
    s_add_u32 m0, s14, 66560
    s_nop 0
    buffer_load_dwordx4 v37, s[40:43], s7 offen lds
    s_mov_b32 s7, 384
    s_mov_b32 s8, 528384
    s_add_u32 m0, s15, 98304
    s_nop 0
    buffer_load_dwordx4 v40, s[44:47], s8 offen lds
    s_add_u32 m0, s15, 99328
    s_nop 0
    buffer_load_dwordx4 v41, s[44:47], s8 offen lds
    s_add_u32 m0, s15, 100352
    s_nop 0
    buffer_load_dwordx4 v42, s[44:47], s8 offen lds
    s_add_u32 m0, s15, 101376
    s_nop 0
    buffer_load_dwordx4 v43, s[44:47], s8 offen lds
    s_add_u32 m0, s15, 102400
    s_nop 0
    buffer_load_dwordx4 v44, s[44:47], s8 offen lds
    s_add_u32 m0, s15, 103424
    s_nop 0
    buffer_load_dwordx4 v45, s[44:47], s8 offen lds
    s_add_u32 m0, s14, 98304
    s_nop 0
    buffer_load_dwordx4 v36, s[40:43], s7 offen lds
    s_add_u32 m0, s14, 99328
    s_nop 0
    buffer_load_dwordx4 v37, s[40:43], s7 offen lds
    s_waitcnt vmcnt(8)
    s_barrier
    s_mov_b32 s7, 512
    s_mov_b32 s8, 704512
    s_add_u32 m0, s15, 0
    s_nop 0
    buffer_load_dwordx4 v40, s[44:47], s8 offen lds
    s_add_u32 m0, s15, 1024
    s_nop 0
    buffer_load_dwordx4 v41, s[44:47], s8 offen lds
    s_add_u32 m0, s15, 2048
    s_nop 0
    buffer_load_dwordx4 v42, s[44:47], s8 offen lds
    s_add_u32 m0, s15, 3072
    s_nop 0
    buffer_load_dwordx4 v43, s[44:47], s8 offen lds
    s_add_u32 m0, s15, 4096
    s_nop 0
    buffer_load_dwordx4 v44, s[44:47], s8 offen lds
    s_add_u32 m0, s15, 5120
    s_nop 0
    buffer_load_dwordx4 v45, s[44:47], s8 offen lds
    s_add_u32 m0, s14, 0
    s_nop 0
    buffer_load_dwordx4 v36, s[40:43], s7 offen lds
    s_add_u32 m0, s14, 1024
    s_nop 0
    buffer_load_dwordx4 v37, s[40:43], s7 offen lds
    s_waitcnt vmcnt(8)
    s_barrier
    s_mov_b32 s7, 640
    s_mov_b32 s8, 880640
    s_add_u32 m0, s15, 32768
    s_nop 0
    buffer_load_dwordx4 v40, s[44:47], s8 offen lds
    s_add_u32 m0, s15, 33792
    s_nop 0
    buffer_load_dwordx4 v41, s[44:47], s8 offen lds
    s_add_u32 m0, s15, 34816
    s_nop 0
    buffer_load_dwordx4 v42, s[44:47], s8 offen lds
    s_add_u32 m0, s15, 35840
    s_nop 0
    buffer_load_dwordx4 v43, s[44:47], s8 offen lds
    s_add_u32 m0, s15, 36864
    s_nop 0
    buffer_load_dwordx4 v44, s[44:47], s8 offen lds
    s_add_u32 m0, s15, 37888
    s_nop 0
    buffer_load_dwordx4 v45, s[44:47], s8 offen lds
    s_add_u32 m0, s14, 32768
    s_nop 0
    buffer_load_dwordx4 v36, s[40:43], s7 offen lds
    s_add_u32 m0, s14, 33792
    s_nop 0
    buffer_load_dwordx4 v37, s[40:43], s7 offen lds
    s_waitcnt vmcnt(8)
    s_barrier
    s_mov_b32 s7, 768
    s_mov_b32 s8, 1056768
    s_add_u32 m0, s15, 65536
    s_nop 0
    buffer_load_dwordx4 v40, s[44:47], s8 offen lds
    s_add_u32 m0, s15, 66560
    s_nop 0
    buffer_load_dwordx4 v41, s[44:47], s8 offen lds
    s_add_u32 m0, s15, 67584
    s_nop 0
    buffer_load_dwordx4 v42, s[44:47], s8 offen lds
    s_add_u32 m0, s15, 68608
    s_nop 0
    buffer_load_dwordx4 v43, s[44:47], s8 offen lds
    s_add_u32 m0, s15, 69632
    s_nop 0
    buffer_load_dwordx4 v44, s[44:47], s8 offen lds
    s_add_u32 m0, s15, 70656
    s_nop 0
    buffer_load_dwordx4 v45, s[44:47], s8 offen lds
    s_add_u32 m0, s14, 65536
    s_nop 0
    buffer_load_dwordx4 v36, s[40:43], s7 offen lds
    s_add_u32 m0, s14, 66560
    s_nop 0
    buffer_load_dwordx4 v37, s[40:43], s7 offen lds
    s_waitcnt vmcnt(8)
    s_barrier
    s_mov_b32 s7, 896
    s_mov_b32 s8, 1232896
    s_add_u32 m0, s15, 98304
    s_nop 0
    buffer_load_dwordx4 v40, s[44:47], s8 offen lds
    s_add_u32 m0, s15, 99328
    s_nop 0
    buffer_load_dwordx4 v41, s[44:47], s8 offen lds
    s_add_u32 m0, s15, 100352
    s_nop 0
    buffer_load_dwordx4 v42, s[44:47], s8 offen lds
    s_add_u32 m0, s15, 101376
    s_nop 0
    buffer_load_dwordx4 v43, s[44:47], s8 offen lds
    s_add_u32 m0, s15, 102400
    s_nop 0
    buffer_load_dwordx4 v44, s[44:47], s8 offen lds
    s_add_u32 m0, s15, 103424
    s_nop 0
    buffer_load_dwordx4 v45, s[44:47], s8 offen lds
    s_add_u32 m0, s14, 98304
    s_nop 0
    buffer_load_dwordx4 v36, s[40:43], s7 offen lds
    s_add_u32 m0, s14, 99328
    s_nop 0
    buffer_load_dwordx4 v37, s[40:43], s7 offen lds
    s_waitcnt vmcnt(8)
    s_barrier
    s_waitcnt vmcnt(0)
    s_barrier
    s_waitcnt vmcnt(0)
    s_barrier
    s_endpgm
L_comp_g3_kernel:
    s_waitcnt lgkmcnt(0)
    v_add_u32 v7, 0, v4
    v_and_b32 v17, 7, v3
    v_xor_b32 v7, v7, v17
    v_lshlrev_b32 v7, 4, v7
    v_lshl_add_u32 v14, v3, 7, v7
    v_add_u32 v7, 4, v4
    v_and_b32 v17, 7, v3
    v_xor_b32 v7, v7, v17
    v_lshlrev_b32 v7, 4, v7
    v_lshl_add_u32 v15, v3, 7, v7
    v_mul_u32_u24 v9, 3, v2
    v_add_u32 v9, 0, v9
    v_lshrrev_b32 v5, 2, v3
    v_lshl_add_u32 v5, v4, 3, v5
    v_bfe_u32 v6, v5, 1, 1
    v_bfe_u32 v7, v5, 3, 1
    v_lshl_or_b32 v6, v7, 1, v6
    v_xor_b32 v6, v6, v9
    v_mul_u32_u24 v5, 384, v5
    v_lshl_add_u32 v5, v6, 5, v5
    v_and_b32 v6, 3, v3
    v_lshl_add_u32 v5, v6, 3, v5
    v_add_u32 v16, 8192, v5
    v_mul_u32_u24 v9, 3, v2
    v_add_u32 v9, 1, v9
    v_lshrrev_b32 v5, 2, v3
    v_lshl_add_u32 v5, v4, 3, v5
    v_bfe_u32 v6, v5, 1, 1
    v_bfe_u32 v7, v5, 3, 1
    v_lshl_or_b32 v6, v7, 1, v6
    v_xor_b32 v6, v6, v9
    v_mul_u32_u24 v5, 384, v5
    v_lshl_add_u32 v5, v6, 5, v5
    v_and_b32 v6, 3, v3
    v_lshl_add_u32 v5, v6, 3, v5
    v_add_u32 v17, 8192, v5
    v_mul_u32_u24 v9, 3, v2
    v_add_u32 v9, 2, v9
    v_lshrrev_b32 v5, 2, v3
    v_lshl_add_u32 v5, v4, 3, v5
    v_bfe_u32 v6, v5, 1, 1
    v_bfe_u32 v7, v5, 3, 1
    v_lshl_or_b32 v6, v7, 1, v6
    v_xor_b32 v6, v6, v9
    v_mul_u32_u24 v5, 384, v5
    v_lshl_add_u32 v5, v6, 5, v5
    v_and_b32 v6, 3, v3
    v_lshl_add_u32 v5, v6, 3, v5
    v_add_u32 v18, 8192, v5
    v_add_u32 v212, 32768, v14
    v_add_u32 v213, 32768, v15
    v_add_u32 v214, 32768, v16
    v_add_u32 v215, 32768, v17
    v_add_u32 v216, 32768, v18
    v_add_u32 v217, 65536, v14
    v_add_u32 v218, 65536, v15
    v_add_u32 v219, 65536, v16
    v_add_u32 v220, 65536, v17
    v_add_u32 v221, 65536, v18
    v_add_u32 v222, 98304, v14
    v_add_u32 v223, 98304, v15
    v_add_u32 v224, 98304, v16
    v_add_u32 v225, 98304, v17
    v_add_u32 v226, 98304, v18
    v_mov_b32 v120, 0
    v_mov_b32 v121, 0
    v_mov_b32 v122, 0
    v_mov_b32 v123, 0
    v_mov_b32 v124, 0
    v_mov_b32 v125, 0
    v_mov_b32 v126, 0
    v_mov_b32 v127, 0
    v_mov_b32 v128, 0
    v_mov_b32 v129, 0
    v_mov_b32 v130, 0
    v_mov_b32 v131, 0
    v_mov_b32 v132, 0
    v_mov_b32 v133, 0
    v_mov_b32 v134, 0
    v_mov_b32 v135, 0
    v_mov_b32 v136, 0
    v_mov_b32 v137, 0
    v_mov_b32 v138, 0
    v_mov_b32 v139, 0
    v_mov_b32 v140, 0
    v_mov_b32 v141, 0
    v_mov_b32 v142, 0
    v_mov_b32 v143, 0
    v_mov_b32 v144, 0
    v_mov_b32 v145, 0
    v_mov_b32 v146, 0
    v_mov_b32 v147, 0
    v_mov_b32 v148, 0
    v_mov_b32 v149, 0
    v_mov_b32 v150, 0
    v_mov_b32 v151, 0
    v_mov_b32 v152, 0
    v_mov_b32 v153, 0
    v_mov_b32 v154, 0
    v_mov_b32 v155, 0
    v_mov_b32 v156, 0
    v_mov_b32 v157, 0
    v_mov_b32 v158, 0
    v_mov_b32 v159, 0
    v_mov_b32 v160, 0
    v_mov_b32 v161, 0
    v_mov_b32 v162, 0
    v_mov_b32 v163, 0
    v_mov_b32 v164, 0
    v_mov_b32 v165, 0
    v_mov_b32 v166, 0
    v_mov_b32 v167, 0
    v_mov_b32 v168, 0
    v_mov_b32 v169, 0
    v_mov_b32 v170, 0
    v_mov_b32 v171, 0
    v_mov_b32 v172, 0
    v_mov_b32 v173, 0
    v_mov_b32 v174, 0
    v_mov_b32 v175, 0
    v_mov_b32 v176, 0
    v_mov_b32 v177, 0
    v_mov_b32 v178, 0
    v_mov_b32 v179, 0
    v_mov_b32 v180, s9
    v_mov_b32 v181, s9
    v_mov_b32 v182, s9
    v_mov_b32 v183, s9
    v_mov_b32 v32, 0
    v_mov_b32 v33, 0
    v_mov_b32 v34, 0
    v_mov_b32 v35, 0
    v_mov_b32 v36, 0
    v_mov_b32 v37, 0
    v_mov_b32 v38, 0
    v_mov_b32 v39, 0
    v_mov_b32 v40, 0
    v_mov_b32 v41, 0
    v_mov_b32 v42, 0
    v_mov_b32 v43, 0
    v_mov_b32 v44, 0
    v_mov_b32 v45, 0
    v_mov_b32 v46, 0
    v_mov_b32 v47, 0
    v_lshlrev_b32 v30, 11, v2
    s_barrier
    ds_read_b64_tr_b16 v[76:77], v16 offset:0
    ds_read_b64_tr_b16 v[78:79], v16 offset:1536
    ds_read_b64_tr_b16 v[80:81], v17 offset:0
    ds_read_b64_tr_b16 v[82:83], v17 offset:1536
    ds_read_b64_tr_b16 v[84:85], v18 offset:0
    ds_read_b64_tr_b16 v[86:87], v18 offset:1536
    ds_read_b128 v[56:59], v14 offset:0
    ds_read_b128 v[60:63], v14 offset:2048
    ds_read_b128 v[64:67], v14 offset:4096
    ds_read_b128 v[68:71], v14 offset:6144
    v_add_u32 v31, v30, v14
    ds_read_b128 v[196:199], v31
    s_waitcnt lgkmcnt(0)
    v_mfma_f32_16x16x32_bf16 v[168:171], v[76:79], v[180:183], v[168:171]
    ds_read_b64_tr_b16 v[108:109], v16 offset:12288
    ds_read_b64_tr_b16 v[110:111], v16 offset:13824
    v_mfma_f32_16x16x32_bf16 v[172:175], v[80:83], v[180:183], v[172:175]
    ds_read_b64_tr_b16 v[112:113], v17 offset:12288
    ds_read_b64_tr_b16 v[114:115], v17 offset:13824
    v_mfma_f32_16x16x32_bf16 v[176:179], v[84:87], v[180:183], v[176:179]
    ds_read_b64_tr_b16 v[116:117], v18 offset:12288
    ds_read_b64_tr_b16 v[118:119], v18 offset:13824
    v_mfma_f32_16x16x32_bf16 v[120:123], v[76:79], v[56:59], v[120:123]
    ds_read_b128 v[88:91], v15 offset:0
    ds_read_b128 v[92:95], v15 offset:2048
    v_mfma_f32_16x16x32_bf16 v[124:127], v[80:83], v[56:59], v[124:127]
    ds_read_b128 v[96:99], v15 offset:4096
    ds_read_b128 v[100:103], v15 offset:6144
    v_mfma_f32_16x16x32_bf16 v[128:131], v[84:87], v[56:59], v[128:131]
    v_add_u32 v31, v30, v15
    ds_read_b128 v[200:203], v31
    v_mfma_f32_16x16x32_bf16 v[132:135], v[76:79], v[60:63], v[132:135]
    v_mfma_f32_16x16x32_bf16 v[136:139], v[80:83], v[60:63], v[136:139]
    v_mfma_f32_16x16x32_bf16 v[140:143], v[84:87], v[60:63], v[140:143]
    v_mfma_f32_16x16x32_bf16 v[144:147], v[76:79], v[64:67], v[144:147]
    v_mfma_f32_16x16x32_bf16 v[148:151], v[80:83], v[64:67], v[148:151]
    v_mfma_f32_16x16x32_bf16 v[152:155], v[84:87], v[64:67], v[152:155]
    v_mfma_f32_16x16x32_bf16 v[156:159], v[76:79], v[68:71], v[156:159]
    v_mfma_f32_16x16x32_bf16 v[160:163], v[80:83], v[68:71], v[160:163]
    v_mfma_f32_16x16x32_bf16 v[164:167], v[84:87], v[68:71], v[164:167]
    v_mfma_f32_16x16x32_bf16 v[32:35], v[180:183], v[196:199], v[32:35]
    v_mfma_f32_16x16x32_bf16 v[36:39], v[196:199], v[196:199], v[36:39]
    s_waitcnt lgkmcnt(0)
    v_mfma_f32_16x16x32_bf16 v[168:171], v[108:111], v[180:183], v[168:171]
    v_mfma_f32_16x16x32_bf16 v[172:175], v[112:115], v[180:183], v[172:175]
    v_mfma_f32_16x16x32_bf16 v[176:179], v[116:119], v[180:183], v[176:179]
    v_mfma_f32_16x16x32_bf16 v[120:123], v[108:111], v[88:91], v[120:123]
    v_mfma_f32_16x16x32_bf16 v[124:127], v[112:115], v[88:91], v[124:127]
    v_mfma_f32_16x16x32_bf16 v[128:131], v[116:119], v[88:91], v[128:131]
    v_mfma_f32_16x16x32_bf16 v[132:135], v[108:111], v[92:95], v[132:135]
    v_mfma_f32_16x16x32_bf16 v[136:139], v[112:115], v[92:95], v[136:139]
    v_mfma_f32_16x16x32_bf16 v[140:143], v[116:119], v[92:95], v[140:143]
    v_mfma_f32_16x16x32_bf16 v[144:147], v[108:111], v[96:99], v[144:147]
    v_mfma_f32_16x16x32_bf16 v[148:151], v[112:115], v[96:99], v[148:151]
    v_mfma_f32_16x16x32_bf16 v[152:155], v[116:119], v[96:99], v[152:155]
    v_mfma_f32_16x16x32_bf16 v[156:159], v[108:111], v[100:103], v[156:159]
    v_mfma_f32_16x16x32_bf16 v[160:163], v[112:115], v[100:103], v[160:163]
    v_mfma_f32_16x16x32_bf16 v[164:167], v[116:119], v[100:103], v[164:167]
    v_mfma_f32_16x16x32_bf16 v[32:35], v[180:183], v[200:203], v[32:35]
    v_mfma_f32_16x16x32_bf16 v[36:39], v[200:203], v[200:203], v[36:39]
    s_barrier
    ds_read_b64_tr_b16 v[76:77], v214 offset:0
    ds_read_b64_tr_b16 v[78:79], v214 offset:1536
    ds_read_b64_tr_b16 v[80:81], v215 offset:0
    ds_read_b64_tr_b16 v[82:83], v215 offset:1536
    ds_read_b64_tr_b16 v[84:85], v216 offset:0
    ds_read_b64_tr_b16 v[86:87], v216 offset:1536
    ds_read_b128 v[56:59], v212 offset:0
    ds_read_b128 v[60:63], v212 offset:2048
    ds_read_b128 v[64:67], v212 offset:4096
    ds_read_b128 v[68:71], v212 offset:6144
    v_add_u32 v31, v30, v212
    ds_read_b128 v[196:199], v31
    s_waitcnt lgkmcnt(0)
    v_mfma_f32_16x16x32_bf16 v[168:171], v[76:79], v[180:183], v[168:171]
    ds_read_b64_tr_b16 v[108:109], v214 offset:12288
    ds_read_b64_tr_b16 v[110:111], v214 offset:13824
    v_mfma_f32_16x16x32_bf16 v[172:175], v[80:83], v[180:183], v[172:175]
    ds_read_b64_tr_b16 v[112:113], v215 offset:12288
    ds_read_b64_tr_b16 v[114:115], v215 offset:13824
    v_mfma_f32_16x16x32_bf16 v[176:179], v[84:87], v[180:183], v[176:179]
    ds_read_b64_tr_b16 v[116:117], v216 offset:12288
    ds_read_b64_tr_b16 v[118:119], v216 offset:13824
    v_mfma_f32_16x16x32_bf16 v[120:123], v[76:79], v[56:59], v[120:123]
    ds_read_b128 v[88:91], v213 offset:0
    ds_read_b128 v[92:95], v213 offset:2048
    v_mfma_f32_16x16x32_bf16 v[124:127], v[80:83], v[56:59], v[124:127]
    ds_read_b128 v[96:99], v213 offset:4096
    ds_read_b128 v[100:103], v213 offset:6144
    v_mfma_f32_16x16x32_bf16 v[128:131], v[84:87], v[56:59], v[128:131]
    v_add_u32 v31, v30, v213
    ds_read_b128 v[200:203], v31
    v_mfma_f32_16x16x32_bf16 v[132:135], v[76:79], v[60:63], v[132:135]
    v_mfma_f32_16x16x32_bf16 v[136:139], v[80:83], v[60:63], v[136:139]
    v_mfma_f32_16x16x32_bf16 v[140:143], v[84:87], v[60:63], v[140:143]
    v_mfma_f32_16x16x32_bf16 v[144:147], v[76:79], v[64:67], v[144:147]
    v_mfma_f32_16x16x32_bf16 v[148:151], v[80:83], v[64:67], v[148:151]
    v_mfma_f32_16x16x32_bf16 v[152:155], v[84:87], v[64:67], v[152:155]
    v_mfma_f32_16x16x32_bf16 v[156:159], v[76:79], v[68:71], v[156:159]
    v_mfma_f32_16x16x32_bf16 v[160:163], v[80:83], v[68:71], v[160:163]
    v_mfma_f32_16x16x32_bf16 v[164:167], v[84:87], v[68:71], v[164:167]
    v_mfma_f32_16x16x32_bf16 v[32:35], v[180:183], v[196:199], v[32:35]
    v_mfma_f32_16x16x32_bf16 v[36:39], v[196:199], v[196:199], v[36:39]
    s_waitcnt lgkmcnt(0)
    v_mfma_f32_16x16x32_bf16 v[168:171], v[108:111], v[180:183], v[168:171]
    ds_read_b64_tr_b16 v[76:77], v219 offset:0
    ds_read_b64_tr_b16 v[78:79], v219 offset:1536
    v_mfma_f32_16x16x32_bf16 v[172:175], v[112:115], v[180:183], v[172:175]
    ds_read_b64_tr_b16 v[80:81], v220 offset:0
    ds_read_b64_tr_b16 v[82:83], v220 offset:1536
    v_mfma_f32_16x16x32_bf16 v[176:179], v[116:119], v[180:183], v[176:179]
    ds_read_b64_tr_b16 v[84:85], v221 offset:0
    ds_read_b64_tr_b16 v[86:87], v221 offset:1536
    v_mfma_f32_16x16x32_bf16 v[120:123], v[108:111], v[88:91], v[120:123]
    ds_read_b128 v[56:59], v217 offset:0
    ds_read_b128 v[60:63], v217 offset:2048
    v_mfma_f32_16x16x32_bf16 v[124:127], v[112:115], v[88:91], v[124:127]
    ds_read_b128 v[64:67], v217 offset:4096
    ds_read_b128 v[68:71], v217 offset:6144
    v_mfma_f32_16x16x32_bf16 v[128:131], v[116:119], v[88:91], v[128:131]
    v_add_u32 v31, v30, v217
    ds_read_b128 v[196:199], v31
    v_mfma_f32_16x16x32_bf16 v[132:135], v[108:111], v[92:95], v[132:135]
    v_mfma_f32_16x16x32_bf16 v[136:139], v[112:115], v[92:95], v[136:139]
    v_mfma_f32_16x16x32_bf16 v[140:143], v[116:119], v[92:95], v[140:143]
    v_mfma_f32_16x16x32_bf16 v[144:147], v[108:111], v[96:99], v[144:147]
    v_mfma_f32_16x16x32_bf16 v[148:151], v[112:115], v[96:99], v[148:151]
    v_mfma_f32_16x16x32_bf16 v[152:155], v[116:119], v[96:99], v[152:155]
    v_mfma_f32_16x16x32_bf16 v[156:159], v[108:111], v[100:103], v[156:159]
    v_mfma_f32_16x16x32_bf16 v[160:163], v[112:115], v[100:103], v[160:163]
    v_mfma_f32_16x16x32_bf16 v[164:167], v[116:119], v[100:103], v[164:167]
    v_mfma_f32_16x16x32_bf16 v[32:35], v[180:183], v[200:203], v[32:35]
    v_mfma_f32_16x16x32_bf16 v[36:39], v[200:203], v[200:203], v[36:39]
    s_barrier
    s_waitcnt lgkmcnt(0)
    v_mfma_f32_16x16x32_bf16 v[168:171], v[76:79], v[180:183], v[168:171]
    ds_read_b64_tr_b16 v[108:109], v219 offset:12288
    ds_read_b64_tr_b16 v[110:111], v219 offset:13824
    v_mfma_f32_16x16x32_bf16 v[172:175], v[80:83], v[180:183], v[172:175]
    ds_read_b64_tr_b16 v[112:113], v220 offset:12288
    ds_read_b64_tr_b16 v[114:115], v220 offset:13824
    v_mfma_f32_16x16x32_bf16 v[176:179], v[84:87], v[180:183], v[176:179]
    ds_read_b64_tr_b16 v[116:117], v221 offset:12288
    ds_read_b64_tr_b16 v[118:119], v221 offset:13824
    v_mfma_f32_16x16x32_bf16 v[120:123], v[76:79], v[56:59], v[120:123]
    ds_read_b128 v[88:91], v218 offset:0
    ds_read_b128 v[92:95], v218 offset:2048
    v_mfma_f32_16x16x32_bf16 v[124:127], v[80:83], v[56:59], v[124:127]
    ds_read_b128 v[96:99], v218 offset:4096
    ds_read_b128 v[100:103], v218 offset:6144
    v_mfma_f32_16x16x32_bf16 v[128:131], v[84:87], v[56:59], v[128:131]
    v_add_u32 v31, v30, v218
    ds_read_b128 v[200:203], v31
    v_mfma_f32_16x16x32_bf16 v[132:135], v[76:79], v[60:63], v[132:135]
    v_mfma_f32_16x16x32_bf16 v[136:139], v[80:83], v[60:63], v[136:139]
    v_mfma_f32_16x16x32_bf16 v[140:143], v[84:87], v[60:63], v[140:143]
    v_mfma_f32_16x16x32_bf16 v[144:147], v[76:79], v[64:67], v[144:147]
    v_mfma_f32_16x16x32_bf16 v[148:151], v[80:83], v[64:67], v[148:151]
    v_mfma_f32_16x16x32_bf16 v[152:155], v[84:87], v[64:67], v[152:155]
    v_mfma_f32_16x16x32_bf16 v[156:159], v[76:79], v[68:71], v[156:159]
    v_mfma_f32_16x16x32_bf16 v[160:163], v[80:83], v[68:71], v[160:163]
    v_mfma_f32_16x16x32_bf16 v[164:167], v[84:87], v[68:71], v[164:167]
    v_mfma_f32_16x16x32_bf16 v[32:35], v[180:183], v[196:199], v[32:35]
    v_mfma_f32_16x16x32_bf16 v[36:39], v[196:199], v[196:199], v[36:39]
    s_waitcnt lgkmcnt(0)
    v_mfma_f32_16x16x32_bf16 v[168:171], v[108:111], v[180:183], v[168:171]
    ds_read_b64_tr_b16 v[76:77], v224 offset:0
    ds_read_b64_tr_b16 v[78:79], v224 offset:1536
    v_mfma_f32_16x16x32_bf16 v[172:175], v[112:115], v[180:183], v[172:175]
    ds_read_b64_tr_b16 v[80:81], v225 offset:0
    ds_read_b64_tr_b16 v[82:83], v225 offset:1536
    v_mfma_f32_16x16x32_bf16 v[176:179], v[116:119], v[180:183], v[176:179]
    ds_read_b64_tr_b16 v[84:85], v226 offset:0
    ds_read_b64_tr_b16 v[86:87], v226 offset:1536
    v_mfma_f32_16x16x32_bf16 v[120:123], v[108:111], v[88:91], v[120:123]
    ds_read_b128 v[56:59], v222 offset:0
    ds_read_b128 v[60:63], v222 offset:2048
    v_mfma_f32_16x16x32_bf16 v[124:127], v[112:115], v[88:91], v[124:127]
    ds_read_b128 v[64:67], v222 offset:4096
    ds_read_b128 v[68:71], v222 offset:6144
    v_mfma_f32_16x16x32_bf16 v[128:131], v[116:119], v[88:91], v[128:131]
    v_add_u32 v31, v30, v222
    ds_read_b128 v[196:199], v31
    v_mfma_f32_16x16x32_bf16 v[132:135], v[108:111], v[92:95], v[132:135]
    v_mfma_f32_16x16x32_bf16 v[136:139], v[112:115], v[92:95], v[136:139]
    v_mfma_f32_16x16x32_bf16 v[140:143], v[116:119], v[92:95], v[140:143]
    v_mfma_f32_16x16x32_bf16 v[144:147], v[108:111], v[96:99], v[144:147]
    v_mfma_f32_16x16x32_bf16 v[148:151], v[112:115], v[96:99], v[148:151]
    v_mfma_f32_16x16x32_bf16 v[152:155], v[116:119], v[96:99], v[152:155]
    v_mfma_f32_16x16x32_bf16 v[156:159], v[108:111], v[100:103], v[156:159]
    v_mfma_f32_16x16x32_bf16 v[160:163], v[112:115], v[100:103], v[160:163]
    v_mfma_f32_16x16x32_bf16 v[164:167], v[116:119], v[100:103], v[164:167]
    v_mfma_f32_16x16x32_bf16 v[32:35], v[180:183], v[200:203], v[32:35]
    v_mfma_f32_16x16x32_bf16 v[36:39], v[200:203], v[200:203], v[36:39]
    s_barrier
    s_waitcnt lgkmcnt(0)
    v_mfma_f32_16x16x32_bf16 v[168:171], v[76:79], v[180:183], v[168:171]
    ds_read_b64_tr_b16 v[108:109], v224 offset:12288
    ds_read_b64_tr_b16 v[110:111], v224 offset:13824
    v_mfma_f32_16x16x32_bf16 v[172:175], v[80:83], v[180:183], v[172:175]
    ds_read_b64_tr_b16 v[112:113], v225 offset:12288
    ds_read_b64_tr_b16 v[114:115], v225 offset:13824
    v_mfma_f32_16x16x32_bf16 v[176:179], v[84:87], v[180:183], v[176:179]
    ds_read_b64_tr_b16 v[116:117], v226 offset:12288
    ds_read_b64_tr_b16 v[118:119], v226 offset:13824
    v_mfma_f32_16x16x32_bf16 v[120:123], v[76:79], v[56:59], v[120:123]
    ds_read_b128 v[88:91], v223 offset:0
    ds_read_b128 v[92:95], v223 offset:2048
    v_mfma_f32_16x16x32_bf16 v[124:127], v[80:83], v[56:59], v[124:127]
    ds_read_b128 v[96:99], v223 offset:4096
    ds_read_b128 v[100:103], v223 offset:6144
    v_mfma_f32_16x16x32_bf16 v[128:131], v[84:87], v[56:59], v[128:131]
    v_add_u32 v31, v30, v223
    ds_read_b128 v[200:203], v31
    v_mfma_f32_16x16x32_bf16 v[132:135], v[76:79], v[60:63], v[132:135]
    v_mfma_f32_16x16x32_bf16 v[136:139], v[80:83], v[60:63], v[136:139]
    v_mfma_f32_16x16x32_bf16 v[140:143], v[84:87], v[60:63], v[140:143]
    v_mfma_f32_16x16x32_bf16 v[144:147], v[76:79], v[64:67], v[144:147]
    v_mfma_f32_16x16x32_bf16 v[148:151], v[80:83], v[64:67], v[148:151]
    v_mfma_f32_16x16x32_bf16 v[152:155], v[84:87], v[64:67], v[152:155]
    v_mfma_f32_16x16x32_bf16 v[156:159], v[76:79], v[68:71], v[156:159]
    v_mfma_f32_16x16x32_bf16 v[160:163], v[80:83], v[68:71], v[160:163]
    v_mfma_f32_16x16x32_bf16 v[164:167], v[84:87], v[68:71], v[164:167]
    v_mfma_f32_16x16x32_bf16 v[32:35], v[180:183], v[196:199], v[32:35]
    v_mfma_f32_16x16x32_bf16 v[36:39], v[196:199], v[196:199], v[36:39]
    s_waitcnt lgkmcnt(0)
    v_mfma_f32_16x16x32_bf16 v[168:171], v[108:111], v[180:183], v[168:171]
    ds_read_b64_tr_b16 v[76:77], v16 offset:0
    ds_read_b64_tr_b16 v[78:79], v16 offset:1536
    v_mfma_f32_16x16x32_bf16 v[172:175], v[112:115], v[180:183], v[172:175]
    ds_read_b64_tr_b16 v[80:81], v17 offset:0
    ds_read_b64_tr_b16 v[82:83], v17 offset:1536
    v_mfma_f32_16x16x32_bf16 v[176:179], v[116:119], v[180:183], v[176:179]
    ds_read_b64_tr_b16 v[84:85], v18 offset:0
    ds_read_b64_tr_b16 v[86:87], v18 offset:1536
    v_mfma_f32_16x16x32_bf16 v[120:123], v[108:111], v[88:91], v[120:123]
    ds_read_b128 v[56:59], v14 offset:0
    ds_read_b128 v[60:63], v14 offset:2048
    v_mfma_f32_16x16x32_bf16 v[124:127], v[112:115], v[88:91], v[124:127]
    ds_read_b128 v[64:67], v14 offset:4096
    ds_read_b128 v[68:71], v14 offset:6144
    v_mfma_f32_16x16x32_bf16 v[128:131], v[116:119], v[88:91], v[128:131]
    v_add_u32 v31, v30, v14
    ds_read_b128 v[196:199], v31
    v_mfma_f32_16x16x32_bf16 v[132:135], v[108:111], v[92:95], v[132:135]
    v_mfma_f32_16x16x32_bf16 v[136:139], v[112:115], v[92:95], v[136:139]
    v_mfma_f32_16x16x32_bf16 v[140:143], v[116:119], v[92:95], v[140:143]
    v_mfma_f32_16x16x32_bf16 v[144:147], v[108:111], v[96:99], v[144:147]
    v_mfma_f32_16x16x32_bf16 v[148:151], v[112:115], v[96:99], v[148:151]
    v_mfma_f32_16x16x32_bf16 v[152:155], v[116:119], v[96:99], v[152:155]
    v_mfma_f32_16x16x32_bf16 v[156:159], v[108:111], v[100:103], v[156:159]
    v_mfma_f32_16x16x32_bf16 v[160:163], v[112:115], v[100:103], v[160:163]
    v_mfma_f32_16x16x32_bf16 v[164:167], v[116:119], v[100:103], v[164:167]
    v_mfma_f32_16x16x32_bf16 v[32:35], v[180:183], v[200:203], v[32:35]
    v_mfma_f32_16x16x32_bf16 v[36:39], v[200:203], v[200:203], v[36:39]
    s_barrier
    s_waitcnt lgkmcnt(0)
    v_mfma_f32_16x16x32_bf16 v[168:171], v[76:79], v[180:183], v[168:171]
    ds_read_b64_tr_b16 v[108:109], v16 offset:12288
    ds_read_b64_tr_b16 v[110:111], v16 offset:13824
    v_mfma_f32_16x16x32_bf16 v[172:175], v[80:83], v[180:183], v[172:175]
    ds_read_b64_tr_b16 v[112:113], v17 offset:12288
    ds_read_b64_tr_b16 v[114:115], v17 offset:13824
    v_mfma_f32_16x16x32_bf16 v[176:179], v[84:87], v[180:183], v[176:179]
    ds_read_b64_tr_b16 v[116:117], v18 offset:12288
    ds_read_b64_tr_b16 v[118:119], v18 offset:13824
    v_mfma_f32_16x16x32_bf16 v[120:123], v[76:79], v[56:59], v[120:123]
    ds_read_b128 v[88:91], v15 offset:0
    ds_read_b128 v[92:95], v15 offset:2048
    v_mfma_f32_16x16x32_bf16 v[124:127], v[80:83], v[56:59], v[124:127]
    ds_read_b128 v[96:99], v15 offset:4096
    ds_read_b128 v[100:103], v15 offset:6144
    v_mfma_f32_16x16x32_bf16 v[128:131], v[84:87], v[56:59], v[128:131]
    v_add_u32 v31, v30, v15
    ds_read_b128 v[200:203], v31
    v_mfma_f32_16x16x32_bf16 v[132:135], v[76:79], v[60:63], v[132:135]
    v_mfma_f32_16x16x32_bf16 v[136:139], v[80:83], v[60:63], v[136:139]
    v_mfma_f32_16x16x32_bf16 v[140:143], v[84:87], v[60:63], v[140:143]
    v_mfma_f32_16x16x32_bf16 v[144:147], v[76:79], v[64:67], v[144:147]
    v_mfma_f32_16x16x32_bf16 v[148:151], v[80:83], v[64:67], v[148:151]
    v_mfma_f32_16x16x32_bf16 v[152:155], v[84:87], v[64:67], v[152:155]
    v_mfma_f32_16x16x32_bf16 v[156:159], v[76:79], v[68:71], v[156:159]
    v_mfma_f32_16x16x32_bf16 v[160:163], v[80:83], v[68:71], v[160:163]
    v_mfma_f32_16x16x32_bf16 v[164:167], v[84:87], v[68:71], v[164:167]
    v_mfma_f32_16x16x32_bf16 v[32:35], v[180:183], v[196:199], v[32:35]
    v_mfma_f32_16x16x32_bf16 v[36:39], v[196:199], v[196:199], v[36:39]
    s_waitcnt lgkmcnt(0)
    v_mfma_f32_16x16x32_bf16 v[168:171], v[108:111], v[180:183], v[168:171]
    ds_read_b64_tr_b16 v[76:77], v214 offset:0
    ds_read_b64_tr_b16 v[78:79], v214 offset:1536
    v_mfma_f32_16x16x32_bf16 v[172:175], v[112:115], v[180:183], v[172:175]
    ds_read_b64_tr_b16 v[80:81], v215 offset:0
    ds_read_b64_tr_b16 v[82:83], v215 offset:1536
    v_mfma_f32_16x16x32_bf16 v[176:179], v[116:119], v[180:183], v[176:179]
    ds_read_b64_tr_b16 v[84:85], v216 offset:0
    ds_read_b64_tr_b16 v[86:87], v216 offset:1536
    v_mfma_f32_16x16x32_bf16 v[120:123], v[108:111], v[88:91], v[120:123]
    ds_read_b128 v[56:59], v212 offset:0
    ds_read_b128 v[60:63], v212 offset:2048
    v_mfma_f32_16x16x32_bf16 v[124:127], v[112:115], v[88:91], v[124:127]
    ds_read_b128 v[64:67], v212 offset:4096
    ds_read_b128 v[68:71], v212 offset:6144
    v_mfma_f32_16x16x32_bf16 v[128:131], v[116:119], v[88:91], v[128:131]
    v_add_u32 v31, v30, v212
    ds_read_b128 v[196:199], v31
    v_mfma_f32_16x16x32_bf16 v[132:135], v[108:111], v[92:95], v[132:135]
    v_mfma_f32_16x16x32_bf16 v[136:139], v[112:115], v[92:95], v[136:139]
    v_mfma_f32_16x16x32_bf16 v[140:143], v[116:119], v[92:95], v[140:143]
    v_mfma_f32_16x16x32_bf16 v[144:147], v[108:111], v[96:99], v[144:147]
    v_mfma_f32_16x16x32_bf16 v[148:151], v[112:115], v[96:99], v[148:151]
    v_mfma_f32_16x16x32_bf16 v[152:155], v[116:119], v[96:99], v[152:155]
    v_mfma_f32_16x16x32_bf16 v[156:159], v[108:111], v[100:103], v[156:159]
    v_mfma_f32_16x16x32_bf16 v[160:163], v[112:115], v[100:103], v[160:163]
    v_mfma_f32_16x16x32_bf16 v[164:167], v[116:119], v[100:103], v[164:167]
    v_mfma_f32_16x16x32_bf16 v[32:35], v[180:183], v[200:203], v[32:35]
    v_mfma_f32_16x16x32_bf16 v[36:39], v[200:203], v[200:203], v[36:39]
    s_barrier
    s_waitcnt lgkmcnt(0)
    v_mfma_f32_16x16x32_bf16 v[168:171], v[76:79], v[180:183], v[168:171]
    ds_read_b64_tr_b16 v[108:109], v214 offset:12288
    ds_read_b64_tr_b16 v[110:111], v214 offset:13824
    v_mfma_f32_16x16x32_bf16 v[172:175], v[80:83], v[180:183], v[172:175]
    ds_read_b64_tr_b16 v[112:113], v215 offset:12288
    ds_read_b64_tr_b16 v[114:115], v215 offset:13824
    v_mfma_f32_16x16x32_bf16 v[176:179], v[84:87], v[180:183], v[176:179]
    ds_read_b64_tr_b16 v[116:117], v216 offset:12288
    ds_read_b64_tr_b16 v[118:119], v216 offset:13824
    v_mfma_f32_16x16x32_bf16 v[120:123], v[76:79], v[56:59], v[120:123]
    ds_read_b128 v[88:91], v213 offset:0
    ds_read_b128 v[92:95], v213 offset:2048
    v_mfma_f32_16x16x32_bf16 v[124:127], v[80:83], v[56:59], v[124:127]
    ds_read_b128 v[96:99], v213 offset:4096
    ds_read_b128 v[100:103], v213 offset:6144
    v_mfma_f32_16x16x32_bf16 v[128:131], v[84:87], v[56:59], v[128:131]
    v_add_u32 v31, v30, v213
    ds_read_b128 v[200:203], v31
    v_mfma_f32_16x16x32_bf16 v[132:135], v[76:79], v[60:63], v[132:135]
    v_mfma_f32_16x16x32_bf16 v[136:139], v[80:83], v[60:63], v[136:139]
    v_mfma_f32_16x16x32_bf16 v[140:143], v[84:87], v[60:63], v[140:143]
    v_mfma_f32_16x16x32_bf16 v[144:147], v[76:79], v[64:67], v[144:147]
    v_mfma_f32_16x16x32_bf16 v[148:151], v[80:83], v[64:67], v[148:151]
    v_mfma_f32_16x16x32_bf16 v[152:155], v[84:87], v[64:67], v[152:155]
    v_mfma_f32_16x16x32_bf16 v[156:159], v[76:79], v[68:71], v[156:159]
    v_mfma_f32_16x16x32_bf16 v[160:163], v[80:83], v[68:71], v[160:163]
    v_mfma_f32_16x16x32_bf16 v[164:167], v[84:87], v[68:71], v[164:167]
    v_mfma_f32_16x16x32_bf16 v[32:35], v[180:183], v[196:199], v[32:35]
    v_mfma_f32_16x16x32_bf16 v[36:39], v[196:199], v[196:199], v[36:39]
    s_waitcnt lgkmcnt(0)
    v_mfma_f32_16x16x32_bf16 v[168:171], v[108:111], v[180:183], v[168:171]
    ds_read_b64_tr_b16 v[76:77], v219 offset:0
    ds_read_b64_tr_b16 v[78:79], v219 offset:1536
    v_mfma_f32_16x16x32_bf16 v[172:175], v[112:115], v[180:183], v[172:175]
    ds_read_b64_tr_b16 v[80:81], v220 offset:0
    ds_read_b64_tr_b16 v[82:83], v220 offset:1536
    v_mfma_f32_16x16x32_bf16 v[176:179], v[116:119], v[180:183], v[176:179]
    ds_read_b64_tr_b16 v[84:85], v221 offset:0
    ds_read_b64_tr_b16 v[86:87], v221 offset:1536
    v_mfma_f32_16x16x32_bf16 v[120:123], v[108:111], v[88:91], v[120:123]
    ds_read_b128 v[56:59], v217 offset:0
    ds_read_b128 v[60:63], v217 offset:2048
    v_mfma_f32_16x16x32_bf16 v[124:127], v[112:115], v[88:91], v[124:127]
    ds_read_b128 v[64:67], v217 offset:4096
    ds_read_b128 v[68:71], v217 offset:6144
    v_mfma_f32_16x16x32_bf16 v[128:131], v[116:119], v[88:91], v[128:131]
    v_add_u32 v31, v30, v217
    ds_read_b128 v[196:199], v31
    v_mfma_f32_16x16x32_bf16 v[132:135], v[108:111], v[92:95], v[132:135]
    v_mfma_f32_16x16x32_bf16 v[136:139], v[112:115], v[92:95], v[136:139]
    v_mfma_f32_16x16x32_bf16 v[140:143], v[116:119], v[92:95], v[140:143]
    v_mfma_f32_16x16x32_bf16 v[144:147], v[108:111], v[96:99], v[144:147]
    v_mfma_f32_16x16x32_bf16 v[148:151], v[112:115], v[96:99], v[148:151]
    v_mfma_f32_16x16x32_bf16 v[152:155], v[116:119], v[96:99], v[152:155]
    v_mfma_f32_16x16x32_bf16 v[156:159], v[108:111], v[100:103], v[156:159]
    v_mfma_f32_16x16x32_bf16 v[160:163], v[112:115], v[100:103], v[160:163]
    v_mfma_f32_16x16x32_bf16 v[164:167], v[116:119], v[100:103], v[164:167]
    v_mfma_f32_16x16x32_bf16 v[32:35], v[180:183], v[200:203], v[32:35]
    v_mfma_f32_16x16x32_bf16 v[36:39], v[200:203], v[200:203], v[36:39]
    s_barrier
    s_waitcnt lgkmcnt(0)
    v_mfma_f32_16x16x32_bf16 v[168:171], v[76:79], v[180:183], v[168:171]
    ds_read_b64_tr_b16 v[108:109], v219 offset:12288
    ds_read_b64_tr_b16 v[110:111], v219 offset:13824
    v_mfma_f32_16x16x32_bf16 v[172:175], v[80:83], v[180:183], v[172:175]
    ds_read_b64_tr_b16 v[112:113], v220 offset:12288
    ds_read_b64_tr_b16 v[114:115], v220 offset:13824
    v_mfma_f32_16x16x32_bf16 v[176:179], v[84:87], v[180:183], v[176:179]
    ds_read_b64_tr_b16 v[116:117], v221 offset:12288
    ds_read_b64_tr_b16 v[118:119], v221 offset:13824
    v_mfma_f32_16x16x32_bf16 v[120:123], v[76:79], v[56:59], v[120:123]
    ds_read_b128 v[88:91], v218 offset:0
    ds_read_b128 v[92:95], v218 offset:2048
    v_mfma_f32_16x16x32_bf16 v[124:127], v[80:83], v[56:59], v[124:127]
    ds_read_b128 v[96:99], v218 offset:4096
    ds_read_b128 v[100:103], v218 offset:6144
    v_mfma_f32_16x16x32_bf16 v[128:131], v[84:87], v[56:59], v[128:131]
    v_add_u32 v31, v30, v218
    ds_read_b128 v[200:203], v31
    v_mfma_f32_16x16x32_bf16 v[132:135], v[76:79], v[60:63], v[132:135]
    v_mfma_f32_16x16x32_bf16 v[136:139], v[80:83], v[60:63], v[136:139]
    v_mfma_f32_16x16x32_bf16 v[140:143], v[84:87], v[60:63], v[140:143]
    v_mfma_f32_16x16x32_bf16 v[144:147], v[76:79], v[64:67], v[144:147]
    v_mfma_f32_16x16x32_bf16 v[148:151], v[80:83], v[64:67], v[148:151]
    v_mfma_f32_16x16x32_bf16 v[152:155], v[84:87], v[64:67], v[152:155]
    v_mfma_f32_16x16x32_bf16 v[156:159], v[76:79], v[68:71], v[156:159]
    v_mfma_f32_16x16x32_bf16 v[160:163], v[80:83], v[68:71], v[160:163]
    v_mfma_f32_16x16x32_bf16 v[164:167], v[84:87], v[68:71], v[164:167]
    v_mfma_f32_16x16x32_bf16 v[32:35], v[180:183], v[196:199], v[32:35]
    v_mfma_f32_16x16x32_bf16 v[36:39], v[196:199], v[196:199], v[36:39]
    s_waitcnt lgkmcnt(0)
    v_mfma_f32_16x16x32_bf16 v[168:171], v[108:111], v[180:183], v[168:171]
    ds_read_b64_tr_b16 v[76:77], v224 offset:0
    ds_read_b64_tr_b16 v[78:79], v224 offset:1536
    v_mfma_f32_16x16x32_bf16 v[172:175], v[112:115], v[180:183], v[172:175]
    ds_read_b64_tr_b16 v[80:81], v225 offset:0
    ds_read_b64_tr_b16 v[82:83], v225 offset:1536
    v_mfma_f32_16x16x32_bf16 v[176:179], v[116:119], v[180:183], v[176:179]
    ds_read_b64_tr_b16 v[84:85], v226 offset:0
    ds_read_b64_tr_b16 v[86:87], v226 offset:1536
    v_mfma_f32_16x16x32_bf16 v[120:123], v[108:111], v[88:91], v[120:123]
    ds_read_b128 v[56:59], v222 offset:0
    ds_read_b128 v[60:63], v222 offset:2048
    v_mfma_f32_16x16x32_bf16 v[124:127], v[112:115], v[88:91], v[124:127]
    ds_read_b128 v[64:67], v222 offset:4096
    ds_read_b128 v[68:71], v222 offset:6144
    v_mfma_f32_16x16x32_bf16 v[128:131], v[116:119], v[88:91], v[128:131]
    v_add_u32 v31, v30, v222
    ds_read_b128 v[196:199], v31
    v_mfma_f32_16x16x32_bf16 v[132:135], v[108:111], v[92:95], v[132:135]
    v_mfma_f32_16x16x32_bf16 v[136:139], v[112:115], v[92:95], v[136:139]
    v_mfma_f32_16x16x32_bf16 v[140:143], v[116:119], v[92:95], v[140:143]
    v_mfma_f32_16x16x32_bf16 v[144:147], v[108:111], v[96:99], v[144:147]
    v_mfma_f32_16x16x32_bf16 v[148:151], v[112:115], v[96:99], v[148:151]
    v_mfma_f32_16x16x32_bf16 v[152:155], v[116:119], v[96:99], v[152:155]
    v_mfma_f32_16x16x32_bf16 v[156:159], v[108:111], v[100:103], v[156:159]
    v_mfma_f32_16x16x32_bf16 v[160:163], v[112:115], v[100:103], v[160:163]
    v_mfma_f32_16x16x32_bf16 v[164:167], v[116:119], v[100:103], v[164:167]
    v_mfma_f32_16x16x32_bf16 v[32:35], v[180:183], v[200:203], v[32:35]
    v_mfma_f32_16x16x32_bf16 v[36:39], v[200:203], v[200:203], v[36:39]
    s_barrier
    s_waitcnt lgkmcnt(0)
    v_mfma_f32_16x16x32_bf16 v[168:171], v[76:79], v[180:183], v[168:171]
    ds_read_b64_tr_b16 v[108:109], v224 offset:12288
    ds_read_b64_tr_b16 v[110:111], v224 offset:13824
    v_mfma_f32_16x16x32_bf16 v[172:175], v[80:83], v[180:183], v[172:175]
    ds_read_b64_tr_b16 v[112:113], v225 offset:12288
    ds_read_b64_tr_b16 v[114:115], v225 offset:13824
    v_mfma_f32_16x16x32_bf16 v[176:179], v[84:87], v[180:183], v[176:179]
    ds_read_b64_tr_b16 v[116:117], v226 offset:12288
    ds_read_b64_tr_b16 v[118:119], v226 offset:13824
    v_mfma_f32_16x16x32_bf16 v[120:123], v[76:79], v[56:59], v[120:123]
    ds_read_b128 v[88:91], v223 offset:0
    ds_read_b128 v[92:95], v223 offset:2048
    v_mfma_f32_16x16x32_bf16 v[124:127], v[80:83], v[56:59], v[124:127]
    ds_read_b128 v[96:99], v223 offset:4096
    ds_read_b128 v[100:103], v223 offset:6144
    v_mfma_f32_16x16x32_bf16 v[128:131], v[84:87], v[56:59], v[128:131]
    v_add_u32 v31, v30, v223
    ds_read_b128 v[200:203], v31
    v_mfma_f32_16x16x32_bf16 v[132:135], v[76:79], v[60:63], v[132:135]
    v_mfma_f32_16x16x32_bf16 v[136:139], v[80:83], v[60:63], v[136:139]
    v_mfma_f32_16x16x32_bf16 v[140:143], v[84:87], v[60:63], v[140:143]
    v_mfma_f32_16x16x32_bf16 v[144:147], v[76:79], v[64:67], v[144:147]
    v_mfma_f32_16x16x32_bf16 v[148:151], v[80:83], v[64:67], v[148:151]
    v_mfma_f32_16x16x32_bf16 v[152:155], v[84:87], v[64:67], v[152:155]
    v_mfma_f32_16x16x32_bf16 v[156:159], v[76:79], v[68:71], v[156:159]
    v_mfma_f32_16x16x32_bf16 v[160:163], v[80:83], v[68:71], v[160:163]
    v_mfma_f32_16x16x32_bf16 v[164:167], v[84:87], v[68:71], v[164:167]
    v_mfma_f32_16x16x32_bf16 v[32:35], v[180:183], v[196:199], v[32:35]
    v_mfma_f32_16x16x32_bf16 v[36:39], v[196:199], v[196:199], v[36:39]
    s_waitcnt lgkmcnt(0)
    v_mfma_f32_16x16x32_bf16 v[168:171], v[108:111], v[180:183], v[168:171]
    v_mfma_f32_16x16x32_bf16 v[172:175], v[112:115], v[180:183], v[172:175]
    v_mfma_f32_16x16x32_bf16 v[176:179], v[116:119], v[180:183], v[176:179]
    v_mfma_f32_16x16x32_bf16 v[120:123], v[108:111], v[88:91], v[120:123]
    v_mfma_f32_16x16x32_bf16 v[124:127], v[112:115], v[88:91], v[124:127]
    v_mfma_f32_16x16x32_bf16 v[128:131], v[116:119], v[88:91], v[128:131]
    v_mfma_f32_16x16x32_bf16 v[132:135], v[108:111], v[92:95], v[132:135]
    v_mfma_f32_16x16x32_bf16 v[136:139], v[112:115], v[92:95], v[136:139]
    v_mfma_f32_16x16x32_bf16 v[140:143], v[116:119], v[92:95], v[140:143]
    v_mfma_f32_16x16x32_bf16 v[144:147], v[108:111], v[96:99], v[144:147]
    v_mfma_f32_16x16x32_bf16 v[148:151], v[112:115], v[96:99], v[148:151]
    v_mfma_f32_16x16x32_bf16 v[152:155], v[116:119], v[96:99], v[152:155]
    v_mfma_f32_16x16x32_bf16 v[156:159], v[108:111], v[100:103], v[156:159]
    v_mfma_f32_16x16x32_bf16 v[160:163], v[112:115], v[100:103], v[160:163]
    v_mfma_f32_16x16x32_bf16 v[164:167], v[116:119], v[100:103], v[164:167]
    v_mfma_f32_16x16x32_bf16 v[32:35], v[180:183], v[200:203], v[32:35]
    v_mfma_f32_16x16x32_bf16 v[36:39], v[200:203], v[200:203], v[36:39]
    s_nop 7
    v_lshrrev_b32 v5, 2, v3
    v_and_b32 v6, 3, v3
    v_cmp_eq_u32 s[60:61], v5, v4
    v_cmp_eq_u32 s[62:63], 1, v6
    v_cmp_eq_u32 s[64:65], 2, v6
    v_cmp_eq_u32 s[66:67], 3, v6
    s_nop 1
    v_cndmask_b32 v36, v36, v37, s[62:63]
    v_cndmask_b32 v36, v36, v38, s[64:65]
    v_cndmask_b32 v36, v36, v39, s[66:67]
    v_cndmask_b32 v36, 0, v36, s[60:61]
    v_mov_b32 v208, v36
    s_nop 1
    v_permlane16_swap_b32 v36, v208
    s_nop 0
    v_add_f32 v36, v36, v208
    v_mov_b32 v208, v36
    s_nop 1
    v_permlane32_swap_b32 v36, v208
    s_nop 0
    v_add_f32 v36, v36, v208
    v_mul_f32 v32, 0x3b000000, v32
    v_mul_f32 v36, 0x3b000000, v36
    v_fma_f32 v36, -v32, v32, v36
    v_max_f32 v36, 0, v36
    v_cvt_pk_bf16_f32 v208, v32, v32
    v_lshlrev_b32 v32, 16, v208
    v_cvt_pk_bf16_f32 v208, v36, v36
    v_lshlrev_b32 v36, 16, v208
    v_add_f32 v36, 0x3727c5ac, v36
    v_cvt_pk_bf16_f32 v208, v36, v36
    v_lshlrev_b32 v36, 16, v208
    v_sqrt_f32 v36, v36
    s_nop 0
    v_cvt_pk_bf16_f32 v208, v36, v36
    v_lshlrev_b32 v36, 16, v208
    v_rcp_f32 v52, v36
    s_nop 0
    v_mov_b32 v53, v52
    v_mul_f32 v54, v32, v52
    v_sub_f32 v54, 0, v54
    v_mov_b32 v55, v54
    v_mov_b32 v53, v54
    v_lshl_add_u32 v5, v2, 4, v3
    v_lshlrev_b32 v5, 3, v5
    v_add_u32 v5, 131072, v5
    ds_write_b64 v5, v[52:53]
    s_waitcnt lgkmcnt(0)
    s_barrier
    v_lshlrev_b32 v5, 3, v3
    v_lshlrev_b32 v6, 5, v4
    v_add_u32 v5, 131072, v5
    v_add_u32 v6, 131072, v6
    ds_read_b64 v[56:57], v5 offset:0
    ds_read_b64 v[58:59], v5 offset:128
    ds_read_b64 v[60:61], v5 offset:256
    ds_read_b64 v[62:63], v5 offset:384
    s_waitcnt lgkmcnt(0)
    s_nop 5
    v_mul_f32 v120, v120, v56
    v_fmac_f32 v120, v168, v57
    v_mul_f32 v121, v121, v56
    v_fmac_f32 v121, v169, v57
    v_mul_f32 v122, v122, v56
    v_fmac_f32 v122, v170, v57
    v_mul_f32 v123, v123, v56
    v_fmac_f32 v123, v171, v57
    v_mul_f32 v124, v124, v56
    v_fmac_f32 v124, v172, v57
    v_mul_f32 v125, v125, v56
    v_fmac_f32 v125, v173, v57
    v_mul_f32 v126, v126, v56
    v_fmac_f32 v126, v174, v57
    v_mul_f32 v127, v127, v56
    v_fmac_f32 v127, v175, v57
    v_mul_f32 v128, v128, v56
    v_fmac_f32 v128, v176, v57
    v_mul_f32 v129, v129, v56
    v_fmac_f32 v129, v177, v57
    v_mul_f32 v130, v130, v56
    v_fmac_f32 v130, v178, v57
    v_mul_f32 v131, v131, v56
    v_fmac_f32 v131, v179, v57
    v_mul_f32 v132, v132, v58
    v_fmac_f32 v132, v168, v59
    v_mul_f32 v133, v133, v58
    v_fmac_f32 v133, v169, v59
    v_mul_f32 v134, v134, v58
    v_fmac_f32 v134, v170, v59
    v_mul_f32 v135, v135, v58
    v_fmac_f32 v135, v171, v59
    v_mul_f32 v136, v136, v58
    v_fmac_f32 v136, v172, v59
    v_mul_f32 v137, v137, v58
    v_fmac_f32 v137, v173, v59
    v_mul_f32 v138, v138, v58
    v_fmac_f32 v138, v174, v59
    v_mul_f32 v139, v139, v58
    v_fmac_f32 v139, v175, v59
    v_mul_f32 v140, v140, v58
    v_fmac_f32 v140, v176, v59
    v_mul_f32 v141, v141, v58
    v_fmac_f32 v141, v177, v59
    v_mul_f32 v142, v142, v58
    v_fmac_f32 v142, v178, v59
    v_mul_f32 v143, v143, v58
    v_fmac_f32 v143, v179, v59
    v_mul_f32 v144, v144, v60
    v_fmac_f32 v144, v168, v61
    v_mul_f32 v145, v145, v60
    v_fmac_f32 v145, v169, v61
    v_mul_f32 v146, v146, v60
    v_fmac_f32 v146, v170, v61
    v_mul_f32 v147, v147, v60
    v_fmac_f32 v147, v171, v61
    v_mul_f32 v148, v148, v60
    v_fmac_f32 v148, v172, v61
    v_mul_f32 v149, v149, v60
    v_fmac_f32 v149, v173, v61
    v_mul_f32 v150, v150, v60
    v_fmac_f32 v150, v174, v61
    v_mul_f32 v151, v151, v60
    v_fmac_f32 v151, v175, v61
    v_mul_f32 v152, v152, v60
    v_fmac_f32 v152, v176, v61
    v_mul_f32 v153, v153, v60
    v_fmac_f32 v153, v177, v61
    v_mul_f32 v154, v154, v60
    v_fmac_f32 v154, v178, v61
    v_mul_f32 v155, v155, v60
    v_fmac_f32 v155, v179, v61
    v_mul_f32 v156, v156, v62
    v_fmac_f32 v156, v168, v63
    v_mul_f32 v157, v157, v62
    v_fmac_f32 v157, v169, v63
    v_mul_f32 v158, v158, v62
    v_fmac_f32 v158, v170, v63
    v_mul_f32 v159, v159, v62
    v_fmac_f32 v159, v171, v63
    v_mul_f32 v160, v160, v62
    v_fmac_f32 v160, v172, v63
    v_mul_f32 v161, v161, v62
    v_fmac_f32 v161, v173, v63
    v_mul_f32 v162, v162, v62
    v_fmac_f32 v162, v174, v63
    v_mul_f32 v163, v163, v62
    v_fmac_f32 v163, v175, v63
    v_mul_f32 v164, v164, v62
    v_fmac_f32 v164, v176, v63
    v_mul_f32 v165, v165, v62
    v_fmac_f32 v165, v177, v63
    v_mul_f32 v166, v166, v62
    v_fmac_f32 v166, v178, v63
    v_mul_f32 v167, v167, v62
    v_fmac_f32 v167, v179, v63
    s_lshr_b32 s12, s5, 2
    s_mul_i32 s12, s12, 3145728
    s_add_u32 s12, s12, 6291456
    s_add_u32 s48, s36, s12
    s_addc_u32 s49, s37, 0
    s_mov_b32 s50, 2818048
    s_mov_b32 s51, 0x00020000
    s_and_b32 s13, s5, 3
    s_mul_i32 s13, s13, 192
    s_mul_i32 s14, s3, 48
    s_add_u32 s13, s13, s14
    v_lshlrev_b32 v5, 2, v4
    v_add_u32 v5, s13, v5
    v_add_u32 v6, s6, v3
    v_mul_u32_u24 v6, 1376, v6
    v_lshl_add_u32 v6, v5, 1, v6
    s_mov_b32 s12, 0x3d372713
    s_mov_b32 s13, 0xc0135761
    v_mov_b32 v9, -1
    v_add_u32 v7, 0, v5
    v_cmp_gt_u32 vcc, 688, v7
    v_add_u32 v7, 0, v6
    s_nop 0
    v_cndmask_b32 v10, v9, v7, vcc
    v_add_u32 v7, 16, v5
    v_cmp_gt_u32 vcc, 688, v7
    v_add_u32 v7, 32, v6
    s_nop 0
    v_cndmask_b32 v11, v9, v7, vcc
    v_add_u32 v7, 32, v5
    v_cmp_gt_u32 vcc, 688, v7
    v_add_u32 v7, 64, v6
    s_nop 0
    v_cndmask_b32 v12, v9, v7, vcc
    v_cvt_pk_bf16_f32 v56, v120, v121
    v_lshlrev_b32 v120, 16, v56
    v_and_b32 v121, 0xffff0000, v56
    v_cvt_pk_bf16_f32 v56, v122, v123
    v_lshlrev_b32 v122, 16, v56
    v_and_b32 v123, 0xffff0000, v56
    v_mul_f32 v57, v120, v120
    v_mul_f32 v57, s12, v57
    v_fma_f32 v57, v57, v120, v120
    v_mul_f32 v57, s13, v57
    v_mul_f32 v58, v121, v121
    v_mul_f32 v58, s12, v58
    v_fma_f32 v58, v58, v121, v121
    v_mul_f32 v58, s13, v58
    v_mul_f32 v59, v122, v122
    v_mul_f32 v59, s12, v59
    v_fma_f32 v59, v59, v122, v122
    v_mul_f32 v59, s13, v59
    v_mul_f32 v60, v123, v123
    v_mul_f32 v60, s12, v60
    v_fma_f32 v60, v60, v123, v123
    v_mul_f32 v60, s13, v60
    v_exp_f32 v57, v57
    v_exp_f32 v58, v58
    v_exp_f32 v59, v59
    v_exp_f32 v60, v60
    s_nop 0
    v_add_f32 v57, 1.0, v57
    v_add_f32 v58, 1.0, v58
    v_add_f32 v59, 1.0, v59
    v_add_f32 v60, 1.0, v60
    v_rcp_f32 v57, v57
    v_rcp_f32 v58, v58
    v_rcp_f32 v59, v59
    v_rcp_f32 v60, v60
    s_nop 0
    v_mul_f32 v120, v120, v57
    v_mul_f32 v121, v121, v58
    v_mul_f32 v122, v122, v59
    v_mul_f32 v123, v123, v60
    v_cvt_pk_bf16_f32 v120, v120, v121
    v_cvt_pk_bf16_f32 v121, v122, v123
    s_mov_b32 s14, 0
    buffer_store_dwordx2 v[120:121], v10, s[48:51], s14 offen
    v_cvt_pk_bf16_f32 v56, v124, v125
    v_lshlrev_b32 v124, 16, v56
    v_and_b32 v125, 0xffff0000, v56
    v_cvt_pk_bf16_f32 v56, v126, v127
    v_lshlrev_b32 v126, 16, v56
    v_and_b32 v127, 0xffff0000, v56
    v_mul_f32 v57, v124, v124
    v_mul_f32 v57, s12, v57
    v_fma_f32 v57, v57, v124, v124
    v_mul_f32 v57, s13, v57
    v_mul_f32 v58, v125, v125
    v_mul_f32 v58, s12, v58
    v_fma_f32 v58, v58, v125, v125
    v_mul_f32 v58, s13, v58
    v_mul_f32 v59, v126, v126
    v_mul_f32 v59, s12, v59
    v_fma_f32 v59, v59, v126, v126
    v_mul_f32 v59, s13, v59
    v_mul_f32 v60, v127, v127
    v_mul_f32 v60, s12, v60
    v_fma_f32 v60, v60, v127, v127
    v_mul_f32 v60, s13, v60
    v_exp_f32 v57, v57
    v_exp_f32 v58, v58
    v_exp_f32 v59, v59
    v_exp_f32 v60, v60
    s_nop 0
    v_add_f32 v57, 1.0, v57
    v_add_f32 v58, 1.0, v58
    v_add_f32 v59, 1.0, v59
    v_add_f32 v60, 1.0, v60
    v_rcp_f32 v57, v57
    v_rcp_f32 v58, v58
    v_rcp_f32 v59, v59
    v_rcp_f32 v60, v60
    s_nop 0
    v_mul_f32 v124, v124, v57
    v_mul_f32 v125, v125, v58
    v_mul_f32 v126, v126, v59
    v_mul_f32 v127, v127, v60
    v_cvt_pk_bf16_f32 v124, v124, v125
    v_cvt_pk_bf16_f32 v125, v126, v127
    s_mov_b32 s14, 0
    buffer_store_dwordx2 v[124:125], v11, s[48:51], s14 offen
    v_cvt_pk_bf16_f32 v56, v128, v129
    v_lshlrev_b32 v128, 16, v56
    v_and_b32 v129, 0xffff0000, v56
    v_cvt_pk_bf16_f32 v56, v130, v131
    v_lshlrev_b32 v130, 16, v56
    v_and_b32 v131, 0xffff0000, v56
    v_mul_f32 v57, v128, v128
    v_mul_f32 v57, s12, v57
    v_fma_f32 v57, v57, v128, v128
    v_mul_f32 v57, s13, v57
    v_mul_f32 v58, v129, v129
    v_mul_f32 v58, s12, v58
    v_fma_f32 v58, v58, v129, v129
    v_mul_f32 v58, s13, v58
    v_mul_f32 v59, v130, v130
    v_mul_f32 v59, s12, v59
    v_fma_f32 v59, v59, v130, v130
    v_mul_f32 v59, s13, v59
    v_mul_f32 v60, v131, v131
    v_mul_f32 v60, s12, v60
    v_fma_f32 v60, v60, v131, v131
    v_mul_f32 v60, s13, v60
    v_exp_f32 v57, v57
    v_exp_f32 v58, v58
    v_exp_f32 v59, v59
    v_exp_f32 v60, v60
    s_nop 0
    v_add_f32 v57, 1.0, v57
    v_add_f32 v58, 1.0, v58
    v_add_f32 v59, 1.0, v59
    v_add_f32 v60, 1.0, v60
    v_rcp_f32 v57, v57
    v_rcp_f32 v58, v58
    v_rcp_f32 v59, v59
    v_rcp_f32 v60, v60
    s_nop 0
    v_mul_f32 v128, v128, v57
    v_mul_f32 v129, v129, v58
    v_mul_f32 v130, v130, v59
    v_mul_f32 v131, v131, v60
    v_cvt_pk_bf16_f32 v128, v128, v129
    v_cvt_pk_bf16_f32 v129, v130, v131
    s_mov_b32 s14, 0
    buffer_store_dwordx2 v[128:129], v12, s[48:51], s14 offen
    v_cvt_pk_bf16_f32 v56, v132, v133
    v_lshlrev_b32 v132, 16, v56
    v_and_b32 v133, 0xffff0000, v56
    v_cvt_pk_bf16_f32 v56, v134, v135
    v_lshlrev_b32 v134, 16, v56
    v_and_b32 v135, 0xffff0000, v56
    v_mul_f32 v57, v132, v132
    v_mul_f32 v57, s12, v57
    v_fma_f32 v57, v57, v132, v132
    v_mul_f32 v57, s13, v57
    v_mul_f32 v58, v133, v133
    v_mul_f32 v58, s12, v58
    v_fma_f32 v58, v58, v133, v133
    v_mul_f32 v58, s13, v58
    v_mul_f32 v59, v134, v134
    v_mul_f32 v59, s12, v59
    v_fma_f32 v59, v59, v134, v134
    v_mul_f32 v59, s13, v59
    v_mul_f32 v60, v135, v135
    v_mul_f32 v60, s12, v60
    v_fma_f32 v60, v60, v135, v135
    v_mul_f32 v60, s13, v60
    v_exp_f32 v57, v57
    v_exp_f32 v58, v58
    v_exp_f32 v59, v59
    v_exp_f32 v60, v60
    s_nop 0
    v_add_f32 v57, 1.0, v57
    v_add_f32 v58, 1.0, v58
    v_add_f32 v59, 1.0, v59
    v_add_f32 v60, 1.0, v60
    v_rcp_f32 v57, v57
    v_rcp_f32 v58, v58
    v_rcp_f32 v59, v59
    v_rcp_f32 v60, v60
    s_nop 0
    v_mul_f32 v132, v132, v57
    v_mul_f32 v133, v133, v58
    v_mul_f32 v134, v134, v59
    v_mul_f32 v135, v135, v60
    v_cvt_pk_bf16_f32 v132, v132, v133
    v_cvt_pk_bf16_f32 v133, v134, v135
    s_mov_b32 s14, 22016
    buffer_store_dwordx2 v[132:133], v10, s[48:51], s14 offen
    v_cvt_pk_bf16_f32 v56, v136, v137
    v_lshlrev_b32 v136, 16, v56
    v_and_b32 v137, 0xffff0000, v56
    v_cvt_pk_bf16_f32 v56, v138, v139
    v_lshlrev_b32 v138, 16, v56
    v_and_b32 v139, 0xffff0000, v56
    v_mul_f32 v57, v136, v136
    v_mul_f32 v57, s12, v57
    v_fma_f32 v57, v57, v136, v136
    v_mul_f32 v57, s13, v57
    v_mul_f32 v58, v137, v137
    v_mul_f32 v58, s12, v58
    v_fma_f32 v58, v58, v137, v137
    v_mul_f32 v58, s13, v58
    v_mul_f32 v59, v138, v138
    v_mul_f32 v59, s12, v59
    v_fma_f32 v59, v59, v138, v138
    v_mul_f32 v59, s13, v59
    v_mul_f32 v60, v139, v139
    v_mul_f32 v60, s12, v60
    v_fma_f32 v60, v60, v139, v139
    v_mul_f32 v60, s13, v60
    v_exp_f32 v57, v57
    v_exp_f32 v58, v58
    v_exp_f32 v59, v59
    v_exp_f32 v60, v60
    s_nop 0
    v_add_f32 v57, 1.0, v57
    v_add_f32 v58, 1.0, v58
    v_add_f32 v59, 1.0, v59
    v_add_f32 v60, 1.0, v60
    v_rcp_f32 v57, v57
    v_rcp_f32 v58, v58
    v_rcp_f32 v59, v59
    v_rcp_f32 v60, v60
    s_nop 0
    v_mul_f32 v136, v136, v57
    v_mul_f32 v137, v137, v58
    v_mul_f32 v138, v138, v59
    v_mul_f32 v139, v139, v60
    v_cvt_pk_bf16_f32 v136, v136, v137
    v_cvt_pk_bf16_f32 v137, v138, v139
    s_mov_b32 s14, 22016
    buffer_store_dwordx2 v[136:137], v11, s[48:51], s14 offen
    v_cvt_pk_bf16_f32 v56, v140, v141
    v_lshlrev_b32 v140, 16, v56
    v_and_b32 v141, 0xffff0000, v56
    v_cvt_pk_bf16_f32 v56, v142, v143
    v_lshlrev_b32 v142, 16, v56
    v_and_b32 v143, 0xffff0000, v56
    v_mul_f32 v57, v140, v140
    v_mul_f32 v57, s12, v57
    v_fma_f32 v57, v57, v140, v140
    v_mul_f32 v57, s13, v57
    v_mul_f32 v58, v141, v141
    v_mul_f32 v58, s12, v58
    v_fma_f32 v58, v58, v141, v141
    v_mul_f32 v58, s13, v58
    v_mul_f32 v59, v142, v142
    v_mul_f32 v59, s12, v59
    v_fma_f32 v59, v59, v142, v142
    v_mul_f32 v59, s13, v59
    v_mul_f32 v60, v143, v143
    v_mul_f32 v60, s12, v60
    v_fma_f32 v60, v60, v143, v143
    v_mul_f32 v60, s13, v60
    v_exp_f32 v57, v57
    v_exp_f32 v58, v58
    v_exp_f32 v59, v59
    v_exp_f32 v60, v60
    s_nop 0
    v_add_f32 v57, 1.0, v57
    v_add_f32 v58, 1.0, v58
    v_add_f32 v59, 1.0, v59
    v_add_f32 v60, 1.0, v60
    v_rcp_f32 v57, v57
    v_rcp_f32 v58, v58
    v_rcp_f32 v59, v59
    v_rcp_f32 v60, v60
    s_nop 0
    v_mul_f32 v140, v140, v57
    v_mul_f32 v141, v141, v58
    v_mul_f32 v142, v142, v59
    v_mul_f32 v143, v143, v60
    v_cvt_pk_bf16_f32 v140, v140, v141
    v_cvt_pk_bf16_f32 v141, v142, v143
    s_mov_b32 s14, 22016
    buffer_store_dwordx2 v[140:141], v12, s[48:51], s14 offen
    v_cvt_pk_bf16_f32 v56, v144, v145
    v_lshlrev_b32 v144, 16, v56
    v_and_b32 v145, 0xffff0000, v56
    v_cvt_pk_bf16_f32 v56, v146, v147
    v_lshlrev_b32 v146, 16, v56
    v_and_b32 v147, 0xffff0000, v56
    v_mul_f32 v57, v144, v144
    v_mul_f32 v57, s12, v57
    v_fma_f32 v57, v57, v144, v144
    v_mul_f32 v57, s13, v57
    v_mul_f32 v58, v145, v145
    v_mul_f32 v58, s12, v58
    v_fma_f32 v58, v58, v145, v145
    v_mul_f32 v58, s13, v58
    v_mul_f32 v59, v146, v146
    v_mul_f32 v59, s12, v59
    v_fma_f32 v59, v59, v146, v146
    v_mul_f32 v59, s13, v59
    v_mul_f32 v60, v147, v147
    v_mul_f32 v60, s12, v60
    v_fma_f32 v60, v60, v147, v147
    v_mul_f32 v60, s13, v60
    v_exp_f32 v57, v57
    v_exp_f32 v58, v58
    v_exp_f32 v59, v59
    v_exp_f32 v60, v60
    s_nop 0
    v_add_f32 v57, 1.0, v57
    v_add_f32 v58, 1.0, v58
    v_add_f32 v59, 1.0, v59
    v_add_f32 v60, 1.0, v60
    v_rcp_f32 v57, v57
    v_rcp_f32 v58, v58
    v_rcp_f32 v59, v59
    v_rcp_f32 v60, v60
    s_nop 0
    v_mul_f32 v144, v144, v57
    v_mul_f32 v145, v145, v58
    v_mul_f32 v146, v146, v59
    v_mul_f32 v147, v147, v60
    v_cvt_pk_bf16_f32 v144, v144, v145
    v_cvt_pk_bf16_f32 v145, v146, v147
    s_mov_b32 s14, 44032
    buffer_store_dwordx2 v[144:145], v10, s[48:51], s14 offen
    v_cvt_pk_bf16_f32 v56, v148, v149
    v_lshlrev_b32 v148, 16, v56
    v_and_b32 v149, 0xffff0000, v56
    v_cvt_pk_bf16_f32 v56, v150, v151
    v_lshlrev_b32 v150, 16, v56
    v_and_b32 v151, 0xffff0000, v56
    v_mul_f32 v57, v148, v148
    v_mul_f32 v57, s12, v57
    v_fma_f32 v57, v57, v148, v148
    v_mul_f32 v57, s13, v57
    v_mul_f32 v58, v149, v149
    v_mul_f32 v58, s12, v58
    v_fma_f32 v58, v58, v149, v149
    v_mul_f32 v58, s13, v58
    v_mul_f32 v59, v150, v150
    v_mul_f32 v59, s12, v59
    v_fma_f32 v59, v59, v150, v150
    v_mul_f32 v59, s13, v59
    v_mul_f32 v60, v151, v151
    v_mul_f32 v60, s12, v60
    v_fma_f32 v60, v60, v151, v151
    v_mul_f32 v60, s13, v60
    v_exp_f32 v57, v57
    v_exp_f32 v58, v58
    v_exp_f32 v59, v59
    v_exp_f32 v60, v60
    s_nop 0
    v_add_f32 v57, 1.0, v57
    v_add_f32 v58, 1.0, v58
    v_add_f32 v59, 1.0, v59
    v_add_f32 v60, 1.0, v60
    v_rcp_f32 v57, v57
    v_rcp_f32 v58, v58
    v_rcp_f32 v59, v59
    v_rcp_f32 v60, v60
    s_nop 0
    v_mul_f32 v148, v148, v57
    v_mul_f32 v149, v149, v58
    v_mul_f32 v150, v150, v59
    v_mul_f32 v151, v151, v60
    v_cvt_pk_bf16_f32 v148, v148, v149
    v_cvt_pk_bf16_f32 v149, v150, v151
    s_mov_b32 s14, 44032
    buffer_store_dwordx2 v[148:149], v11, s[48:51], s14 offen
    v_cvt_pk_bf16_f32 v56, v152, v153
    v_lshlrev_b32 v152, 16, v56
    v_and_b32 v153, 0xffff0000, v56
    v_cvt_pk_bf16_f32 v56, v154, v155
    v_lshlrev_b32 v154, 16, v56
    v_and_b32 v155, 0xffff0000, v56
    v_mul_f32 v57, v152, v152
    v_mul_f32 v57, s12, v57
    v_fma_f32 v57, v57, v152, v152
    v_mul_f32 v57, s13, v57
    v_mul_f32 v58, v153, v153
    v_mul_f32 v58, s12, v58
    v_fma_f32 v58, v58, v153, v153
    v_mul_f32 v58, s13, v58
    v_mul_f32 v59, v154, v154
    v_mul_f32 v59, s12, v59
    v_fma_f32 v59, v59, v154, v154
    v_mul_f32 v59, s13, v59
    v_mul_f32 v60, v155, v155
    v_mul_f32 v60, s12, v60
    v_fma_f32 v60, v60, v155, v155
    v_mul_f32 v60, s13, v60
    v_exp_f32 v57, v57
    v_exp_f32 v58, v58
    v_exp_f32 v59, v59
    v_exp_f32 v60, v60
    s_nop 0
    v_add_f32 v57, 1.0, v57
    v_add_f32 v58, 1.0, v58
    v_add_f32 v59, 1.0, v59
    v_add_f32 v60, 1.0, v60
    v_rcp_f32 v57, v57
    v_rcp_f32 v58, v58
    v_rcp_f32 v59, v59
    v_rcp_f32 v60, v60
    s_nop 0
    v_mul_f32 v152, v152, v57
    v_mul_f32 v153, v153, v58
    v_mul_f32 v154, v154, v59
    v_mul_f32 v155, v155, v60
    v_cvt_pk_bf16_f32 v152, v152, v153
    v_cvt_pk_bf16_f32 v153, v154, v155
    s_mov_b32 s14, 44032
    buffer_store_dwordx2 v[152:153], v12, s[48:51], s14 offen
    v_cvt_pk_bf16_f32 v56, v156, v157
    v_lshlrev_b32 v156, 16, v56
    v_and_b32 v157, 0xffff0000, v56
    v_cvt_pk_bf16_f32 v56, v158, v159
    v_lshlrev_b32 v158, 16, v56
    v_and_b32 v159, 0xffff0000, v56
    v_mul_f32 v57, v156, v156
    v_mul_f32 v57, s12, v57
    v_fma_f32 v57, v57, v156, v156
    v_mul_f32 v57, s13, v57
    v_mul_f32 v58, v157, v157
    v_mul_f32 v58, s12, v58
    v_fma_f32 v58, v58, v157, v157
    v_mul_f32 v58, s13, v58
    v_mul_f32 v59, v158, v158
    v_mul_f32 v59, s12, v59
    v_fma_f32 v59, v59, v158, v158
    v_mul_f32 v59, s13, v59
    v_mul_f32 v60, v159, v159
    v_mul_f32 v60, s12, v60
    v_fma_f32 v60, v60, v159, v159
    v_mul_f32 v60, s13, v60
    v_exp_f32 v57, v57
    v_exp_f32 v58, v58
    v_exp_f32 v59, v59
    v_exp_f32 v60, v60
    s_nop 0
    v_add_f32 v57, 1.0, v57
    v_add_f32 v58, 1.0, v58
    v_add_f32 v59, 1.0, v59
    v_add_f32 v60, 1.0, v60
    v_rcp_f32 v57, v57
    v_rcp_f32 v58, v58
    v_rcp_f32 v59, v59
    v_rcp_f32 v60, v60
    s_nop 0
    v_mul_f32 v156, v156, v57
    v_mul_f32 v157, v157, v58
    v_mul_f32 v158, v158, v59
    v_mul_f32 v159, v159, v60
    v_cvt_pk_bf16_f32 v156, v156, v157
    v_cvt_pk_bf16_f32 v157, v158, v159
    s_mov_b32 s14, 66048
    buffer_store_dwordx2 v[156:157], v10, s[48:51], s14 offen
    v_cvt_pk_bf16_f32 v56, v160, v161
    v_lshlrev_b32 v160, 16, v56
    v_and_b32 v161, 0xffff0000, v56
    v_cvt_pk_bf16_f32 v56, v162, v163
    v_lshlrev_b32 v162, 16, v56
    v_and_b32 v163, 0xffff0000, v56
    v_mul_f32 v57, v160, v160
    v_mul_f32 v57, s12, v57
    v_fma_f32 v57, v57, v160, v160
    v_mul_f32 v57, s13, v57
    v_mul_f32 v58, v161, v161
    v_mul_f32 v58, s12, v58
    v_fma_f32 v58, v58, v161, v161
    v_mul_f32 v58, s13, v58
    v_mul_f32 v59, v162, v162
    v_mul_f32 v59, s12, v59
    v_fma_f32 v59, v59, v162, v162
    v_mul_f32 v59, s13, v59
    v_mul_f32 v60, v163, v163
    v_mul_f32 v60, s12, v60
    v_fma_f32 v60, v60, v163, v163
    v_mul_f32 v60, s13, v60
    v_exp_f32 v57, v57
    v_exp_f32 v58, v58
    v_exp_f32 v59, v59
    v_exp_f32 v60, v60
    s_nop 0
    v_add_f32 v57, 1.0, v57
    v_add_f32 v58, 1.0, v58
    v_add_f32 v59, 1.0, v59
    v_add_f32 v60, 1.0, v60
    v_rcp_f32 v57, v57
    v_rcp_f32 v58, v58
    v_rcp_f32 v59, v59
    v_rcp_f32 v60, v60
    s_nop 0
    v_mul_f32 v160, v160, v57
    v_mul_f32 v161, v161, v58
    v_mul_f32 v162, v162, v59
    v_mul_f32 v163, v163, v60
    v_cvt_pk_bf16_f32 v160, v160, v161
    v_cvt_pk_bf16_f32 v161, v162, v163
    s_mov_b32 s14, 66048
    buffer_store_dwordx2 v[160:161], v11, s[48:51], s14 offen
    v_cvt_pk_bf16_f32 v56, v164, v165
    v_lshlrev_b32 v164, 16, v56
    v_and_b32 v165, 0xffff0000, v56
    v_cvt_pk_bf16_f32 v56, v166, v167
    v_lshlrev_b32 v166, 16, v56
    v_and_b32 v167, 0xffff0000, v56
    v_mul_f32 v57, v164, v164
    v_mul_f32 v57, s12, v57
    v_fma_f32 v57, v57, v164, v164
    v_mul_f32 v57, s13, v57
    v_mul_f32 v58, v165, v165
    v_mul_f32 v58, s12, v58
    v_fma_f32 v58, v58, v165, v165
    v_mul_f32 v58, s13, v58
    v_mul_f32 v59, v166, v166
    v_mul_f32 v59, s12, v59
    v_fma_f32 v59, v59, v166, v166
    v_mul_f32 v59, s13, v59
    v_mul_f32 v60, v167, v167
    v_mul_f32 v60, s12, v60
    v_fma_f32 v60, v60, v167, v167
    v_mul_f32 v60, s13, v60
    v_exp_f32 v57, v57
    v_exp_f32 v58, v58
    v_exp_f32 v59, v59
    v_exp_f32 v60, v60
    s_nop 0
    v_add_f32 v57, 1.0, v57
    v_add_f32 v58, 1.0, v58
    v_add_f32 v59, 1.0, v59
    v_add_f32 v60, 1.0, v60
    v_rcp_f32 v57, v57
    v_rcp_f32 v58, v58
    v_rcp_f32 v59, v59
    v_rcp_f32 v60, v60
    s_nop 0
    v_mul_f32 v164, v164, v57
    v_mul_f32 v165, v165, v58
    v_mul_f32 v166, v166, v59
    v_mul_f32 v167, v167, v60
    v_cvt_pk_bf16_f32 v164, v164, v165
    v_cvt_pk_bf16_f32 v165, v166, v167
    s_mov_b32 s14, 66048
    buffer_store_dwordx2 v[164:165], v12, s[48:51], s14 offen
L_end_g3_kernel:
    s_endpgm
.globl ln2_kernel
.p2align 8
.type ln2_kernel,@function
ln2_kernel:
    s_cmp_ge_u32 s2, 256
    s_cbranch_scc1 L_end_ln2_kernel
    s_load_dwordx16 s[16:31], s[0:1], 0
    s_load_dwordx4 s[32:35], s[0:1], 64
    s_load_dwordx2 s[36:37], s[0:1], 80
    v_and_b32 v1, 63, v0
    v_lshrrev_b32 v5, 6, v0
    v_bfe_u32 v2, v0, 6, 2
    v_and_b32 v3, 15, v0
    v_bfe_u32 v4, v0, 4, 2
    v_readfirstlane_b32 s39, v5
    s_and_b32 s3, s39, 3
    s_lshr_b32 s38, s39, 2
    s_waitcnt lgkmcnt(0)
    s_add_u32 s40, s36, 9437184
    s_addc_u32 s41, s37, 0
    s_mov_b32 s42, 2818048
    s_mov_b32 s43, 0x00020000
    s_add_u32 s44, s36, 12582912
    s_addc_u32 s45, s37, 0
    s_mov_b32 s46, 3145728
    s_mov_b32 s47, 0x00020000
    s_mov_b32 s9, 0x3f803f80
    s_lshl_b32 s4, s2, 2
    s_add_u32 s4, s4, s3
    s_lshl_b32 s4, s4, 1
    s_mul_i32 s5, s4, 1376
    v_lshlrev_b32 v5, 4, v1
    v_add_u32 v5, s5, v5
    v_mov_b32 v7, -1
    v_add_u32 v6, 1024, v5
    v_cmp_gt_u32 s[50:51], 22, v1
    s_nop 1
    v_cndmask_b32 v6, v7, v6, s[50:51]
    s_mov_b32 s6, 1376
    buffer_load_dwordx4 v[16:19], v5, s[40:43], 0 offen
    buffer_load_dwordx4 v[20:23], v6, s[40:43], 0 offen
    buffer_load_dwordx4 v[24:27], v5, s[40:43], s6 offen
    buffer_load_dwordx4 v[28:31], v6, s[40:43], s6 offen
    s_mul_i32 s7, s4, 192
    v_add_u32 v8, 0, v1
    v_mul_u32_u24 v9, 5462, v8
    v_lshrrev_b32 v9, 16, v9
    v_mul_u32_u24 v10, 12, v9
    v_sub_u32 v10, v8, v10
    s_mov_b32 s11, 393216
    v_mul_lo_u32 v9, v9, s11
    v_lshl_add_u32 v9, v10, 4, v9
    v_add_u32 v12, s7, v9
    v_add_u32 v8, 64, v1
    v_mul_u32_u24 v9, 5462, v8
    v_lshrrev_b32 v9, 16, v9
    v_mul_u32_u24 v10, 12, v9
    v_sub_u32 v10, v8, v10
    s_mov_b32 s11, 393216
    v_mul_lo_u32 v9, v9, s11
    v_lshl_add_u32 v9, v10, 4, v9
    v_add_u32 v13, s7, v9
    v_cmp_gt_u32 vcc, 32, v1
    s_nop 1
    v_cndmask_b32 v13, v7, v13, vcc
    s_mov_b32 s8, 192
    v_mov_b32 v40, 0
    v_mov_b32 v41, 0
    s_waitcnt vmcnt(2)
    v_dot2_f32_bf16 v40, v16, s9, v40
    v_dot2_f32_bf16 v41, v16, v16, v41
    v_dot2_f32_bf16 v40, v17, s9, v40
    v_dot2_f32_bf16 v41, v17, v17, v41
    v_dot2_f32_bf16 v40, v18, s9, v40
    v_dot2_f32_bf16 v41, v18, v18, v41
    v_dot2_f32_bf16 v40, v19, s9, v40
    v_dot2_f32_bf16 v41, v19, v19, v41
    v_dot2_f32_bf16 v40, v20, s9, v40
    v_dot2_f32_bf16 v41, v20, v20, v41
    v_dot2_f32_bf16 v40, v21, s9, v40
    v_dot2_f32_bf16 v41, v21, v21, v41
    v_dot2_f32_bf16 v40, v22, s9, v40
    v_dot2_f32_bf16 v41, v22, v22, v41
    v_dot2_f32_bf16 v40, v23, s9, v40
    v_dot2_f32_bf16 v41, v23, v23, v41
    s_nop 2
    v_add_f32_dpp v40, v40, v40 quad_perm:[1,0,3,2] row_mask:0xf bank_mask:0xf
    s_nop 1
    v_add_f32_dpp v40, v40, v40 quad_perm:[2,3,0,1] row_mask:0xf bank_mask:0xf
    s_nop 1
    v_add_f32_dpp v40, v40, v40 row_half_mirror row_mask:0xf bank_mask:0xf
    s_nop 1
    v_add_f32_dpp v40, v40, v40 row_mirror row_mask:0xf bank_mask:0xf
    s_nop 1
    v_mov_b32 v42, v40
    s_nop 1
    v_permlane16_swap_b32 v40, v42
    s_nop 0
    v_add_f32 v40, v40, v42
    v_mov_b32 v42, v40
    s_nop 1
    v_permlane32_swap_b32 v40, v42
    s_nop 0
    v_add_f32 v40, v40, v42
    v_add_f32_dpp v41, v41, v41 quad_perm:[1,0,3,2] row_mask:0xf bank_mask:0xf
    s_nop 1
    v_add_f32_dpp v41, v41, v41 quad_perm:[2,3,0,1] row_mask:0xf bank_mask:0xf
    s_nop 1
    v_add_f32_dpp v41, v41, v41 row_half_mirror row_mask:0xf bank_mask:0xf
    s_nop 1
    v_add_f32_dpp v41, v41, v41 row_mirror row_mask:0xf bank_mask:0xf
    s_nop 1
    v_mov_b32 v42, v41
    s_nop 1
    v_permlane16_swap_b32 v41, v42
    s_nop 0
    v_add_f32 v41, v41, v42
    v_mov_b32 v42, v41
    s_nop 1
    v_permlane32_swap_b32 v41, v42
    s_nop 0
    v_add_f32 v41, v41, v42
    v_mul_f32 v40, 0x3abe82fa, v40
    v_mul_f32 v41, 0x3abe82fa, v41
    v_fma_f32 v41, -v40, v40, v41
    v_max_f32 v41, 0, v41
    v_cvt_pk_bf16_f32 v42, v40, v40
    v_lshlrev_b32 v40, 16, v42
    v_cvt_pk_bf16_f32 v42, v41, v41
    v_lshlrev_b32 v41, 16, v42
    v_add_f32 v41, 0x3727c5ac, v41
    v_cvt_pk_bf16_f32 v42, v41, v41
    v_lshlrev_b32 v41, 16, v42
    v_sqrt_f32 v41, v41
    s_nop 0
    v_cvt_pk_bf16_f32 v42, v41, v41
    v_lshlrev_b32 v41, 16, v42
    v_rcp_f32 v44, v41
    s_nop 0
    v_mov_b32 v45, v44
    v_mul_f32 v46, v40, v44
    v_sub_f32 v46, 0, v46
    v_mov_b32 v47, v46
    v_lshlrev_b32 v48, 16, v16
    v_and_b32 v49, 0xffff0000, v16
    v_pk_fma_f32 v[48:49], v[48:49], v[44:45], v[46:47]
    v_cvt_pk_bf16_f32 v16, v48, v49
    v_lshlrev_b32 v50, 16, v17
    v_and_b32 v51, 0xffff0000, v17
    v_pk_fma_f32 v[50:51], v[50:51], v[44:45], v[46:47]
    v_cvt_pk_bf16_f32 v17, v50, v51
    v_lshlrev_b32 v48, 16, v18
    v_and_b32 v49, 0xffff0000, v18
    v_pk_fma_f32 v[48:49], v[48:49], v[44:45], v[46:47]
    v_cvt_pk_bf16_f32 v18, v48, v49
    v_lshlrev_b32 v50, 16, v19
    v_and_b32 v51, 0xffff0000, v19
    v_pk_fma_f32 v[50:51], v[50:51], v[44:45], v[46:47]
    v_cvt_pk_bf16_f32 v19, v50, v51
    v_lshlrev_b32 v48, 16, v20
    v_and_b32 v49, 0xffff0000, v20
    v_pk_fma_f32 v[48:49], v[48:49], v[44:45], v[46:47]
    v_cvt_pk_bf16_f32 v20, v48, v49
    v_lshlrev_b32 v50, 16, v21
    v_and_b32 v51, 0xffff0000, v21
    v_pk_fma_f32 v[50:51], v[50:51], v[44:45], v[46:47]
    v_cvt_pk_bf16_f32 v21, v50, v51
    v_lshlrev_b32 v48, 16, v22
    v_and_b32 v49, 0xffff0000, v22
    v_pk_fma_f32 v[48:49], v[48:49], v[44:45], v[46:47]
    v_cvt_pk_bf16_f32 v22, v48, v49
    v_lshlrev_b32 v50, 16, v23
    v_and_b32 v51, 0xffff0000, v23
    v_pk_fma_f32 v[50:51], v[50:51], v[44:45], v[46:47]
    v_cvt_pk_bf16_f32 v23, v50, v51
    v_cndmask_b32 v20, 0, v20, s[50:51]
    v_cndmask_b32 v21, 0, v21, s[50:51]
    v_cndmask_b32 v22, 0, v22, s[50:51]
    v_cndmask_b32 v23, 0, v23, s[50:51]
    buffer_store_dwordx4 v[16:19], v12, s[44:47], 0 offen
    buffer_store_dwordx4 v[20:23], v13, s[44:47], 0 offen
    v_mov_b32 v40, 0
    v_mov_b32 v41, 0
    s_waitcnt vmcnt(2)
    v_dot2_f32_bf16 v40, v24, s9, v40
    v_dot2_f32_bf16 v41, v24, v24, v41
    v_dot2_f32_bf16 v40, v25, s9, v40
    v_dot2_f32_bf16 v41, v25, v25, v41
    v_dot2_f32_bf16 v40, v26, s9, v40
    v_dot2_f32_bf16 v41, v26, v26, v41
    v_dot2_f32_bf16 v40, v27, s9, v40
    v_dot2_f32_bf16 v41, v27, v27, v41
    v_dot2_f32_bf16 v40, v28, s9, v40
    v_dot2_f32_bf16 v41, v28, v28, v41
    v_dot2_f32_bf16 v40, v29, s9, v40
    v_dot2_f32_bf16 v41, v29, v29, v41
    v_dot2_f32_bf16 v40, v30, s9, v40
    v_dot2_f32_bf16 v41, v30, v30, v41
    v_dot2_f32_bf16 v40, v31, s9, v40
    v_dot2_f32_bf16 v41, v31, v31, v41
    s_nop 2
    v_add_f32_dpp v40, v40, v40 quad_perm:[1,0,3,2] row_mask:0xf bank_mask:0xf
    s_nop 1
    v_add_f32_dpp v40, v40, v40 quad_perm:[2,3,0,1] row_mask:0xf bank_mask:0xf
    s_nop 1
    v_add_f32_dpp v40, v40, v40 row_half_mirror row_mask:0xf bank_mask:0xf
    s_nop 1
    v_add_f32_dpp v40, v40, v40 row_mirror row_mask:0xf bank_mask:0xf
    s_nop 1
    v_mov_b32 v42, v40
    s_nop 1
    v_permlane16_swap_b32 v40, v42
    s_nop 0
    v_add_f32 v40, v40, v42
    v_mov_b32 v42, v40
    s_nop 1
    v_permlane32_swap_b32 v40, v42
    s_nop 0
    v_add_f32 v40, v40, v42
    v_add_f32_dpp v41, v41, v41 quad_perm:[1,0,3,2] row_mask:0xf bank_mask:0xf
    s_nop 1
    v_add_f32_dpp v41, v41, v41 quad_perm:[2,3,0,1] row_mask:0xf bank_mask:0xf
    s_nop 1
    v_add_f32_dpp v41, v41, v41 row_half_mirror row_mask:0xf bank_mask:0xf
    s_nop 1
    v_add_f32_dpp v41, v41, v41 row_mirror row_mask:0xf bank_mask:0xf
    s_nop 1
    v_mov_b32 v42, v41
    s_nop 1
    v_permlane16_swap_b32 v41, v42
    s_nop 0
    v_add_f32 v41, v41, v42
    v_mov_b32 v42, v41
    s_nop 1
    v_permlane32_swap_b32 v41, v42
    s_nop 0
    v_add_f32 v41, v41, v42
    v_mul_f32 v40, 0x3abe82fa, v40
    v_mul_f32 v41, 0x3abe82fa, v41
    v_fma_f32 v41, -v40, v40, v41
    v_max_f32 v41, 0, v41
    v_cvt_pk_bf16_f32 v42, v40, v40
    v_lshlrev_b32 v40, 16, v42
    v_cvt_pk_bf16_f32 v42, v41, v41
    v_lshlrev_b32 v41, 16, v42
    v_add_f32 v41, 0x3727c5ac, v41
    v_cvt_pk_bf16_f32 v42, v41, v41
    v_lshlrev_b32 v41, 16, v42
    v_sqrt_f32 v41, v41
    s_nop 0
    v_cvt_pk_bf16_f32 v42, v41, v41
    v_lshlrev_b32 v41, 16, v42
    v_rcp_f32 v44, v41
    s_nop 0
    v_mov_b32 v45, v44
    v_mul_f32 v46, v40, v44
    v_sub_f32 v46, 0, v46
    v_mov_b32 v47, v46
    v_lshlrev_b32 v48, 16, v24
    v_and_b32 v49, 0xffff0000, v24
    v_pk_fma_f32 v[48:49], v[48:49], v[44:45], v[46:47]
    v_cvt_pk_bf16_f32 v24, v48, v49
    v_lshlrev_b32 v50, 16, v25
    v_and_b32 v51, 0xffff0000, v25
    v_pk_fma_f32 v[50:51], v[50:51], v[44:45], v[46:47]
    v_cvt_pk_bf16_f32 v25, v50, v51
    v_lshlrev_b32 v48, 16, v26
    v_and_b32 v49, 0xffff0000, v26
    v_pk_fma_f32 v[48:49], v[48:49], v[44:45], v[46:47]
    v_cvt_pk_bf16_f32 v26, v48, v49
    v_lshlrev_b32 v50, 16, v27
    v_and_b32 v51, 0xffff0000, v27
    v_pk_fma_f32 v[50:51], v[50:51], v[44:45], v[46:47]
    v_cvt_pk_bf16_f32 v27, v50, v51
    v_lshlrev_b32 v48, 16, v28
    v_and_b32 v49, 0xffff0000, v28
    v_pk_fma_f32 v[48:49], v[48:49], v[44:45], v[46:47]
    v_cvt_pk_bf16_f32 v28, v48, v49
    v_lshlrev_b32 v50, 16, v29
    v_and_b32 v51, 0xffff0000, v29
    v_pk_fma_f32 v[50:51], v[50:51], v[44:45], v[46:47]
    v_cvt_pk_bf16_f32 v29, v50, v51
    v_lshlrev_b32 v48, 16, v30
    v_and_b32 v49, 0xffff0000, v30
    v_pk_fma_f32 v[48:49], v[48:49], v[44:45], v[46:47]
    v_cvt_pk_bf16_f32 v30, v48, v49
    v_lshlrev_b32 v50, 16, v31
    v_and_b32 v51, 0xffff0000, v31
    v_pk_fma_f32 v[50:51], v[50:51], v[44:45], v[46:47]
    v_cvt_pk_bf16_f32 v31, v50, v51
    v_cndmask_b32 v28, 0, v28, s[50:51]
    v_cndmask_b32 v29, 0, v29, s[50:51]
    v_cndmask_b32 v30, 0, v30, s[50:51]
    v_cndmask_b32 v31, 0, v31, s[50:51]
    buffer_store_dwordx4 v[24:27], v12, s[44:47], s8 offen
    buffer_store_dwordx4 v[28:31], v13, s[44:47], s8 offen
L_end_ln2_kernel:
    s_endpgm
.globl g4_kernel
.p2align 8
.type g4_kernel,@function
g4_kernel:
    s_cmp_ge_u32 s2, 256
    s_cbranch_scc1 L_end_g4_kernel
    s_load_dwordx16 s[16:31], s[0:1], 0
    s_load_dwordx4 s[32:35], s[0:1], 64
    s_load_dwordx2 s[36:37], s[0:1], 80
    v_and_b32 v1, 63, v0
    v_lshrrev_b32 v5, 6, v0
    v_bfe_u32 v2, v0, 6, 2
    v_and_b32 v3, 15, v0
    v_bfe_u32 v4, v0, 4, 2
    v_readfirstlane_b32 s39, v5
    s_and_b32 s3, s39, 3
    s_lshr_b32 s38, s39, 2
    s_and_b32 s4, s2, 3
    s_lshl_b32 s4, s4, 3
    s_bfe_u32 s12, s2, 0x30003
    s_add_u32 s4, s4, s12
    s_bfe_u32 s5, s2, 0x10002
    s_lshl_b32 s5, s5, 2
    s_lshr_b32 s12, s2, 6
    s_add_u32 s5, s5, s12
    s_lshl_b32 s6, s4, 6
    s_mov_b32 s9, 0x3f803f80
    s_mul_i32 s10, s5, 393216
    s_cmp_eq_u32 s38, 0
    s_cbranch_scc1 L_comp_g4_kernel
    s_lshl_b32 s14, s3, 11
    s_mul_i32 s15, s3, 3072
    s_add_u32 s15, s15, 8192
    s_and_b32 s13, s3, 1
    s_lshl_b32 s13, s13, 10
    s_add_u32 s13, s13, 8192
    v_lshrrev_b32 v5, 3, v1
    v_and_b32 v6, 7, v1
    v_xor_b32 v6, v6, v5
    v_lshl_add_u32 v7, v2, 4, v5
    v_add_u32 v7, s6, v7
    s_mov_b32 s11, 4096
    v_mul_lo_u32 v7, v7, s11
    v_lshl_add_u32 v36, v6, 4, v7
    v_add_u32 v37, 32768, v36
    v_mul_u32_u24 v5, 192, v2
    v_add_u32 v5, v5, v1
    s_mov_b32 s11, 192
    v_add_u32 v6, 0, v5
    v_mul_u32_u24 v7, 5462, v6
    v_lshrrev_b32 v7, 16, v7
    v_mul_u32_u24 v8, 12, v7
    v_sub_u32 v8, v6, v8
    v_bfe_u32 v9, v7, 3, 1
    v_lshrrev_b32 v17, 1, v8
    v_xor_b32 v9, v9, v17
    v_and_b32 v8, 1, v8
    v_mul_lo_u32 v7, v7, s11
    v_lshl_add_u32 v7, v8, 4, v7
    v_lshl_add_u32 v7, v9, 5, v7
    v_add_u32 v40, s10, v7
    v_add_u32 v6, 64, v5
    v_mul_u32_u24 v7, 5462, v6
    v_lshrrev_b32 v7, 16, v7
    v_mul_u32_u24 v8, 12, v7
    v_sub_u32 v8, v6, v8
    v_bfe_u32 v9, v7, 3, 1
    v_lshrrev_b32 v17, 1, v8
    v_xor_b32 v9, v9, v17
    v_and_b32 v8, 1, v8
    v_mul_lo_u32 v7, v7, s11
    v_lshl_add_u32 v7, v8, 4, v7
    v_lshl_add_u32 v7, v9, 5, v7
    v_add_u32 v41, s10, v7
    v_add_u32 v6, 128, v5
    v_mul_u32_u24 v7, 5462, v6
    v_lshrrev_b32 v7, 16, v7
    v_mul_u32_u24 v8, 12, v7
    v_sub_u32 v8, v6, v8
    v_bfe_u32 v9, v7, 3, 1
    v_lshrrev_b32 v17, 1, v8
    v_xor_b32 v9, v9, v17
    v_and_b32 v8, 1, v8
    v_mul_lo_u32 v7, v7, s11
    v_lshl_add_u32 v7, v8, 4, v7
    v_lshl_add_u32 v7, v9, 5, v7
    v_add_u32 v42, s10, v7
    s_waitcnt lgkmcnt(0)
    s_mov_b32 s40, s26
    s_mov_b32 s41, s27
    s_mov_b32 s42, 8388608
    s_mov_b32 s43, 0x00020000
    s_add_u32 s44, s36, 12582912
    s_addc_u32 s45, s37, 0
    s_mov_b32 s46, 3145728
    s_mov_b32 s47, 0x00020000
    s_mov_b32 s7, 0
    s_mov_b32 s8, 0
    s_add_u32 m0, s15, 0
    s_nop 0
    buffer_load_dwordx4 v40, s[44:47], s8 offen lds
    s_add_u32 m0, s15, 1024
    s_nop 0
    buffer_load_dwordx4 v41, s[44:47], s8 offen lds
    s_add_u32 m0, s15, 2048
    s_nop 0
    buffer_load_dwordx4 v42, s[44:47], s8 offen lds
    s_add_u32 m0, s14, 0
    s_nop 0
    buffer_load_dwordx4 v36, s[40:43], s7 offen lds
    s_add_u32 m0, s14, 1024
    s_nop 0
    buffer_load_dwordx4 v37, s[40:43], s7 offen lds
    s_mov_b32 s7, 128
    s_mov_b32 s8, 12288
    s_add_u32 m0, s15, 20480
    s_nop 0
    buffer_load_dwordx4 v40, s[44:47], s8 offen lds
    s_add_u32 m0, s15, 21504
    s_nop 0
    buffer_load_dwordx4 v41, s[44:47], s8 offen lds
    s_add_u32 m0, s15, 22528
    s_nop 0
    buffer_load_dwordx4 v42, s[44:47], s8 offen lds
    s_add_u32 m0, s14, 20480
    s_nop 0
    buffer_load_dwordx4 v36, s[40:43], s7 offen lds
    s_add_u32 m0, s14, 21504
    s_nop 0
    buffer_load_dwordx4 v37, s[40:43], s7 offen lds
    s_waitcnt vmcnt(5)
    s_barrier
    s_mov_b32 s7, 256
    s_mov_b32 s8, 24576
    s_add_u32 m0, s15, 40960
    s_nop 0
    buffer_load_dwordx4 v40, s[44:47], s8 offen lds
    s_add_u32 m0, s15, 41984
    s_nop 0
    buffer_load_dwordx4 v41, s[44:47], s8 offen lds
    s_add_u32 m0, s15, 43008
    s_nop 0
    buffer_load_dwordx4 v42, s[44:47], s8 offen lds
    s_add_u32 m0, s14, 40960
    s_nop 0
    buffer_load_dwordx4 v36, s[40:43], s7 offen lds
    s_add_u32 m0, s14, 41984
    s_nop 0
    buffer_load_dwordx4 v37, s[40:43], s7 offen lds
    s_mov_b32 s7, 384
    s_mov_b32 s8, 36864
    s_add_u32 m0, s15, 61440
    s_nop 0
    buffer_load_dwordx4 v40, s[44:47], s8 offen lds
    s_add_u32 m0, s15, 62464
    s_nop 0
    buffer_load_dwordx4 v41, s[44:47], s8 offen lds
    s_add_u32 m0, s15, 63488
    s_nop 0
    buffer_load_dwordx4 v42, s[44:47], s8 offen lds
    s_add_u32 m0, s14, 61440
    s_nop 0
    buffer_load_dwordx4 v36, s[40:43], s7 offen lds
    s_add_u32 m0, s14, 62464
    s_nop 0
    buffer_load_dwordx4 v37, s[40:43], s7 offen lds
    s_waitcnt vmcnt(5)
    s_barrier
    s_mov_b32 s7, 512
    s_mov_b32 s8, 49152
    s_add_u32 m0, s15, 81920
    s_nop 0
    buffer_load_dwordx4 v40, s[44:47], s8 offen lds
    s_add_u32 m0, s15, 82944
    s_nop 0
    buffer_load_dwordx4 v41, s[44:47], s8 offen lds
    s_add_u32 m0, s15, 83968
    s_nop 0
    buffer_load_dwordx4 v42, s[44:47], s8 offen lds
    s_add_u32 m0, s14, 81920
    s_nop 0
    buffer_load_dwordx4 v36, s[40:43], s7 offen lds
    s_add_u32 m0, s14, 82944
    s_nop 0
    buffer_load_dwordx4 v37, s[40:43], s7 offen lds
    s_mov_b32 s7, 640
    s_mov_b32 s8, 61440
    s_add_u32 m0, s15, 102400
    s_nop 0
    buffer_load_dwordx4 v40, s[44:47], s8 offen lds
    s_add_u32 m0, s15, 103424
    s_nop 0
    buffer_load_dwordx4 v41, s[44:47], s8 offen lds
    s_add_u32 m0, s15, 104448
    s_nop 0
    buffer_load_dwordx4 v42, s[44:47], s8 offen lds
    s_add_u32 m0, s14, 102400
    s_nop 0
    buffer_load_dwordx4 v36, s[40:43], s7 offen lds
    s_add_u32 m0, s14, 103424
    s_nop 0
    buffer_load_dwordx4 v37, s[40:43], s7 offen lds
    s_waitcnt vmcnt(10)
    s_barrier
    s_mov_b32 s7, 768
    s_mov_b32 s8, 73728
    s_add_u32 m0, s15, 122880
    s_nop 0
    buffer_load_dwordx4 v40, s[44:47], s8 offen lds
    s_add_u32 m0, s15, 123904
    s_nop 0
    buffer_load_dwordx4 v41, s[44:47], s8 offen lds
    s_add_u32 m0, s15, 124928
    s_nop 0
    buffer_load_dwordx4 v42, s[44:47], s8 offen lds
    s_add_u32 m0, s14, 122880
    s_nop 0
    buffer_load_dwordx4 v36, s[40:43], s7 offen lds
    s_add_u32 m0, s14, 123904
    s_nop 0
    buffer_load_dwordx4 v37, s[40:43], s7 offen lds
    s_mov_b32 s7, 896
    s_mov_b32 s8, 86016
    s_add_u32 m0, s15, 0
    s_nop 0
    buffer_load_dwordx4 v40, s[44:47], s8 offen lds
    s_add_u32 m0, s15, 1024
    s_nop 0
    buffer_load_dwordx4 v41, s[44:47], s8 offen lds
    s_add_u32 m0, s15, 2048
    s_nop 0
    buffer_load_dwordx4 v42, s[44:47], s8 offen lds
    s_add_u32 m0, s14, 0
    s_nop 0
    buffer_load_dwordx4 v36, s[40:43], s7 offen lds
    s_add_u32 m0, s14, 1024
    s_nop 0
    buffer_load_dwordx4 v37, s[40:43], s7 offen lds
    s_waitcnt vmcnt(15)
    s_barrier
    s_mov_b32 s7, 1024
    s_mov_b32 s8, 98304
    s_add_u32 m0, s15, 20480
    s_nop 0
    buffer_load_dwordx4 v40, s[44:47], s8 offen lds
    s_add_u32 m0, s15, 21504
    s_nop 0
    buffer_load_dwordx4 v41, s[44:47], s8 offen lds
    s_add_u32 m0, s15, 22528
    s_nop 0
    buffer_load_dwordx4 v42, s[44:47], s8 offen lds
    s_add_u32 m0, s14, 20480
    s_nop 0
    buffer_load_dwordx4 v36, s[40:43], s7 offen lds
    s_add_u32 m0, s14, 21504
    s_nop 0
    buffer_load_dwordx4 v37, s[40:43], s7 offen lds
    s_mov_b32 s7, 1152
    s_mov_b32 s8, 110592
    s_add_u32 m0, s15, 40960
    s_nop 0
    buffer_load_dwordx4 v40, s[44:47], s8 offen lds
    s_add_u32 m0, s15, 41984
    s_nop 0
    buffer_load_dwordx4 v41, s[44:47], s8 offen lds
    s_add_u32 m0, s15, 43008
    s_nop 0
    buffer_load_dwordx4 v42, s[44:47], s8 offen lds
    s_add_u32 m0, s14, 40960
    s_nop 0
    buffer_load_dwordx4 v36, s[40:43], s7 offen lds
    s_add_u32 m0, s14, 41984
    s_nop 0
    buffer_load_dwordx4 v37, s[40:43], s7 offen lds
    s_waitcnt vmcnt(20)
    s_barrier
    s_mov_b32 s7, 1280
    s_mov_b32 s8, 122880
    s_add_u32 m0, s15, 61440
    s_nop 0
    buffer_load_dwordx4 v40, s[44:47], s8 offen lds
    s_add_u32 m0, s15, 62464
    s_nop 0
    buffer_load_dwordx4 v41, s[44:47], s8 offen lds
    s_add_u32 m0, s15, 63488
    s_nop 0
    buffer_load_dwordx4 v42, s[44:47], s8 offen lds
    s_add_u32 m0, s14, 61440
    s_nop 0
    buffer_load_dwordx4 v36, s[40:43], s7 offen lds
    s_add_u32 m0, s14, 62464
    s_nop 0
    buffer_load_dwordx4 v37, s[40:43], s7 offen lds
    s_waitcnt vmcnt(20)
    s_barrier
    s_mov_b32 s7, 1408
    s_mov_b32 s8, 135168
    s_add_u32 m0, s15, 81920
    s_nop 0
    buffer_load_dwordx4 v40, s[44:47], s8 offen lds
    s_add_u32 m0, s15, 82944
    s_nop 0
    buffer_load_dwordx4 v41, s[44:47], s8 offen lds
    s_add_u32 m0, s15, 83968
    s_nop 0
    buffer_load_dwordx4 v42, s[44:47], s8 offen lds
    s_add_u32 m0, s14, 81920
    s_nop 0
    buffer_load_dwordx4 v36, s[40:43], s7 offen lds
    s_add_u32 m0, s14, 82944
    s_nop 0
    buffer_load_dwordx4 v37, s[40:43], s7 offen lds
    s_waitcnt vmcnt(20)
    s_barrier
    s_mov_b32 s7, 1536
    s_mov_b32 s8, 147456
    s_add_u32 m0, s15, 102400
    s_nop 0
    buffer_load_dwordx4 v40, s[44:47], s8 offen lds
    s_add_u32 m0, s15, 103424
    s_nop 0
    buffer_load_dwordx4 v41, s[44:47], s8 offen lds
    s_add_u32 m0, s15, 104448
    s_nop 0
    buffer_load_dwordx4 v42, s[44:47], s8 offen lds
    s_add_u32 m0, s14, 102400
    s_nop 0
    buffer_load_dwordx4 v36, s[40:43], s7 offen lds
    s_add_u32 m0, s14, 103424
    s_nop 0
    buffer_load_dwordx4 v37, s[40:43], s7 offen lds
    s_waitcnt vmcnt(20)
    s_barrier
    s_mov_b32 s7, 1664
    s_mov_b32 s8, 159744
    s_add_u32 m0, s15, 122880
    s_nop 0
    buffer_load_dwordx4 v40, s[44:47], s8 offen lds
    s_add_u32 m0, s15, 123904
    s_nop 0
    buffer_load_dwordx4 v41, s[44:47], s8 offen lds
    s_add_u32 m0, s15, 124928
    s_nop 0
    buffer_load_dwordx4 v42, s[44:47], s8 offen lds
    s_add_u32 m0, s14, 122880
    s_nop 0
    buffer_load_dwordx4 v36, s[40:43], s7 offen lds
    s_add_u32 m0, s14, 123904
    s_nop 0
    buffer_load_dwordx4 v37, s[40:43], s7 offen lds
    s_waitcnt vmcnt(20)
    s_barrier
    s_mov_b32 s7, 1792
    s_mov_b32 s8, 172032
    s_add_u32 m0, s15, 0
    s_nop 0
    buffer_load_dwordx4 v40, s[44:47], s8 offen lds
    s_add_u32 m0, s15, 1024
    s_nop 0
    buffer_load_dwordx4 v41, s[44:47], s8 offen lds
    s_add_u32 m0, s15, 2048
    s_nop 0
    buffer_load_dwordx4 v42, s[44:47], s8 offen lds
    s_add_u32 m0, s14, 0
    s_nop 0
    buffer_load_dwordx4 v36, s[40:43], s7 offen lds
    s_add_u32 m0, s14, 1024
    s_nop 0
    buffer_load_dwordx4 v37, s[40:43], s7 offen lds
    s_waitcnt vmcnt(20)
    s_barrier
    s_mov_b32 s7, 1920
    s_mov_b32 s8, 184320
    s_add_u32 m0, s15, 20480
    s_nop 0
    buffer_load_dwordx4 v40, s[44:47], s8 offen lds
    s_add_u32 m0, s15, 21504
    s_nop 0
    buffer_load_dwordx4 v41, s[44:47], s8 offen lds
    s_add_u32 m0, s15, 22528
    s_nop 0
    buffer_load_dwordx4 v42, s[44:47], s8 offen lds
    s_add_u32 m0, s14, 20480
    s_nop 0
    buffer_load_dwordx4 v36, s[40:43], s7 offen lds
    s_add_u32 m0, s14, 21504
    s_nop 0
    buffer_load_dwordx4 v37, s[40:43], s7 offen lds
    s_waitcnt vmcnt(20)
    s_barrier
    s_mov_b32 s7, 2048
    s_mov_b32 s8, 196608
    s_add_u32 m0, s15, 40960
    s_nop 0
    buffer_load_dwordx4 v40, s[44:47], s8 offen lds
    s_add_u32 m0, s15, 41984
    s_nop 0
    buffer_load_dwordx4 v41, s[44:47], s8 offen lds
    s_add_u32 m0, s15, 43008
    s_nop 0
    buffer_load_dwordx4 v42, s[44:47], s8 offen lds
    s_add_u32 m0, s14, 40960
    s_nop 0
    buffer_load_dwordx4 v36, s[40:43], s7 offen lds
    s_add_u32 m0, s14, 41984
    s_nop 0
    buffer_load_dwordx4 v37, s[40:43], s7 offen lds
    s_waitcnt vmcnt(20)
    s_barrier
    s_mov_b32 s7, 2176
    s_mov_b32 s8, 208896
    s_add_u32 m0, s15, 61440
    s_nop 0
    buffer_load_dwordx4 v40, s[44:47], s8 offen lds
    s_add_u32 m0, s15, 62464
    s_nop 0
    buffer_load_dwordx4 v41, s[44:47], s8 offen lds
    s_add_u32 m0, s15, 63488
    s_nop 0
    buffer_load_dwordx4 v42, s[44:47], s8 offen lds
    s_add_u32 m0, s14, 61440
    s_nop 0
    buffer_load_dwordx4 v36, s[40:43], s7 offen lds
    s_add_u32 m0, s14, 62464
    s_nop 0
    buffer_load_dwordx4 v37, s[40:43], s7 offen lds
    s_waitcnt vmcnt(20)
    s_barrier
    s_mov_b32 s7, 2304
    s_mov_b32 s8, 221184
    s_add_u32 m0, s15, 81920
    s_nop 0
    buffer_load_dwordx4 v40, s[44:47], s8 offen lds
    s_add_u32 m0, s15, 82944
    s_nop 0
    buffer_load_dwordx4 v41, s[44:47], s8 offen lds
    s_add_u32 m0, s15, 83968
    s_nop 0
    buffer_load_dwordx4 v42, s[44:47], s8 offen lds
    s_add_u32 m0, s14, 81920
    s_nop 0
    buffer_load_dwordx4 v36, s[40:43], s7 offen lds
    s_add_u32 m0, s14, 82944
    s_nop 0
    buffer_load_dwordx4 v37, s[40:43], s7 offen lds
    s_waitcnt vmcnt(20)
    s_barrier
    s_mov_b32 s7, 2432
    s_mov_b32 s8, 233472
    s_add_u32 m0, s15, 102400
    s_nop 0
    buffer_load_dwordx4 v40, s[44:47], s8 offen lds
    s_add_u32 m0, s15, 103424
    s_nop 0
    buffer_load_dwordx4 v41, s[44:47], s8 offen lds
    s_add_u32 m0, s15, 104448
    s_nop 0
    buffer_load_dwordx4 v42, s[44:47], s8 offen lds
    s_add_u32 m0, s14, 102400
    s_nop 0
    buffer_load_dwordx4 v36, s[40:43], s7 offen lds
    s_add_u32 m0, s14, 103424
    s_nop 0
    buffer_load_dwordx4 v37, s[40:43], s7 offen lds
    s_waitcnt vmcnt(20)
    s_barrier
    s_mov_b32 s7, 2560
    s_mov_b32 s8, 245760
    s_add_u32 m0, s15, 122880
    s_nop 0
    buffer_load_dwordx4 v40, s[44:47], s8 offen lds
    s_add_u32 m0, s15, 123904
    s_nop 0
    buffer_load_dwordx4 v41, s[44:47], s8 offen lds
    s_add_u32 m0, s15, 124928
    s_nop 0
    buffer_load_dwordx4 v42, s[44:47], s8 offen lds
    s_add_u32 m0, s14, 122880
    s_nop 0
    buffer_load_dwordx4 v36, s[40:43], s7 offen lds
    s_add_u32 m0, s14, 123904
    s_nop 0
    buffer_load_dwordx4 v37, s[40:43], s7 offen lds
    s_waitcnt vmcnt(20)
    s_barrier
    s_mov_b32 s7, 2688
    s_mov_b32 s8, 258048
    s_add_u32 m0, s15, 0
    s_nop 0
    buffer_load_dwordx4 v40, s[44:47], s8 offen lds
    s_add_u32 m0, s15, 1024
    s_nop 0
    buffer_load_dwordx4 v41, s[44:47], s8 offen lds
    s_add_u32 m0, s15, 2048
    s_nop 0
    buffer_load_dwordx4 v42, s[44:47], s8 offen lds
    s_add_u32 m0, s14, 0
    s_nop 0
    buffer_load_dwordx4 v36, s[40:43], s7 offen lds
    s_add_u32 m0, s14, 1024
    s_nop 0
    buffer_load_dwordx4 v37, s[40:43], s7 offen lds
    s_waitcnt vmcnt(20)
    s_barrier
    s_mov_b32 s7, 2816
    s_mov_b32 s8, 270336
    s_add_u32 m0, s15, 20480
    s_nop 0
    buffer_load_dwordx4 v40, s[44:47], s8 offen lds
    s_add_u32 m0, s15, 21504
    s_nop 0
    buffer_load_dwordx4 v41, s[44:47], s8 offen lds
    s_add_u32 m0, s15, 22528
    s_nop 0
    buffer_load_dwordx4 v42, s[44:47], s8 offen lds
    s_add_u32 m0, s14, 20480
    s_nop 0
    buffer_load_dwordx4 v36, s[40:43], s7 offen lds
    s_add_u32 m0, s14, 21504
    s_nop 0
    buffer_load_dwordx4 v37, s[40:43], s7 offen lds
    s_waitcnt vmcnt(20)
    s_barrier
    s_mov_b32 s7, 2944
    s_mov_b32 s8, 282624
    s_add_u32 m0, s15, 40960
    s_nop 0
    buffer_load_dwordx4 v40, s[44:47], s8 offen lds
    s_add_u32 m0, s15, 41984
    s_nop 0
    buffer_load_dwordx4 v41, s[44:47], s8 offen lds
    s_add_u32 m0, s15, 43008
    s_nop 0
    buffer_load_dwordx4 v42, s[44:47], s8 offen lds
    s_add_u32 m0, s14, 40960
    s_nop 0
    buffer_load_dwordx4 v36, s[40:43], s7 offen lds
    s_add_u32 m0, s14, 41984
    s_nop 0
    buffer_load_dwordx4 v37, s[40:43], s7 offen lds
    s_waitcnt vmcnt(20)
    s_barrier
    s_mov_b32 s7, 3072
    s_mov_b32 s8, 294912
    s_add_u32 m0, s15, 61440
    s_nop 0
    buffer_load_dwordx4 v40, s[44:47], s8 offen lds
    s_add_u32 m0, s15, 62464
    s_nop 0
    buffer_load_dwordx4 v41, s[44:47], s8 offen lds
    s_add_u32 m0, s15, 63488
    s_nop 0
    buffer_load_dwordx4 v42, s[44:47], s8 offen lds
    s_add_u32 m0, s14, 61440
    s_nop 0
    buffer_load_dwordx4 v36, s[40:43], s7 offen lds
    s_add_u32 m0, s14, 62464
    s_nop 0
    buffer_load_dwordx4 v37, s[40:43], s7 offen lds
    s_waitcnt vmcnt(20)
    s_barrier
    s_mov_b32 s7, 3200
    s_mov_b32 s8, 307200
    s_add_u32 m0, s15, 81920
    s_nop 0
    buffer_load_dwordx4 v40, s[44:47], s8 offen lds
    s_add_u32 m0, s15, 82944
    s_nop 0
    buffer_load_dwordx4 v41, s[44:47], s8 offen lds
    s_add_u32 m0, s15, 83968
    s_nop 0
    buffer_load_dwordx4 v42, s[44:47], s8 offen lds
    s_add_u32 m0, s14, 81920
    s_nop 0
    buffer_load_dwordx4 v36, s[40:43], s7 offen lds
    s_add_u32 m0, s14, 82944
    s_nop 0
    buffer_load_dwordx4 v37, s[40:43], s7 offen lds
    s_waitcnt vmcnt(20)
    s_barrier
    s_mov_b32 s7, 3328
    s_mov_b32 s8, 319488
    s_add_u32 m0, s15, 102400
    s_nop 0
    buffer_load_dwordx4 v40, s[44:47], s8 offen lds
    s_add_u32 m0, s15, 103424
    s_nop 0
    buffer_load_dwordx4 v41, s[44:47], s8 offen lds
    s_add_u32 m0, s15, 104448
    s_nop 0
    buffer_load_dwordx4 v42, s[44:47], s8 offen lds
    s_add_u32 m0, s14, 102400
    s_nop 0
    buffer_load_dwordx4 v36, s[40:43], s7 offen lds
    s_add_u32 m0, s14, 103424
    s_nop 0
    buffer_load_dwordx4 v37, s[40:43], s7 offen lds
    s_waitcnt vmcnt(20)
    s_barrier
    s_mov_b32 s7, 3456
    s_mov_b32 s8, 331776
    s_add_u32 m0, s15, 122880
    s_nop 0
    buffer_load_dwordx4 v40, s[44:47], s8 offen lds
    s_add_u32 m0, s15, 123904
    s_nop 0
    buffer_load_dwordx4 v41, s[44:47], s8 offen lds
    s_add_u32 m0, s15, 124928
    s_nop 0
    buffer_load_dwordx4 v42, s[44:47], s8 offen lds
    s_add_u32 m0, s14, 122880
    s_nop 0
    buffer_load_dwordx4 v36, s[40:43], s7 offen lds
    s_add_u32 m0, s14, 123904
    s_nop 0
    buffer_load_dwordx4 v37, s[40:43], s7 offen lds
    s_waitcnt vmcnt(20)
    s_barrier
    s_mov_b32 s7, 3584
    s_mov_b32 s8, 344064
    s_add_u32 m0, s15, 0
    s_nop 0
    buffer_load_dwordx4 v40, s[44:47], s8 offen lds
    s_add_u32 m0, s15, 1024
    s_nop 0
    buffer_load_dwordx4 v41, s[44:47], s8 offen lds
    s_add_u32 m0, s15, 2048
    s_nop 0
    buffer_load_dwordx4 v42, s[44:47], s8 offen lds
    s_add_u32 m0, s14, 0
    s_nop 0
    buffer_load_dwordx4 v36, s[40:43], s7 offen lds
    s_add_u32 m0, s14, 1024
    s_nop 0
    buffer_load_dwordx4 v37, s[40:43], s7 offen lds
    s_waitcnt vmcnt(20)
    s_barrier
    s_mov_b32 s7, 3712
    s_mov_b32 s8, 356352
    s_add_u32 m0, s15, 20480
    s_nop 0
    buffer_load_dwordx4 v40, s[44:47], s8 offen lds
    s_add_u32 m0, s15, 21504
    s_nop 0
    buffer_load_dwordx4 v41, s[44:47], s8 offen lds
    s_add_u32 m0, s15, 22528
    s_nop 0
    buffer_load_dwordx4 v42, s[44:47], s8 offen lds
    s_add_u32 m0, s14, 20480
    s_nop 0
    buffer_load_dwordx4 v36, s[40:43], s7 offen lds
    s_add_u32 m0, s14, 21504
    s_nop 0
    buffer_load_dwordx4 v37, s[40:43], s7 offen lds
    s_waitcnt vmcnt(20)
    s_barrier
    s_mov_b32 s7, 3840
    s_mov_b32 s8, 368640
    s_add_u32 m0, s15, 40960
    s_nop 0
    buffer_load_dwordx4 v40, s[44:47], s8 offen lds
    s_add_u32 m0, s15, 41984
    s_nop 0
    buffer_load_dwordx4 v41, s[44:47], s8 offen lds
    s_add_u32 m0, s15, 43008
    s_nop 0
    buffer_load_dwordx4 v42, s[44:47], s8 offen lds
    s_add_u32 m0, s14, 40960
    s_nop 0
    buffer_load_dwordx4 v36, s[40:43], s7 offen lds
    s_add_u32 m0, s14, 41984
    s_nop 0
    buffer_load_dwordx4 v37, s[40:43], s7 offen lds
    s_waitcnt vmcnt(20)
    s_barrier
    s_mov_b32 s7, 3968
    s_mov_b32 s8, 380928
    s_add_u32 m0, s15, 61440
    s_nop 0
    buffer_load_dwordx4 v40, s[44:47], s8 offen lds
    s_add_u32 m0, s15, 62464
    s_nop 0
    buffer_load_dwordx4 v41, s[44:47], s8 offen lds
    s_add_u32 m0, s15, 63488
    s_nop 0
    buffer_load_dwordx4 v42, s[44:47], s8 offen lds
    s_add_u32 m0, s14, 61440
    s_nop 0
    buffer_load_dwordx4 v36, s[40:43], s7 offen lds
    s_add_u32 m0, s14, 62464
    s_nop 0
    buffer_load_dwordx4 v37, s[40:43], s7 offen lds
    s_waitcnt vmcnt(20)
    s_barrier
    s_waitcnt vmcnt(15)
    s_barrier
    s_waitcnt vmcnt(10)
    s_barrier
    s_waitcnt vmcnt(5)
    s_barrier
    s_waitcnt vmcnt(0)
    s_barrier
    s_waitcnt vmcnt(0)
    s_barrier
    s_endpgm
L_comp_g4_kernel:
    s_waitcnt lgkmcnt(0)
    s_add_u32 s56, s36, 6291456
    s_addc_u32 s57, s37, 0
    s_mov_b32 s58, 2818048
    s_mov_b32 s59, 0x00020000
    s_add_u32 s52, s36, 15728640
    s_addc_u32 s53, s37, 0
    s_mov_b32 s54, 2883584
    s_mov_b32 s55, 0x00020000
    s_mov_b32 s72, s28
    s_mov_b32 s73, s29
    s_mov_b32 s74, 4096
    s_mov_b32 s75, 0x00020000
    v_lshrrev_b32 v5, 1, v2
    v_and_b32 v6, 1, v2
    v_lshl_add_u32 v5, v5, 5, v3
    v_add_u32 v5, s6, v5
    s_mul_i32 s12, s5, 96
    v_mul_u32_u24 v6, 48, v6
    v_lshl_add_u32 v6, v4, 2, v6
    v_add_u32 v6, s12, v6
    v_mul_u32_u24 v7, 1376, v5
    v_lshl_add_u32 v7, v6, 1, v7
    v_mul_u32_u24 v9, 1408, v5
    v_lshl_add_u32 v9, v6, 1, v9
    v_lshlrev_b32 v5, 1, v5
    v_mov_b32 v17, -1
    v_add_u32 v18, 0, v6
    v_cmp_gt_u32 vcc, 688, v18
    v_add_u32 v19, 0, v7
    s_nop 0
    v_cndmask_b32 v20, v17, v19, vcc
    v_cmp_gt_u32 vcc, 704, v18
    v_add_u32 v19, 0, v9
    s_nop 0
    v_cndmask_b32 v24, v17, v19, vcc
    v_add_u32 v18, 16, v6
    v_cmp_gt_u32 vcc, 688, v18
    v_add_u32 v19, 32, v7
    s_nop 0
    v_cndmask_b32 v21, v17, v19, vcc
    v_cmp_gt_u32 vcc, 704, v18
    v_add_u32 v19, 32, v9
    s_nop 0
    v_cndmask_b32 v25, v17, v19, vcc
    v_add_u32 v18, 32, v6
    v_cmp_gt_u32 vcc, 688, v18
    v_add_u32 v19, 64, v7
    s_nop 0
    v_cndmask_b32 v22, v17, v19, vcc
    v_cmp_gt_u32 vcc, 704, v18
    v_add_u32 v19, 64, v9
    s_nop 0
    v_cndmask_b32 v26, v17, v19, vcc
    buffer_load_ushort v28, v5, s[72:75], 0 offen
    buffer_load_ushort v29, v5, s[72:75], 0 offen offset:32
    s_mov_b32 s12, 22016
    s_mov_b32 s13, 22528
    buffer_load_dwordx2 v[40:41], v20, s[56:59], 0 offen
    buffer_load_dwordx2 v[42:43], v21, s[56:59], 0 offen
    buffer_load_dwordx2 v[44:45], v22, s[56:59], 0 offen
    buffer_load_dwordx2 v[46:47], v20, s[56:59], s12 offen
    buffer_load_dwordx2 v[48:49], v21, s[56:59], s12 offen
    buffer_load_dwordx2 v[50:51], v22, s[56:59], s12 offen
    v_lshrrev_b32 v9, 1, v2
    v_add_u32 v7, 0, v4
    v_and_b32 v17, 7, v3
    v_xor_b32 v7, v7, v17
    v_lshlrev_b32 v7, 4, v7
    v_lshl_add_u32 v14, v3, 7, v7
    v_lshl_add_u32 v14, v9, 12, v14
    v_add_u32 v7, 4, v4
    v_and_b32 v17, 7, v3
    v_xor_b32 v7, v7, v17
    v_lshlrev_b32 v7, 4, v7
    v_lshl_add_u32 v15, v3, 7, v7
    v_lshl_add_u32 v15, v9, 12, v15
    v_and_b32 v9, 1, v2
    v_mul_u32_u24 v9, 3, v9
    v_add_u32 v9, 0, v9
    v_lshrrev_b32 v5, 2, v3
    v_lshl_add_u32 v5, v4, 3, v5
    v_bfe_u32 v6, v5, 3, 1
    v_xor_b32 v6, v6, v9
    v_mul_u32_u24 v5, 192, v5
    v_lshl_add_u32 v5, v6, 5, v5
    v_and_b32 v6, 3, v3
    v_lshl_add_u32 v5, v6, 3, v5
    v_add_u32 v16, 8192, v5
    v_and_b32 v9, 1, v2
    v_mul_u32_u24 v9, 3, v9
    v_add_u32 v9, 1, v9
    v_lshrrev_b32 v5, 2, v3
    v_lshl_add_u32 v5, v4, 3, v5
    v_bfe_u32 v6, v5, 3, 1
    v_xor_b32 v6, v6, v9
    v_mul_u32_u24 v5, 192, v5
    v_lshl_add_u32 v5, v6, 5, v5
    v_and_b32 v6, 3, v3
    v_lshl_add_u32 v5, v6, 3, v5
    v_add_u32 v17, 8192, v5
    v_and_b32 v9, 1, v2
    v_mul_u32_u24 v9, 3, v9
    v_add_u32 v9, 2, v9
    v_lshrrev_b32 v5, 2, v3
    v_lshl_add_u32 v5, v4, 3, v5
    v_bfe_u32 v6, v5, 3, 1
    v_xor_b32 v6, v6, v9
    v_mul_u32_u24 v5, 192, v5
    v_lshl_add_u32 v5, v6, 5, v5
    v_and_b32 v6, 3, v3
    v_lshl_add_u32 v5, v6, 3, v5
    v_add_u32 v18, 8192, v5
    v_add_u32 v212, 20480, v14
    v_add_u32 v213, 20480, v15
    v_add_u32 v214, 20480, v16
    v_add_u32 v215, 20480, v17
    v_add_u32 v216, 20480, v18
    v_add_u32 v217, 40960, v14
    v_add_u32 v218, 40960, v15
    v_add_u32 v219, 40960, v16
    v_add_u32 v220, 40960, v17
    v_add_u32 v221, 40960, v18
    v_add_u32 v222, 61440, v14
    v_add_u32 v223, 61440, v15
    v_add_u32 v224, 61440, v16
    v_add_u32 v225, 61440, v17
    v_add_u32 v226, 61440, v18
    v_add_u32 v227, 81920, v14
    v_add_u32 v228, 81920, v15
    v_add_u32 v229, 81920, v16
    v_add_u32 v230, 81920, v17
    v_add_u32 v231, 81920, v18
    v_add_u32 v232, 102400, v14
    v_add_u32 v233, 102400, v15
    v_add_u32 v234, 102400, v16
    v_add_u32 v235, 102400, v17
    v_add_u32 v236, 102400, v18
    v_add_u32 v237, 122880, v14
    v_add_u32 v238, 122880, v15
    v_add_u32 v239, 122880, v16
    v_add_u32 v240, 122880, v17
    v_add_u32 v241, 122880, v18
    v_mov_b32 v120, 0
    v_mov_b32 v121, 0
    v_mov_b32 v122, 0
    v_mov_b32 v123, 0
    v_mov_b32 v124, 0
    v_mov_b32 v125, 0
    v_mov_b32 v126, 0
    v_mov_b32 v127, 0
    v_mov_b32 v128, 0
    v_mov_b32 v129, 0
    v_mov_b32 v130, 0
    v_mov_b32 v131, 0
    v_mov_b32 v132, 0
    v_mov_b32 v133, 0
    v_mov_b32 v134, 0
    v_mov_b32 v135, 0
    v_mov_b32 v136, 0
    v_mov_b32 v137, 0
    v_mov_b32 v138, 0
    v_mov_b32 v139, 0
    v_mov_b32 v140, 0
    v_mov_b32 v141, 0
    v_mov_b32 v142, 0
    v_mov_b32 v143, 0
    s_barrier
    ds_read_b64_tr_b16 v[76:77], v16 offset:0
    ds_read_b64_tr_b16 v[78:79], v16 offset:768
    ds_read_b64_tr_b16 v[80:81], v17 offset:0
    ds_read_b64_tr_b16 v[82:83], v17 offset:768
    ds_read_b64_tr_b16 v[84:85], v18 offset:0
    ds_read_b64_tr_b16 v[86:87], v18 offset:768
    ds_read_b128 v[56:59], v14 offset:0
    ds_read_b128 v[60:63], v14 offset:2048
    s_waitcnt lgkmcnt(0)
    v_mfma_f32_16x16x32_bf16 v[120:123], v[76:79], v[56:59], v[120:123]
    ds_read_b64_tr_b16 v[108:109], v16 offset:6144
    ds_read_b64_tr_b16 v[110:111], v16 offset:6912
    v_mfma_f32_16x16x32_bf16 v[124:127], v[80:83], v[56:59], v[124:127]
    ds_read_b64_tr_b16 v[112:113], v17 offset:6144
    ds_read_b64_tr_b16 v[114:115], v17 offset:6912
    v_mfma_f32_16x16x32_bf16 v[128:131], v[84:87], v[56:59], v[128:131]
    ds_read_b64_tr_b16 v[116:117], v18 offset:6144
    ds_read_b64_tr_b16 v[118:119], v18 offset:6912
    v_mfma_f32_16x16x32_bf16 v[132:135], v[76:79], v[60:63], v[132:135]
    ds_read_b128 v[88:91], v15 offset:0
    ds_read_b128 v[92:95], v15 offset:2048
    v_mfma_f32_16x16x32_bf16 v[136:139], v[80:83], v[60:63], v[136:139]
    v_mfma_f32_16x16x32_bf16 v[140:143], v[84:87], v[60:63], v[140:143]
    s_waitcnt lgkmcnt(0)
    v_mfma_f32_16x16x32_bf16 v[120:123], v[108:111], v[88:91], v[120:123]
    v_mfma_f32_16x16x32_bf16 v[124:127], v[112:115], v[88:91], v[124:127]
    v_mfma_f32_16x16x32_bf16 v[128:131], v[116:119], v[88:91], v[128:131]
    v_mfma_f32_16x16x32_bf16 v[132:135], v[108:111], v[92:95], v[132:135]
    v_mfma_f32_16x16x32_bf16 v[136:139], v[112:115], v[92:95], v[136:139]
    v_mfma_f32_16x16x32_bf16 v[140:143], v[116:119], v[92:95], v[140:143]
    s_barrier
    ds_read_b64_tr_b16 v[76:77], v214 offset:0
    ds_read_b64_tr_b16 v[78:79], v214 offset:768
    ds_read_b64_tr_b16 v[80:81], v215 offset:0
    ds_read_b64_tr_b16 v[82:83], v215 offset:768
    ds_read_b64_tr_b16 v[84:85], v216 offset:0
    ds_read_b64_tr_b16 v[86:87], v216 offset:768
    ds_read_b128 v[56:59], v212 offset:0
    ds_read_b128 v[60:63], v212 offset:2048
    s_waitcnt lgkmcnt(0)
    v_mfma_f32_16x16x32_bf16 v[120:123], v[76:79], v[56:59], v[120:123]
    ds_read_b64_tr_b16 v[108:109], v214 offset:6144
    ds_read_b64_tr_b16 v[110:111], v214 offset:6912
    v_mfma_f32_16x16x32_bf16 v[124:127], v[80:83], v[56:59], v[124:127]
    ds_read_b64_tr_b16 v[112:113], v215 offset:6144
    ds_read_b64_tr_b16 v[114:115], v215 offset:6912
    v_mfma_f32_16x16x32_bf16 v[128:131], v[84:87], v[56:59], v[128:131]
    ds_read_b64_tr_b16 v[116:117], v216 offset:6144
    ds_read_b64_tr_b16 v[118:119], v216 offset:6912
    v_mfma_f32_16x16x32_bf16 v[132:135], v[76:79], v[60:63], v[132:135]
    ds_read_b128 v[88:91], v213 offset:0
    ds_read_b128 v[92:95], v213 offset:2048
    v_mfma_f32_16x16x32_bf16 v[136:139], v[80:83], v[60:63], v[136:139]
    v_mfma_f32_16x16x32_bf16 v[140:143], v[84:87], v[60:63], v[140:143]
    s_waitcnt lgkmcnt(0)
    v_mfma_f32_16x16x32_bf16 v[120:123], v[108:111], v[88:91], v[120:123]
    ds_read_b64_tr_b16 v[76:77], v219 offset:0
    ds_read_b64_tr_b16 v[78:79], v219 offset:768
    v_mfma_f32_16x16x32_bf16 v[124:127], v[112:115], v[88:91], v[124:127]
    ds_read_b64_tr_b16 v[80:81], v220 offset:0
    ds_read_b64_tr_b16 v[82:83], v220 offset:768
    v_mfma_f32_16x16x32_bf16 v[128:131], v[116:119], v[88:91], v[128:131]
    ds_read_b64_tr_b16 v[84:85], v221 offset:0
    ds_read_b64_tr_b16 v[86:87], v221 offset:768
    v_mfma_f32_16x16x32_bf16 v[132:135], v[108:111], v[92:95], v[132:135]
    ds_read_b128 v[56:59], v217 offset:0
    ds_read_b128 v[60:63], v217 offset:2048
    v_mfma_f32_16x16x32_bf16 v[136:139], v[112:115], v[92:95], v[136:139]
    v_mfma_f32_16x16x32_bf16 v[140:143], v[116:119], v[92:95], v[140:143]
    s_barrier
    s_waitcnt lgkmcnt(0)
    v_mfma_f32_16x16x32_bf16 v[120:123], v[76:79], v[56:59], v[120:123]
    ds_read_b64_tr_b16 v[108:109], v219 offset:6144
    ds_read_b64_tr_b16 v[110:111], v219 offset:6912
    v_mfma_f32_16x16x32_bf16 v[124:127], v[80:83], v[56:59], v[124:127]
    ds_read_b64_tr_b16 v[112:113], v220 offset:6144
    ds_read_b64_tr_b16 v[114:115], v220 offset:6912
    v_mfma_f32_16x16x32_bf16 v[128:131], v[84:87], v[56:59], v[128:131]
    ds_read_b64_tr_b16 v[116:117], v221 offset:6144
    ds_read_b64_tr_b16 v[118:119], v221 offset:6912
    v_mfma_f32_16x16x32_bf16 v[132:135], v[76:79], v[60:63], v[132:135]
    ds_read_b128 v[88:91], v218 offset:0
    ds_read_b128 v[92:95], v218 offset:2048
    v_mfma_f32_16x16x32_bf16 v[136:139], v[80:83], v[60:63], v[136:139]
    v_mfma_f32_16x16x32_bf16 v[140:143], v[84:87], v[60:63], v[140:143]
    s_waitcnt lgkmcnt(0)
    v_mfma_f32_16x16x32_bf16 v[120:123], v[108:111], v[88:91], v[120:123]
    ds_read_b64_tr_b16 v[76:77], v224 offset:0
    ds_read_b64_tr_b16 v[78:79], v224 offset:768
    v_mfma_f32_16x16x32_bf16 v[124:127], v[112:115], v[88:91], v[124:127]
    ds_read_b64_tr_b16 v[80:81], v225 offset:0
    ds_read_b64_tr_b16 v[82:83], v225 offset:768
    v_mfma_f32_16x16x32_bf16 v[128:131], v[116:119], v[88:91], v[128:131]
    ds_read_b64_tr_b16 v[84:85], v226 offset:0
    ds_read_b64_tr_b16 v[86:87], v226 offset:768
    v_mfma_f32_16x16x32_bf16 v[132:135], v[108:111], v[92:95], v[132:135]
    ds_read_b128 v[56:59], v222 offset:0
    ds_read_b128 v[60:63], v222 offset:2048
    v_mfma_f32_16x16x32_bf16 v[136:139], v[112:115], v[92:95], v[136:139]
    v_mfma_f32_16x16x32_bf16 v[140:143], v[116:119], v[92:95], v[140:143]
    s_barrier
    s_waitcnt lgkmcnt(0)
    v_mfma_f32_16x16x32_bf16 v[120:123], v[76:79], v[56:59], v[120:123]
    ds_read_b64_tr_b16 v[108:109], v224 offset:6144
    ds_read_b64_tr_b16 v[110:111], v224 offset:6912
    v_mfma_f32_16x16x32_bf16 v[124:127], v[80:83], v[56:59], v[124:127]
    ds_read_b64_tr_b16 v[112:113], v225 offset:6144
    ds_read_b64_tr_b16 v[114:115], v225 offset:6912
    v_mfma_f32_16x16x32_bf16 v[128:131], v[84:87], v[56:59], v[128:131]
    ds_read_b64_tr_b16 v[116:117], v226 offset:6144
    ds_read_b64_tr_b16 v[118:119], v226 offset:6912
    v_mfma_f32_16x16x32_bf16 v[132:135], v[76:79], v[60:63], v[132:135]
    ds_read_b128 v[88:91], v223 offset:0
    ds_read_b128 v[92:95], v223 offset:2048
    v_mfma_f32_16x16x32_bf16 v[136:139], v[80:83], v[60:63], v[136:139]
    v_mfma_f32_16x16x32_bf16 v[140:143], v[84:87], v[60:63], v[140:143]
    s_waitcnt lgkmcnt(0)
    v_mfma_f32_16x16x32_bf16 v[120:123], v[108:111], v[88:91], v[120:123]
    ds_read_b64_tr_b16 v[76:77], v229 offset:0
    ds_read_b64_tr_b16 v[78:79], v229 offset:768
    v_mfma_f32_16x16x32_bf16 v[124:127], v[112:115], v[88:91], v[124:127]
    ds_read_b64_tr_b16 v[80:81], v230 offset:0
    ds_read_b64_tr_b16 v[82:83], v230 offset:768
    v_mfma_f32_16x16x32_bf16 v[128:131], v[116:119], v[88:91], v[128:131]
    ds_read_b64_tr_b16 v[84:85], v231 offset:0
    ds_read_b64_tr_b16 v[86:87], v231 offset:768
    v_mfma_f32_16x16x32_bf16 v[132:135], v[108:111], v[92:95], v[132:135]
    ds_read_b128 v[56:59], v227 offset:0
    ds_read_b128 v[60:63], v227 offset:2048
    v_mfma_f32_16x16x32_bf16 v[136:139], v[112:115], v[92:95], v[136:139]
    v_mfma_f32_16x16x32_bf16 v[140:143], v[116:119], v[92:95], v[140:143]
    s_barrier
    s_waitcnt lgkmcnt(0)
    v_mfma_f32_16x16x32_bf16 v[120:123], v[76:79], v[56:59], v[120:123]
    ds_read_b64_tr_b16 v[108:109], v229 offset:6144
    ds_read_b64_tr_b16 v[110:111], v229 offset:6912
    v_mfma_f32_16x16x32_bf16 v[124:127], v[80:83], v[56:59], v[124:127]
    ds_read_b64_tr_b16 v[112:113], v230 offset:6144
    ds_read_b64_tr_b16 v[114:115], v230 offset:6912
    v_mfma_f32_16x16x32_bf16 v[128:131], v[84:87], v[56:59], v[128:131]
    ds_read_b64_tr_b16 v[116:117], v231 offset:6144
    ds_read_b64_tr_b16 v[118:119], v231 offset:6912
    v_mfma_f32_16x16x32_bf16 v[132:135], v[76:79], v[60:63], v[132:135]
    ds_read_b128 v[88:91], v228 offset:0
    ds_read_b128 v[92:95], v228 offset:2048
    v_mfma_f32_16x16x32_bf16 v[136:139], v[80:83], v[60:63], v[136:139]
    v_mfma_f32_16x16x32_bf16 v[140:143], v[84:87], v[60:63], v[140:143]
    s_waitcnt lgkmcnt(0)
    v_mfma_f32_16x16x32_bf16 v[120:123], v[108:111], v[88:91], v[120:123]
    ds_read_b64_tr_b16 v[76:77], v234 offset:0
    ds_read_b64_tr_b16 v[78:79], v234 offset:768
    v_mfma_f32_16x16x32_bf16 v[124:127], v[112:115], v[88:91], v[124:127]
    ds_read_b64_tr_b16 v[80:81], v235 offset:0
    ds_read_b64_tr_b16 v[82:83], v235 offset:768
    v_mfma_f32_16x16x32_bf16 v[128:131], v[116:119], v[88:91], v[128:131]
    ds_read_b64_tr_b16 v[84:85], v236 offset:0
    ds_read_b64_tr_b16 v[86:87], v236 offset:768
    v_mfma_f32_16x16x32_bf16 v[132:135], v[108:111], v[92:95], v[132:135]
    ds_read_b128 v[56:59], v232 offset:0
    ds_read_b128 v[60:63], v232 offset:2048
    v_mfma_f32_16x16x32_bf16 v[136:139], v[112:115], v[92:95], v[136:139]
    v_mfma_f32_16x16x32_bf16 v[140:143], v[116:119], v[92:95], v[140:143]
    s_barrier
    s_waitcnt lgkmcnt(0)
    v_mfma_f32_16x16x32_bf16 v[120:123], v[76:79], v[56:59], v[120:123]
    ds_read_b64_tr_b16 v[108:109], v234 offset:6144
    ds_read_b64_tr_b16 v[110:111], v234 offset:6912
    v_mfma_f32_16x16x32_bf16 v[124:127], v[80:83], v[56:59], v[124:127]
    ds_read_b64_tr_b16 v[112:113], v235 offset:6144
    ds_read_b64_tr_b16 v[114:115], v235 offset:6912
    v_mfma_f32_16x16x32_bf16 v[128:131], v[84:87], v[56:59], v[128:131]
    ds_read_b64_tr_b16 v[116:117], v236 offset:6144
    ds_read_b64_tr_b16 v[118:119], v236 offset:6912
    v_mfma_f32_16x16x32_bf16 v[132:135], v[76:79], v[60:63], v[132:135]
    ds_read_b128 v[88:91], v233 offset:0
    ds_read_b128 v[92:95], v233 offset:2048
    v_mfma_f32_16x16x32_bf16 v[136:139], v[80:83], v[60:63], v[136:139]
    v_mfma_f32_16x16x32_bf16 v[140:143], v[84:87], v[60:63], v[140:143]
    s_waitcnt lgkmcnt(0)
    v_mfma_f32_16x16x32_bf16 v[120:123], v[108:111], v[88:91], v[120:123]
    ds_read_b64_tr_b16 v[76:77], v239 offset:0
    ds_read_b64_tr_b16 v[78:79], v239 offset:768
    v_mfma_f32_16x16x32_bf16 v[124:127], v[112:115], v[88:91], v[124:127]
    ds_read_b64_tr_b16 v[80:81], v240 offset:0
    ds_read_b64_tr_b16 v[82:83], v240 offset:768
    v_mfma_f32_16x16x32_bf16 v[128:131], v[116:119], v[88:91], v[128:131]
    ds_read_b64_tr_b16 v[84:85], v241 offset:0
    ds_read_b64_tr_b16 v[86:87], v241 offset:768
    v_mfma_f32_16x16x32_bf16 v[132:135], v[108:111], v[92:95], v[132:135]
    ds_read_b128 v[56:59], v237 offset:0
    ds_read_b128 v[60:63], v237 offset:2048
    v_mfma_f32_16x16x32_bf16 v[136:139], v[112:115], v[92:95], v[136:139]
    v_mfma_f32_16x16x32_bf16 v[140:143], v[116:119], v[92:95], v[140:143]
    s_barrier
    s_waitcnt lgkmcnt(0)
    v_mfma_f32_16x16x32_bf16 v[120:123], v[76:79], v[56:59], v[120:123]
    ds_read_b64_tr_b16 v[108:109], v239 offset:6144
    ds_read_b64_tr_b16 v[110:111], v239 offset:6912
    v_mfma_f32_16x16x32_bf16 v[124:127], v[80:83], v[56:59], v[124:127]
    ds_read_b64_tr_b16 v[112:113], v240 offset:6144
    ds_read_b64_tr_b16 v[114:115], v240 offset:6912
    v_mfma_f32_16x16x32_bf16 v[128:131], v[84:87], v[56:59], v[128:131]
    ds_read_b64_tr_b16 v[116:117], v241 offset:6144
    ds_read_b64_tr_b16 v[118:119], v241 offset:6912
    v_mfma_f32_16x16x32_bf16 v[132:135], v[76:79], v[60:63], v[132:135]
    ds_read_b128 v[88:91], v238 offset:0
    ds_read_b128 v[92:95], v238 offset:2048
    v_mfma_f32_16x16x32_bf16 v[136:139], v[80:83], v[60:63], v[136:139]
    v_mfma_f32_16x16x32_bf16 v[140:143], v[84:87], v[60:63], v[140:143]
    s_waitcnt lgkmcnt(0)
    v_mfma_f32_16x16x32_bf16 v[120:123], v[108:111], v[88:91], v[120:123]
    ds_read_b64_tr_b16 v[76:77], v16 offset:0
    ds_read_b64_tr_b16 v[78:79], v16 offset:768
    v_mfma_f32_16x16x32_bf16 v[124:127], v[112:115], v[88:91], v[124:127]
    ds_read_b64_tr_b16 v[80:81], v17 offset:0
    ds_read_b64_tr_b16 v[82:83], v17 offset:768
    v_mfma_f32_16x16x32_bf16 v[128:131], v[116:119], v[88:91], v[128:131]
    ds_read_b64_tr_b16 v[84:85], v18 offset:0
    ds_read_b64_tr_b16 v[86:87], v18 offset:768
    v_mfma_f32_16x16x32_bf16 v[132:135], v[108:111], v[92:95], v[132:135]
    ds_read_b128 v[56:59], v14 offset:0
    ds_read_b128 v[60:63], v14 offset:2048
    v_mfma_f32_16x16x32_bf16 v[136:139], v[112:115], v[92:95], v[136:139]
    v_mfma_f32_16x16x32_bf16 v[140:143], v[116:119], v[92:95], v[140:143]
    s_barrier
    s_waitcnt lgkmcnt(0)
    v_mfma_f32_16x16x32_bf16 v[120:123], v[76:79], v[56:59], v[120:123]
    ds_read_b64_tr_b16 v[108:109], v16 offset:6144
    ds_read_b64_tr_b16 v[110:111], v16 offset:6912
    v_mfma_f32_16x16x32_bf16 v[124:127], v[80:83], v[56:59], v[124:127]
    ds_read_b64_tr_b16 v[112:113], v17 offset:6144
    ds_read_b64_tr_b16 v[114:115], v17 offset:6912
    v_mfma_f32_16x16x32_bf16 v[128:131], v[84:87], v[56:59], v[128:131]
    ds_read_b64_tr_b16 v[116:117], v18 offset:6144
    ds_read_b64_tr_b16 v[118:119], v18 offset:6912
    v_mfma_f32_16x16x32_bf16 v[132:135], v[76:79], v[60:63], v[132:135]
    ds_read_b128 v[88:91], v15 offset:0
    ds_read_b128 v[92:95], v15 offset:2048
    v_mfma_f32_16x16x32_bf16 v[136:139], v[80:83], v[60:63], v[136:139]
    v_mfma_f32_16x16x32_bf16 v[140:143], v[84:87], v[60:63], v[140:143]
    s_waitcnt lgkmcnt(0)
    v_mfma_f32_16x16x32_bf16 v[120:123], v[108:111], v[88:91], v[120:123]
    ds_read_b64_tr_b16 v[76:77], v214 offset:0
    ds_read_b64_tr_b16 v[78:79], v214 offset:768
    v_mfma_f32_16x16x32_bf16 v[124:127], v[112:115], v[88:91], v[124:127]
    ds_read_b64_tr_b16 v[80:81], v215 offset:0
    ds_read_b64_tr_b16 v[82:83], v215 offset:768
    v_mfma_f32_16x16x32_bf16 v[128:131], v[116:119], v[88:91], v[128:131]
    ds_read_b64_tr_b16 v[84:85], v216 offset:0
    ds_read_b64_tr_b16 v[86:87], v216 offset:768
    v_mfma_f32_16x16x32_bf16 v[132:135], v[108:111], v[92:95], v[132:135]
    ds_read_b128 v[56:59], v212 offset:0
    ds_read_b128 v[60:63], v212 offset:2048
    v_mfma_f32_16x16x32_bf16 v[136:139], v[112:115], v[92:95], v[136:139]
    v_mfma_f32_16x16x32_bf16 v[140:143], v[116:119], v[92:95], v[140:143]
    s_barrier
    s_waitcnt lgkmcnt(0)
    v_mfma_f32_16x16x32_bf16 v[120:123], v[76:79], v[56:59], v[120:123]
    ds_read_b64_tr_b16 v[108:109], v214 offset:6144
    ds_read_b64_tr_b16 v[110:111], v214 offset:6912
    v_mfma_f32_16x16x32_bf16 v[124:127], v[80:83], v[56:59], v[124:127]
    ds_read_b64_tr_b16 v[112:113], v215 offset:6144
    ds_read_b64_tr_b16 v[114:115], v215 offset:6912
    v_mfma_f32_16x16x32_bf16 v[128:131], v[84:87], v[56:59], v[128:131]
    ds_read_b64_tr_b16 v[116:117], v216 offset:6144
    ds_read_b64_tr_b16 v[118:119], v216 offset:6912
    v_mfma_f32_16x16x32_bf16 v[132:135], v[76:79], v[60:63], v[132:135]
    ds_read_b128 v[88:91], v213 offset:0
    ds_read_b128 v[92:95], v213 offset:2048
    v_mfma_f32_16x16x32_bf16 v[136:139], v[80:83], v[60:63], v[136:139]
    v_mfma_f32_16x16x32_bf16 v[140:143], v[84:87], v[60:63], v[140:143]
    s_waitcnt lgkmcnt(0)
    v_mfma_f32_16x16x32_bf16 v[120:123], v[108:111], v[88:91], v[120:123]
    ds_read_b64_tr_b16 v[76:77], v219 offset:0
    ds_read_b64_tr_b16 v[78:79], v219 offset:768
    v_mfma_f32_16x16x32_bf16 v[124:127], v[112:115], v[88:91], v[124:127]
    ds_read_b64_tr_b16 v[80:81], v220 offset:0
    ds_read_b64_tr_b16 v[82:83], v220 offset:768
    v_mfma_f32_16x16x32_bf16 v[128:131], v[116:119], v[88:91], v[128:131]
    ds_read_b64_tr_b16 v[84:85], v221 offset:0
    ds_read_b64_tr_b16 v[86:87], v221 offset:768
    v_mfma_f32_16x16x32_bf16 v[132:135], v[108:111], v[92:95], v[132:135]
    ds_read_b128 v[56:59], v217 offset:0
    ds_read_b128 v[60:63], v217 offset:2048
    v_mfma_f32_16x16x32_bf16 v[136:139], v[112:115], v[92:95], v[136:139]
    v_mfma_f32_16x16x32_bf16 v[140:143], v[116:119], v[92:95], v[140:143]
    s_barrier
    s_waitcnt lgkmcnt(0)
    v_mfma_f32_16x16x32_bf16 v[120:123], v[76:79], v[56:59], v[120:123]
    ds_read_b64_tr_b16 v[108:109], v219 offset:6144
    ds_read_b64_tr_b16 v[110:111], v219 offset:6912
    v_mfma_f32_16x16x32_bf16 v[124:127], v[80:83], v[56:59], v[124:127]
    ds_read_b64_tr_b16 v[112:113], v220 offset:6144
    ds_read_b64_tr_b16 v[114:115], v220 offset:6912
    v_mfma_f32_16x16x32_bf16 v[128:131], v[84:87], v[56:59], v[128:131]
    ds_read_b64_tr_b16 v[116:117], v221 offset:6144
    ds_read_b64_tr_b16 v[118:119], v221 offset:6912
    v_mfma_f32_16x16x32_bf16 v[132:135], v[76:79], v[60:63], v[132:135]
    ds_read_b128 v[88:91], v218 offset:0
    ds_read_b128 v[92:95], v218 offset:2048
    v_mfma_f32_16x16x32_bf16 v[136:139], v[80:83], v[60:63], v[136:139]
    v_mfma_f32_16x16x32_bf16 v[140:143], v[84:87], v[60:63], v[140:143]
    s_waitcnt lgkmcnt(0)
    v_mfma_f32_16x16x32_bf16 v[120:123], v[108:111], v[88:91], v[120:123]
    ds_read_b64_tr_b16 v[76:77], v224 offset:0
    ds_read_b64_tr_b16 v[78:79], v224 offset:768
    v_mfma_f32_16x16x32_bf16 v[124:127], v[112:115], v[88:91], v[124:127]
    ds_read_b64_tr_b16 v[80:81], v225 offset:0
    ds_read_b64_tr_b16 v[82:83], v225 offset:768
    v_mfma_f32_16x16x32_bf16 v[128:131], v[116:119], v[88:91], v[128:131]
    ds_read_b64_tr_b16 v[84:85], v226 offset:0
    ds_read_b64_tr_b16 v[86:87], v226 offset:768
    v_mfma_f32_16x16x32_bf16 v[132:135], v[108:111], v[92:95], v[132:135]
    ds_read_b128 v[56:59], v222 offset:0
    ds_read_b128 v[60:63], v222 offset:2048
    v_mfma_f32_16x16x32_bf16 v[136:139], v[112:115], v[92:95], v[136:139]
    v_mfma_f32_16x16x32_bf16 v[140:143], v[116:119], v[92:95], v[140:143]
    s_barrier
    s_waitcnt lgkmcnt(0)
    v_mfma_f32_16x16x32_bf16 v[120:123], v[76:79], v[56:59], v[120:123]
    ds_read_b64_tr_b16 v[108:109], v224 offset:6144
    ds_read_b64_tr_b16 v[110:111], v224 offset:6912
    v_mfma_f32_16x16x32_bf16 v[124:127], v[80:83], v[56:59], v[124:127]
    ds_read_b64_tr_b16 v[112:113], v225 offset:6144
    ds_read_b64_tr_b16 v[114:115], v225 offset:6912
    v_mfma_f32_16x16x32_bf16 v[128:131], v[84:87], v[56:59], v[128:131]
    ds_read_b64_tr_b16 v[116:117], v226 offset:6144
    ds_read_b64_tr_b16 v[118:119], v226 offset:6912
    v_mfma_f32_16x16x32_bf16 v[132:135], v[76:79], v[60:63], v[132:135]
    ds_read_b128 v[88:91], v223 offset:0
    ds_read_b128 v[92:95], v223 offset:2048
    v_mfma_f32_16x16x32_bf16 v[136:139], v[80:83], v[60:63], v[136:139]
    v_mfma_f32_16x16x32_bf16 v[140:143], v[84:87], v[60:63], v[140:143]
    s_waitcnt lgkmcnt(0)
    v_mfma_f32_16x16x32_bf16 v[120:123], v[108:111], v[88:91], v[120:123]
    ds_read_b64_tr_b16 v[76:77], v229 offset:0
    ds_read_b64_tr_b16 v[78:79], v229 offset:768
    v_mfma_f32_16x16x32_bf16 v[124:127], v[112:115], v[88:91], v[124:127]
    ds_read_b64_tr_b16 v[80:81], v230 offset:0
    ds_read_b64_tr_b16 v[82:83], v230 offset:768
    v_mfma_f32_16x16x32_bf16 v[128:131], v[116:119], v[88:91], v[128:131]
    ds_read_b64_tr_b16 v[84:85], v231 offset:0
    ds_read_b64_tr_b16 v[86:87], v231 offset:768
    v_mfma_f32_16x16x32_bf16 v[132:135], v[108:111], v[92:95], v[132:135]
    ds_read_b128 v[56:59], v227 offset:0
    ds_read_b128 v[60:63], v227 offset:2048
    v_mfma_f32_16x16x32_bf16 v[136:139], v[112:115], v[92:95], v[136:139]
    v_mfma_f32_16x16x32_bf16 v[140:143], v[116:119], v[92:95], v[140:143]
    s_barrier
    s_waitcnt lgkmcnt(0)
    v_mfma_f32_16x16x32_bf16 v[120:123], v[76:79], v[56:59], v[120:123]
    ds_read_b64_tr_b16 v[108:109], v229 offset:6144
    ds_read_b64_tr_b16 v[110:111], v229 offset:6912
    v_mfma_f32_16x16x32_bf16 v[124:127], v[80:83], v[56:59], v[124:127]
    ds_read_b64_tr_b16 v[112:113], v230 offset:6144
    ds_read_b64_tr_b16 v[114:115], v230 offset:6912
    v_mfma_f32_16x16x32_bf16 v[128:131], v[84:87], v[56:59], v[128:131]
    ds_read_b64_tr_b16 v[116:117], v231 offset:6144
    ds_read_b64_tr_b16 v[118:119], v231 offset:6912
    v_mfma_f32_16x16x32_bf16 v[132:135], v[76:79], v[60:63], v[132:135]
    ds_read_b128 v[88:91], v228 offset:0
    ds_read_b128 v[92:95], v228 offset:2048
    v_mfma_f32_16x16x32_bf16 v[136:139], v[80:83], v[60:63], v[136:139]
    v_mfma_f32_16x16x32_bf16 v[140:143], v[84:87], v[60:63], v[140:143]
    s_waitcnt lgkmcnt(0)
    v_mfma_f32_16x16x32_bf16 v[120:123], v[108:111], v[88:91], v[120:123]
    ds_read_b64_tr_b16 v[76:77], v234 offset:0
    ds_read_b64_tr_b16 v[78:79], v234 offset:768
    v_mfma_f32_16x16x32_bf16 v[124:127], v[112:115], v[88:91], v[124:127]
    ds_read_b64_tr_b16 v[80:81], v235 offset:0
    ds_read_b64_tr_b16 v[82:83], v235 offset:768
    v_mfma_f32_16x16x32_bf16 v[128:131], v[116:119], v[88:91], v[128:131]
    ds_read_b64_tr_b16 v[84:85], v236 offset:0
    ds_read_b64_tr_b16 v[86:87], v236 offset:768
    v_mfma_f32_16x16x32_bf16 v[132:135], v[108:111], v[92:95], v[132:135]
    ds_read_b128 v[56:59], v232 offset:0
    ds_read_b128 v[60:63], v232 offset:2048
    v_mfma_f32_16x16x32_bf16 v[136:139], v[112:115], v[92:95], v[136:139]
    v_mfma_f32_16x16x32_bf16 v[140:143], v[116:119], v[92:95], v[140:143]
    s_barrier
    s_waitcnt lgkmcnt(0)
    v_mfma_f32_16x16x32_bf16 v[120:123], v[76:79], v[56:59], v[120:123]
    ds_read_b64_tr_b16 v[108:109], v234 offset:6144
    ds_read_b64_tr_b16 v[110:111], v234 offset:6912
    v_mfma_f32_16x16x32_bf16 v[124:127], v[80:83], v[56:59], v[124:127]
    ds_read_b64_tr_b16 v[112:113], v235 offset:6144
    ds_read_b64_tr_b16 v[114:115], v235 offset:6912
    v_mfma_f32_16x16x32_bf16 v[128:131], v[84:87], v[56:59], v[128:131]
    ds_read_b64_tr_b16 v[116:117], v236 offset:6144
    ds_read_b64_tr_b16 v[118:119], v236 offset:6912
    v_mfma_f32_16x16x32_bf16 v[132:135], v[76:79], v[60:63], v[132:135]
    ds_read_b128 v[88:91], v233 offset:0
    ds_read_b128 v[92:95], v233 offset:2048
    v_mfma_f32_16x16x32_bf16 v[136:139], v[80:83], v[60:63], v[136:139]
    v_mfma_f32_16x16x32_bf16 v[140:143], v[84:87], v[60:63], v[140:143]
    s_waitcnt lgkmcnt(0)
    v_mfma_f32_16x16x32_bf16 v[120:123], v[108:111], v[88:91], v[120:123]
    ds_read_b64_tr_b16 v[76:77], v239 offset:0
    ds_read_b64_tr_b16 v[78:79], v239 offset:768
    v_mfma_f32_16x16x32_bf16 v[124:127], v[112:115], v[88:91], v[124:127]
    ds_read_b64_tr_b16 v[80:81], v240 offset:0
    ds_read_b64_tr_b16 v[82:83], v240 offset:768
    v_mfma_f32_16x16x32_bf16 v[128:131], v[116:119], v[88:91], v[128:131]
    ds_read_b64_tr_b16 v[84:85], v241 offset:0
    ds_read_b64_tr_b16 v[86:87], v241 offset:768
    v_mfma_f32_16x16x32_bf16 v[132:135], v[108:111], v[92:95], v[132:135]
    ds_read_b128 v[56:59], v237 offset:0
    ds_read_b128 v[60:63], v237 offset:2048
    v_mfma_f32_16x16x32_bf16 v[136:139], v[112:115], v[92:95], v[136:139]
    v_mfma_f32_16x16x32_bf16 v[140:143], v[116:119], v[92:95], v[140:143]
    s_barrier
    s_waitcnt lgkmcnt(0)
    v_mfma_f32_16x16x32_bf16 v[120:123], v[76:79], v[56:59], v[120:123]
    ds_read_b64_tr_b16 v[108:109], v239 offset:6144
    ds_read_b64_tr_b16 v[110:111], v239 offset:6912
    v_mfma_f32_16x16x32_bf16 v[124:127], v[80:83], v[56:59], v[124:127]
    ds_read_b64_tr_b16 v[112:113], v240 offset:6144
    ds_read_b64_tr_b16 v[114:115], v240 offset:6912
    v_mfma_f32_16x16x32_bf16 v[128:131], v[84:87], v[56:59], v[128:131]
    ds_read_b64_tr_b16 v[116:117], v241 offset:6144
    ds_read_b64_tr_b16 v[118:119], v241 offset:6912
    v_mfma_f32_16x16x32_bf16 v[132:135], v[76:79], v[60:63], v[132:135]
    ds_read_b128 v[88:91], v238 offset:0
    ds_read_b128 v[92:95], v238 offset:2048
    v_mfma_f32_16x16x32_bf16 v[136:139], v[80:83], v[60:63], v[136:139]
    v_mfma_f32_16x16x32_bf16 v[140:143], v[84:87], v[60:63], v[140:143]
    s_waitcnt lgkmcnt(0)
    v_mfma_f32_16x16x32_bf16 v[120:123], v[108:111], v[88:91], v[120:123]
    ds_read_b64_tr_b16 v[76:77], v16 offset:0
    ds_read_b64_tr_b16 v[78:79], v16 offset:768
    v_mfma_f32_16x16x32_bf16 v[124:127], v[112:115], v[88:91], v[124:127]
    ds_read_b64_tr_b16 v[80:81], v17 offset:0
    ds_read_b64_tr_b16 v[82:83], v17 offset:768
    v_mfma_f32_16x16x32_bf16 v[128:131], v[116:119], v[88:91], v[128:131]
    ds_read_b64_tr_b16 v[84:85], v18 offset:0
    ds_read_b64_tr_b16 v[86:87], v18 offset:768
    v_mfma_f32_16x16x32_bf16 v[132:135], v[108:111], v[92:95], v[132:135]
    ds_read_b128 v[56:59], v14 offset:0
    ds_read_b128 v[60:63], v14 offset:2048
    v_mfma_f32_16x16x32_bf16 v[136:139], v[112:115], v[92:95], v[136:139]
    v_mfma_f32_16x16x32_bf16 v[140:143], v[116:119], v[92:95], v[140:143]
    s_barrier
    s_waitcnt lgkmcnt(0)
    v_mfma_f32_16x16x32_bf16 v[120:123], v[76:79], v[56:59], v[120:123]
    ds_read_b64_tr_b16 v[108:109], v16 offset:6144
    ds_read_b64_tr_b16 v[110:111], v16 offset:6912
    v_mfma_f32_16x16x32_bf16 v[124:127], v[80:83], v[56:59], v[124:127]
    ds_read_b64_tr_b16 v[112:113], v17 offset:6144
    ds_read_b64_tr_b16 v[114:115], v17 offset:6912
    v_mfma_f32_16x16x32_bf16 v[128:131], v[84:87], v[56:59], v[128:131]
    ds_read_b64_tr_b16 v[116:117], v18 offset:6144
    ds_read_b64_tr_b16 v[118:119], v18 offset:6912
    v_mfma_f32_16x16x32_bf16 v[132:135], v[76:79], v[60:63], v[132:135]
    ds_read_b128 v[88:91], v15 offset:0
    ds_read_b128 v[92:95], v15 offset:2048
    v_mfma_f32_16x16x32_bf16 v[136:139], v[80:83], v[60:63], v[136:139]
    v_mfma_f32_16x16x32_bf16 v[140:143], v[84:87], v[60:63], v[140:143]
    s_waitcnt lgkmcnt(0)
    v_mfma_f32_16x16x32_bf16 v[120:123], v[108:111], v[88:91], v[120:123]
    ds_read_b64_tr_b16 v[76:77], v214 offset:0
    ds_read_b64_tr_b16 v[78:79], v214 offset:768
    v_mfma_f32_16x16x32_bf16 v[124:127], v[112:115], v[88:91], v[124:127]
    ds_read_b64_tr_b16 v[80:81], v215 offset:0
    ds_read_b64_tr_b16 v[82:83], v215 offset:768
    v_mfma_f32_16x16x32_bf16 v[128:131], v[116:119], v[88:91], v[128:131]
    ds_read_b64_tr_b16 v[84:85], v216 offset:0
    ds_read_b64_tr_b16 v[86:87], v216 offset:768
    v_mfma_f32_16x16x32_bf16 v[132:135], v[108:111], v[92:95], v[132:135]
    ds_read_b128 v[56:59], v212 offset:0
    ds_read_b128 v[60:63], v212 offset:2048
    v_mfma_f32_16x16x32_bf16 v[136:139], v[112:115], v[92:95], v[136:139]
    v_mfma_f32_16x16x32_bf16 v[140:143], v[116:119], v[92:95], v[140:143]
    s_barrier
    s_waitcnt lgkmcnt(0)
    v_mfma_f32_16x16x32_bf16 v[120:123], v[76:79], v[56:59], v[120:123]
    ds_read_b64_tr_b16 v[108:109], v214 offset:6144
    ds_read_b64_tr_b16 v[110:111], v214 offset:6912
    v_mfma_f32_16x16x32_bf16 v[124:127], v[80:83], v[56:59], v[124:127]
    ds_read_b64_tr_b16 v[112:113], v215 offset:6144
    ds_read_b64_tr_b16 v[114:115], v215 offset:6912
    v_mfma_f32_16x16x32_bf16 v[128:131], v[84:87], v[56:59], v[128:131]
    ds_read_b64_tr_b16 v[116:117], v216 offset:6144
    ds_read_b64_tr_b16 v[118:119], v216 offset:6912
    v_mfma_f32_16x16x32_bf16 v[132:135], v[76:79], v[60:63], v[132:135]
    ds_read_b128 v[88:91], v213 offset:0
    ds_read_b128 v[92:95], v213 offset:2048
    v_mfma_f32_16x16x32_bf16 v[136:139], v[80:83], v[60:63], v[136:139]
    v_mfma_f32_16x16x32_bf16 v[140:143], v[84:87], v[60:63], v[140:143]
    s_waitcnt lgkmcnt(0)
    v_mfma_f32_16x16x32_bf16 v[120:123], v[108:111], v[88:91], v[120:123]
    ds_read_b64_tr_b16 v[76:77], v219 offset:0
    ds_read_b64_tr_b16 v[78:79], v219 offset:768
    v_mfma_f32_16x16x32_bf16 v[124:127], v[112:115], v[88:91], v[124:127]
    ds_read_b64_tr_b16 v[80:81], v220 offset:0
    ds_read_b64_tr_b16 v[82:83], v220 offset:768
    v_mfma_f32_16x16x32_bf16 v[128:131], v[116:119], v[88:91], v[128:131]
    ds_read_b64_tr_b16 v[84:85], v221 offset:0
    ds_read_b64_tr_b16 v[86:87], v221 offset:768
    v_mfma_f32_16x16x32_bf16 v[132:135], v[108:111], v[92:95], v[132:135]
    ds_read_b128 v[56:59], v217 offset:0
    ds_read_b128 v[60:63], v217 offset:2048
    v_mfma_f32_16x16x32_bf16 v[136:139], v[112:115], v[92:95], v[136:139]
    v_mfma_f32_16x16x32_bf16 v[140:143], v[116:119], v[92:95], v[140:143]
    s_barrier
    s_waitcnt lgkmcnt(0)
    v_mfma_f32_16x16x32_bf16 v[120:123], v[76:79], v[56:59], v[120:123]
    ds_read_b64_tr_b16 v[108:109], v219 offset:6144
    ds_read_b64_tr_b16 v[110:111], v219 offset:6912
    v_mfma_f32_16x16x32_bf16 v[124:127], v[80:83], v[56:59], v[124:127]
    ds_read_b64_tr_b16 v[112:113], v220 offset:6144
    ds_read_b64_tr_b16 v[114:115], v220 offset:6912
    v_mfma_f32_16x16x32_bf16 v[128:131], v[84:87], v[56:59], v[128:131]
    ds_read_b64_tr_b16 v[116:117], v221 offset:6144
    ds_read_b64_tr_b16 v[118:119], v221 offset:6912
    v_mfma_f32_16x16x32_bf16 v[132:135], v[76:79], v[60:63], v[132:135]
    ds_read_b128 v[88:91], v218 offset:0
    ds_read_b128 v[92:95], v218 offset:2048
    v_mfma_f32_16x16x32_bf16 v[136:139], v[80:83], v[60:63], v[136:139]
    v_mfma_f32_16x16x32_bf16 v[140:143], v[84:87], v[60:63], v[140:143]
    s_waitcnt lgkmcnt(0)
    v_mfma_f32_16x16x32_bf16 v[120:123], v[108:111], v[88:91], v[120:123]
    ds_read_b64_tr_b16 v[76:77], v224 offset:0
    ds_read_b64_tr_b16 v[78:79], v224 offset:768
    v_mfma_f32_16x16x32_bf16 v[124:127], v[112:115], v[88:91], v[124:127]
    ds_read_b64_tr_b16 v[80:81], v225 offset:0
    ds_read_b64_tr_b16 v[82:83], v225 offset:768
    v_mfma_f32_16x16x32_bf16 v[128:131], v[116:119], v[88:91], v[128:131]
    ds_read_b64_tr_b16 v[84:85], v226 offset:0
    ds_read_b64_tr_b16 v[86:87], v226 offset:768
    v_mfma_f32_16x16x32_bf16 v[132:135], v[108:111], v[92:95], v[132:135]
    ds_read_b128 v[56:59], v222 offset:0
    ds_read_b128 v[60:63], v222 offset:2048
    v_mfma_f32_16x16x32_bf16 v[136:139], v[112:115], v[92:95], v[136:139]
    v_mfma_f32_16x16x32_bf16 v[140:143], v[116:119], v[92:95], v[140:143]
    s_barrier
    s_waitcnt lgkmcnt(0)
    v_mfma_f32_16x16x32_bf16 v[120:123], v[76:79], v[56:59], v[120:123]
    ds_read_b64_tr_b16 v[108:109], v224 offset:6144
    ds_read_b64_tr_b16 v[110:111], v224 offset:6912
    v_mfma_f32_16x16x32_bf16 v[124:127], v[80:83], v[56:59], v[124:127]
    ds_read_b64_tr_b16 v[112:113], v225 offset:6144
    ds_read_b64_tr_b16 v[114:115], v225 offset:6912
    v_mfma_f32_16x16x32_bf16 v[128:131], v[84:87], v[56:59], v[128:131]
    ds_read_b64_tr_b16 v[116:117], v226 offset:6144
    ds_read_b64_tr_b16 v[118:119], v226 offset:6912
    v_mfma_f32_16x16x32_bf16 v[132:135], v[76:79], v[60:63], v[132:135]
    ds_read_b128 v[88:91], v223 offset:0
    ds_read_b128 v[92:95], v223 offset:2048
    v_mfma_f32_16x16x32_bf16 v[136:139], v[80:83], v[60:63], v[136:139]
    v_mfma_f32_16x16x32_bf16 v[140:143], v[84:87], v[60:63], v[140:143]
    s_waitcnt lgkmcnt(0)
    v_mfma_f32_16x16x32_bf16 v[120:123], v[108:111], v[88:91], v[120:123]
    ds_read_b64_tr_b16 v[76:77], v229 offset:0
    ds_read_b64_tr_b16 v[78:79], v229 offset:768
    v_mfma_f32_16x16x32_bf16 v[124:127], v[112:115], v[88:91], v[124:127]
    ds_read_b64_tr_b16 v[80:81], v230 offset:0
    ds_read_b64_tr_b16 v[82:83], v230 offset:768
    v_mfma_f32_16x16x32_bf16 v[128:131], v[116:119], v[88:91], v[128:131]
    ds_read_b64_tr_b16 v[84:85], v231 offset:0
    ds_read_b64_tr_b16 v[86:87], v231 offset:768
    v_mfma_f32_16x16x32_bf16 v[132:135], v[108:111], v[92:95], v[132:135]
    ds_read_b128 v[56:59], v227 offset:0
    ds_read_b128 v[60:63], v227 offset:2048
    v_mfma_f32_16x16x32_bf16 v[136:139], v[112:115], v[92:95], v[136:139]
    v_mfma_f32_16x16x32_bf16 v[140:143], v[116:119], v[92:95], v[140:143]
    s_barrier
    s_waitcnt lgkmcnt(0)
    v_mfma_f32_16x16x32_bf16 v[120:123], v[76:79], v[56:59], v[120:123]
    ds_read_b64_tr_b16 v[108:109], v229 offset:6144
    ds_read_b64_tr_b16 v[110:111], v229 offset:6912
    v_mfma_f32_16x16x32_bf16 v[124:127], v[80:83], v[56:59], v[124:127]
    ds_read_b64_tr_b16 v[112:113], v230 offset:6144
    ds_read_b64_tr_b16 v[114:115], v230 offset:6912
    v_mfma_f32_16x16x32_bf16 v[128:131], v[84:87], v[56:59], v[128:131]
    ds_read_b64_tr_b16 v[116:117], v231 offset:6144
    ds_read_b64_tr_b16 v[118:119], v231 offset:6912
    v_mfma_f32_16x16x32_bf16 v[132:135], v[76:79], v[60:63], v[132:135]
    ds_read_b128 v[88:91], v228 offset:0
    ds_read_b128 v[92:95], v228 offset:2048
    v_mfma_f32_16x16x32_bf16 v[136:139], v[80:83], v[60:63], v[136:139]
    v_mfma_f32_16x16x32_bf16 v[140:143], v[84:87], v[60:63], v[140:143]
    s_waitcnt lgkmcnt(0)
    v_mfma_f32_16x16x32_bf16 v[120:123], v[108:111], v[88:91], v[120:123]
    ds_read_b64_tr_b16 v[76:77], v234 offset:0
    ds_read_b64_tr_b16 v[78:79], v234 offset:768
    v_mfma_f32_16x16x32_bf16 v[124:127], v[112:115], v[88:91], v[124:127]
    ds_read_b64_tr_b16 v[80:81], v235 offset:0
    ds_read_b64_tr_b16 v[82:83], v235 offset:768
    v_mfma_f32_16x16x32_bf16 v[128:131], v[116:119], v[88:91], v[128:131]
    ds_read_b64_tr_b16 v[84:85], v236 offset:0
    ds_read_b64_tr_b16 v[86:87], v236 offset:768
    v_mfma_f32_16x16x32_bf16 v[132:135], v[108:111], v[92:95], v[132:135]
    ds_read_b128 v[56:59], v232 offset:0
    ds_read_b128 v[60:63], v232 offset:2048
    v_mfma_f32_16x16x32_bf16 v[136:139], v[112:115], v[92:95], v[136:139]
    v_mfma_f32_16x16x32_bf16 v[140:143], v[116:119], v[92:95], v[140:143]
    s_barrier
    s_waitcnt lgkmcnt(0)
    v_mfma_f32_16x16x32_bf16 v[120:123], v[76:79], v[56:59], v[120:123]
    ds_read_b64_tr_b16 v[108:109], v234 offset:6144
    ds_read_b64_tr_b16 v[110:111], v234 offset:6912
    v_mfma_f32_16x16x32_bf16 v[124:127], v[80:83], v[56:59], v[124:127]
    ds_read_b64_tr_b16 v[112:113], v235 offset:6144
    ds_read_b64_tr_b16 v[114:115], v235 offset:6912
    v_mfma_f32_16x16x32_bf16 v[128:131], v[84:87], v[56:59], v[128:131]
    ds_read_b64_tr_b16 v[116:117], v236 offset:6144
    ds_read_b64_tr_b16 v[118:119], v236 offset:6912
    v_mfma_f32_16x16x32_bf16 v[132:135], v[76:79], v[60:63], v[132:135]
    ds_read_b128 v[88:91], v233 offset:0
    ds_read_b128 v[92:95], v233 offset:2048
    v_mfma_f32_16x16x32_bf16 v[136:139], v[80:83], v[60:63], v[136:139]
    v_mfma_f32_16x16x32_bf16 v[140:143], v[84:87], v[60:63], v[140:143]
    s_waitcnt lgkmcnt(0)
    v_mfma_f32_16x16x32_bf16 v[120:123], v[108:111], v[88:91], v[120:123]
    ds_read_b64_tr_b16 v[76:77], v239 offset:0
    ds_read_b64_tr_b16 v[78:79], v239 offset:768
    v_mfma_f32_16x16x32_bf16 v[124:127], v[112:115], v[88:91], v[124:127]
    ds_read_b64_tr_b16 v[80:81], v240 offset:0
    ds_read_b64_tr_b16 v[82:83], v240 offset:768
    v_mfma_f32_16x16x32_bf16 v[128:131], v[116:119], v[88:91], v[128:131]
    ds_read_b64_tr_b16 v[84:85], v241 offset:0
    ds_read_b64_tr_b16 v[86:87], v241 offset:768
    v_mfma_f32_16x16x32_bf16 v[132:135], v[108:111], v[92:95], v[132:135]
    ds_read_b128 v[56:59], v237 offset:0
    ds_read_b128 v[60:63], v237 offset:2048
    v_mfma_f32_16x16x32_bf16 v[136:139], v[112:115], v[92:95], v[136:139]
    v_mfma_f32_16x16x32_bf16 v[140:143], v[116:119], v[92:95], v[140:143]
    s_barrier
    s_waitcnt lgkmcnt(0)
    v_mfma_f32_16x16x32_bf16 v[120:123], v[76:79], v[56:59], v[120:123]
    ds_read_b64_tr_b16 v[108:109], v239 offset:6144
    ds_read_b64_tr_b16 v[110:111], v239 offset:6912
    v_mfma_f32_16x16x32_bf16 v[124:127], v[80:83], v[56:59], v[124:127]
    ds_read_b64_tr_b16 v[112:113], v240 offset:6144
    ds_read_b64_tr_b16 v[114:115], v240 offset:6912
    v_mfma_f32_16x16x32_bf16 v[128:131], v[84:87], v[56:59], v[128:131]
    ds_read_b64_tr_b16 v[116:117], v241 offset:6144
    ds_read_b64_tr_b16 v[118:119], v241 offset:6912
    v_mfma_f32_16x16x32_bf16 v[132:135], v[76:79], v[60:63], v[132:135]
    ds_read_b128 v[88:91], v238 offset:0
    ds_read_b128 v[92:95], v238 offset:2048
    v_mfma_f32_16x16x32_bf16 v[136:139], v[80:83], v[60:63], v[136:139]
    v_mfma_f32_16x16x32_bf16 v[140:143], v[84:87], v[60:63], v[140:143]
    s_waitcnt lgkmcnt(0)
    v_mfma_f32_16x16x32_bf16 v[120:123], v[108:111], v[88:91], v[120:123]
    ds_read_b64_tr_b16 v[76:77], v16 offset:0
    ds_read_b64_tr_b16 v[78:79], v16 offset:768
    v_mfma_f32_16x16x32_bf16 v[124:127], v[112:115], v[88:91], v[124:127]
    ds_read_b64_tr_b16 v[80:81], v17 offset:0
    ds_read_b64_tr_b16 v[82:83], v17 offset:768
    v_mfma_f32_16x16x32_bf16 v[128:131], v[116:119], v[88:91], v[128:131]
    ds_read_b64_tr_b16 v[84:85], v18 offset:0
    ds_read_b64_tr_b16 v[86:87], v18 offset:768
    v_mfma_f32_16x16x32_bf16 v[132:135], v[108:111], v[92:95], v[132:135]
    ds_read_b128 v[56:59], v14 offset:0
    ds_read_b128 v[60:63], v14 offset:2048
    v_mfma_f32_16x16x32_bf16 v[136:139], v[112:115], v[92:95], v[136:139]
    v_mfma_f32_16x16x32_bf16 v[140:143], v[116:119], v[92:95], v[140:143]
    s_barrier
    s_waitcnt lgkmcnt(0)
    v_mfma_f32_16x16x32_bf16 v[120:123], v[76:79], v[56:59], v[120:123]
    ds_read_b64_tr_b16 v[108:109], v16 offset:6144
    ds_read_b64_tr_b16 v[110:111], v16 offset:6912
    v_mfma_f32_16x16x32_bf16 v[124:127], v[80:83], v[56:59], v[124:127]
    ds_read_b64_tr_b16 v[112:113], v17 offset:6144
    ds_read_b64_tr_b16 v[114:115], v17 offset:6912
    v_mfma_f32_16x16x32_bf16 v[128:131], v[84:87], v[56:59], v[128:131]
    ds_read_b64_tr_b16 v[116:117], v18 offset:6144
    ds_read_b64_tr_b16 v[118:119], v18 offset:6912
    v_mfma_f32_16x16x32_bf16 v[132:135], v[76:79], v[60:63], v[132:135]
    ds_read_b128 v[88:91], v15 offset:0
    ds_read_b128 v[92:95], v15 offset:2048
    v_mfma_f32_16x16x32_bf16 v[136:139], v[80:83], v[60:63], v[136:139]
    v_mfma_f32_16x16x32_bf16 v[140:143], v[84:87], v[60:63], v[140:143]
    s_waitcnt lgkmcnt(0)
    v_mfma_f32_16x16x32_bf16 v[120:123], v[108:111], v[88:91], v[120:123]
    ds_read_b64_tr_b16 v[76:77], v214 offset:0
    ds_read_b64_tr_b16 v[78:79], v214 offset:768
    v_mfma_f32_16x16x32_bf16 v[124:127], v[112:115], v[88:91], v[124:127]
    ds_read_b64_tr_b16 v[80:81], v215 offset:0
    ds_read_b64_tr_b16 v[82:83], v215 offset:768
    v_mfma_f32_16x16x32_bf16 v[128:131], v[116:119], v[88:91], v[128:131]
    ds_read_b64_tr_b16 v[84:85], v216 offset:0
    ds_read_b64_tr_b16 v[86:87], v216 offset:768
    v_mfma_f32_16x16x32_bf16 v[132:135], v[108:111], v[92:95], v[132:135]
    ds_read_b128 v[56:59], v212 offset:0
    ds_read_b128 v[60:63], v212 offset:2048
    v_mfma_f32_16x16x32_bf16 v[136:139], v[112:115], v[92:95], v[136:139]
    v_mfma_f32_16x16x32_bf16 v[140:143], v[116:119], v[92:95], v[140:143]
    s_barrier
    s_waitcnt lgkmcnt(0)
    v_mfma_f32_16x16x32_bf16 v[120:123], v[76:79], v[56:59], v[120:123]
    ds_read_b64_tr_b16 v[108:109], v214 offset:6144
    ds_read_b64_tr_b16 v[110:111], v214 offset:6912
    v_mfma_f32_16x16x32_bf16 v[124:127], v[80:83], v[56:59], v[124:127]
    ds_read_b64_tr_b16 v[112:113], v215 offset:6144
    ds_read_b64_tr_b16 v[114:115], v215 offset:6912
    v_mfma_f32_16x16x32_bf16 v[128:131], v[84:87], v[56:59], v[128:131]
    ds_read_b64_tr_b16 v[116:117], v216 offset:6144
    ds_read_b64_tr_b16 v[118:119], v216 offset:6912
    v_mfma_f32_16x16x32_bf16 v[132:135], v[76:79], v[60:63], v[132:135]
    ds_read_b128 v[88:91], v213 offset:0
    ds_read_b128 v[92:95], v213 offset:2048
    v_mfma_f32_16x16x32_bf16 v[136:139], v[80:83], v[60:63], v[136:139]
    v_mfma_f32_16x16x32_bf16 v[140:143], v[84:87], v[60:63], v[140:143]
    s_waitcnt lgkmcnt(0)
    v_mfma_f32_16x16x32_bf16 v[120:123], v[108:111], v[88:91], v[120:123]
    ds_read_b64_tr_b16 v[76:77], v219 offset:0
    ds_read_b64_tr_b16 v[78:79], v219 offset:768
    v_mfma_f32_16x16x32_bf16 v[124:127], v[112:115], v[88:91], v[124:127]
    ds_read_b64_tr_b16 v[80:81], v220 offset:0
    ds_read_b64_tr_b16 v[82:83], v220 offset:768
    v_mfma_f32_16x16x32_bf16 v[128:131], v[116:119], v[88:91], v[128:131]
    ds_read_b64_tr_b16 v[84:85], v221 offset:0
    ds_read_b64_tr_b16 v[86:87], v221 offset:768
    v_mfma_f32_16x16x32_bf16 v[132:135], v[108:111], v[92:95], v[132:135]
    ds_read_b128 v[56:59], v217 offset:0
    ds_read_b128 v[60:63], v217 offset:2048
    v_mfma_f32_16x16x32_bf16 v[136:139], v[112:115], v[92:95], v[136:139]
    v_mfma_f32_16x16x32_bf16 v[140:143], v[116:119], v[92:95], v[140:143]
    s_barrier
    s_waitcnt lgkmcnt(0)
    v_mfma_f32_16x16x32_bf16 v[120:123], v[76:79], v[56:59], v[120:123]
    ds_read_b64_tr_b16 v[108:109], v219 offset:6144
    ds_read_b64_tr_b16 v[110:111], v219 offset:6912
    v_mfma_f32_16x16x32_bf16 v[124:127], v[80:83], v[56:59], v[124:127]
    ds_read_b64_tr_b16 v[112:113], v220 offset:6144
    ds_read_b64_tr_b16 v[114:115], v220 offset:6912
    v_mfma_f32_16x16x32_bf16 v[128:131], v[84:87], v[56:59], v[128:131]
    ds_read_b64_tr_b16 v[116:117], v221 offset:6144
    ds_read_b64_tr_b16 v[118:119], v221 offset:6912
    v_mfma_f32_16x16x32_bf16 v[132:135], v[76:79], v[60:63], v[132:135]
    ds_read_b128 v[88:91], v218 offset:0
    ds_read_b128 v[92:95], v218 offset:2048
    v_mfma_f32_16x16x32_bf16 v[136:139], v[80:83], v[60:63], v[136:139]
    v_mfma_f32_16x16x32_bf16 v[140:143], v[84:87], v[60:63], v[140:143]
    s_waitcnt lgkmcnt(0)
    v_mfma_f32_16x16x32_bf16 v[120:123], v[108:111], v[88:91], v[120:123]
    ds_read_b64_tr_b16 v[76:77], v224 offset:0
    ds_read_b64_tr_b16 v[78:79], v224 offset:768
    v_mfma_f32_16x16x32_bf16 v[124:127], v[112:115], v[88:91], v[124:127]
    ds_read_b64_tr_b16 v[80:81], v225 offset:0
    ds_read_b64_tr_b16 v[82:83], v225 offset:768
    v_mfma_f32_16x16x32_bf16 v[128:131], v[116:119], v[88:91], v[128:131]
    ds_read_b64_tr_b16 v[84:85], v226 offset:0
    ds_read_b64_tr_b16 v[86:87], v226 offset:768
    v_mfma_f32_16x16x32_bf16 v[132:135], v[108:111], v[92:95], v[132:135]
    ds_read_b128 v[56:59], v222 offset:0
    ds_read_b128 v[60:63], v222 offset:2048
    v_mfma_f32_16x16x32_bf16 v[136:139], v[112:115], v[92:95], v[136:139]
    v_mfma_f32_16x16x32_bf16 v[140:143], v[116:119], v[92:95], v[140:143]
    s_barrier
    s_waitcnt lgkmcnt(0)
    v_mfma_f32_16x16x32_bf16 v[120:123], v[76:79], v[56:59], v[120:123]
    ds_read_b64_tr_b16 v[108:109], v224 offset:6144
    ds_read_b64_tr_b16 v[110:111], v224 offset:6912
    v_mfma_f32_16x16x32_bf16 v[124:127], v[80:83], v[56:59], v[124:127]
    ds_read_b64_tr_b16 v[112:113], v225 offset:6144
    ds_read_b64_tr_b16 v[114:115], v225 offset:6912
    v_mfma_f32_16x16x32_bf16 v[128:131], v[84:87], v[56:59], v[128:131]
    ds_read_b64_tr_b16 v[116:117], v226 offset:6144
    ds_read_b64_tr_b16 v[118:119], v226 offset:6912
    v_mfma_f32_16x16x32_bf16 v[132:135], v[76:79], v[60:63], v[132:135]
    ds_read_b128 v[88:91], v223 offset:0
    ds_read_b128 v[92:95], v223 offset:2048
    v_mfma_f32_16x16x32_bf16 v[136:139], v[80:83], v[60:63], v[136:139]
    v_mfma_f32_16x16x32_bf16 v[140:143], v[84:87], v[60:63], v[140:143]
    s_waitcnt lgkmcnt(0)
    v_mfma_f32_16x16x32_bf16 v[120:123], v[108:111], v[88:91], v[120:123]
    ds_read_b64_tr_b16 v[76:77], v229 offset:0
    ds_read_b64_tr_b16 v[78:79], v229 offset:768
    v_mfma_f32_16x16x32_bf16 v[124:127], v[112:115], v[88:91], v[124:127]
    ds_read_b64_tr_b16 v[80:81], v230 offset:0
    ds_read_b64_tr_b16 v[82:83], v230 offset:768
    v_mfma_f32_16x16x32_bf16 v[128:131], v[116:119], v[88:91], v[128:131]
    ds_read_b64_tr_b16 v[84:85], v231 offset:0
    ds_read_b64_tr_b16 v[86:87], v231 offset:768
    v_mfma_f32_16x16x32_bf16 v[132:135], v[108:111], v[92:95], v[132:135]
    ds_read_b128 v[56:59], v227 offset:0
    ds_read_b128 v[60:63], v227 offset:2048
    v_mfma_f32_16x16x32_bf16 v[136:139], v[112:115], v[92:95], v[136:139]
    v_mfma_f32_16x16x32_bf16 v[140:143], v[116:119], v[92:95], v[140:143]
    s_barrier
    s_waitcnt lgkmcnt(0)
    v_mfma_f32_16x16x32_bf16 v[120:123], v[76:79], v[56:59], v[120:123]
    ds_read_b64_tr_b16 v[108:109], v229 offset:6144
    ds_read_b64_tr_b16 v[110:111], v229 offset:6912
    v_mfma_f32_16x16x32_bf16 v[124:127], v[80:83], v[56:59], v[124:127]
    ds_read_b64_tr_b16 v[112:113], v230 offset:6144
    ds_read_b64_tr_b16 v[114:115], v230 offset:6912
    v_mfma_f32_16x16x32_bf16 v[128:131], v[84:87], v[56:59], v[128:131]
    ds_read_b64_tr_b16 v[116:117], v231 offset:6144
    ds_read_b64_tr_b16 v[118:119], v231 offset:6912
    v_mfma_f32_16x16x32_bf16 v[132:135], v[76:79], v[60:63], v[132:135]
    ds_read_b128 v[88:91], v228 offset:0
    ds_read_b128 v[92:95], v228 offset:2048
    v_mfma_f32_16x16x32_bf16 v[136:139], v[80:83], v[60:63], v[136:139]
    v_mfma_f32_16x16x32_bf16 v[140:143], v[84:87], v[60:63], v[140:143]
    s_waitcnt lgkmcnt(0)
    v_mfma_f32_16x16x32_bf16 v[120:123], v[108:111], v[88:91], v[120:123]
    ds_read_b64_tr_b16 v[76:77], v234 offset:0
    ds_read_b64_tr_b16 v[78:79], v234 offset:768
    v_mfma_f32_16x16x32_bf16 v[124:127], v[112:115], v[88:91], v[124:127]
    ds_read_b64_tr_b16 v[80:81], v235 offset:0
    ds_read_b64_tr_b16 v[82:83], v235 offset:768
    v_mfma_f32_16x16x32_bf16 v[128:131], v[116:119], v[88:91], v[128:131]
    ds_read_b64_tr_b16 v[84:85], v236 offset:0
    ds_read_b64_tr_b16 v[86:87], v236 offset:768
    v_mfma_f32_16x16x32_bf16 v[132:135], v[108:111], v[92:95], v[132:135]
    ds_read_b128 v[56:59], v232 offset:0
    ds_read_b128 v[60:63], v232 offset:2048
    v_mfma_f32_16x16x32_bf16 v[136:139], v[112:115], v[92:95], v[136:139]
    v_mfma_f32_16x16x32_bf16 v[140:143], v[116:119], v[92:95], v[140:143]
    s_barrier
    s_waitcnt lgkmcnt(0)
    v_mfma_f32_16x16x32_bf16 v[120:123], v[76:79], v[56:59], v[120:123]
    ds_read_b64_tr_b16 v[108:109], v234 offset:6144
    ds_read_b64_tr_b16 v[110:111], v234 offset:6912
    v_mfma_f32_16x16x32_bf16 v[124:127], v[80:83], v[56:59], v[124:127]
    ds_read_b64_tr_b16 v[112:113], v235 offset:6144
    ds_read_b64_tr_b16 v[114:115], v235 offset:6912
    v_mfma_f32_16x16x32_bf16 v[128:131], v[84:87], v[56:59], v[128:131]
    ds_read_b64_tr_b16 v[116:117], v236 offset:6144
    ds_read_b64_tr_b16 v[118:119], v236 offset:6912
    v_mfma_f32_16x16x32_bf16 v[132:135], v[76:79], v[60:63], v[132:135]
    ds_read_b128 v[88:91], v233 offset:0
    ds_read_b128 v[92:95], v233 offset:2048
    v_mfma_f32_16x16x32_bf16 v[136:139], v[80:83], v[60:63], v[136:139]
    v_mfma_f32_16x16x32_bf16 v[140:143], v[84:87], v[60:63], v[140:143]
    s_waitcnt lgkmcnt(0)
    v_mfma_f32_16x16x32_bf16 v[120:123], v[108:111], v[88:91], v[120:123]
    ds_read_b64_tr_b16 v[76:77], v239 offset:0
    ds_read_b64_tr_b16 v[78:79], v239 offset:768
    v_mfma_f32_16x16x32_bf16 v[124:127], v[112:115], v[88:91], v[124:127]
    ds_read_b64_tr_b16 v[80:81], v240 offset:0
    ds_read_b64_tr_b16 v[82:83], v240 offset:768
    v_mfma_f32_16x16x32_bf16 v[128:131], v[116:119], v[88:91], v[128:131]
    ds_read_b64_tr_b16 v[84:85], v241 offset:0
    ds_read_b64_tr_b16 v[86:87], v241 offset:768
    v_mfma_f32_16x16x32_bf16 v[132:135], v[108:111], v[92:95], v[132:135]
    ds_read_b128 v[56:59], v237 offset:0
    ds_read_b128 v[60:63], v237 offset:2048
    v_mfma_f32_16x16x32_bf16 v[136:139], v[112:115], v[92:95], v[136:139]
    v_mfma_f32_16x16x32_bf16 v[140:143], v[116:119], v[92:95], v[140:143]
    s_barrier
    s_waitcnt lgkmcnt(0)
    v_mfma_f32_16x16x32_bf16 v[120:123], v[76:79], v[56:59], v[120:123]
    ds_read_b64_tr_b16 v[108:109], v239 offset:6144
    ds_read_b64_tr_b16 v[110:111], v239 offset:6912
    v_mfma_f32_16x16x32_bf16 v[124:127], v[80:83], v[56:59], v[124:127]
    ds_read_b64_tr_b16 v[112:113], v240 offset:6144
    ds_read_b64_tr_b16 v[114:115], v240 offset:6912
    v_mfma_f32_16x16x32_bf16 v[128:131], v[84:87], v[56:59], v[128:131]
    ds_read_b64_tr_b16 v[116:117], v241 offset:6144
    ds_read_b64_tr_b16 v[118:119], v241 offset:6912
    v_mfma_f32_16x16x32_bf16 v[132:135], v[76:79], v[60:63], v[132:135]
    ds_read_b128 v[88:91], v238 offset:0
    ds_read_b128 v[92:95], v238 offset:2048
    v_mfma_f32_16x16x32_bf16 v[136:139], v[80:83], v[60:63], v[136:139]
    v_mfma_f32_16x16x32_bf16 v[140:143], v[84:87], v[60:63], v[140:143]
    s_waitcnt lgkmcnt(0)
    v_mfma_f32_16x16x32_bf16 v[120:123], v[108:111], v[88:91], v[120:123]
    ds_read_b64_tr_b16 v[76:77], v16 offset:0
    ds_read_b64_tr_b16 v[78:79], v16 offset:768
    v_mfma_f32_16x16x32_bf16 v[124:127], v[112:115], v[88:91], v[124:127]
    ds_read_b64_tr_b16 v[80:81], v17 offset:0
    ds_read_b64_tr_b16 v[82:83], v17 offset:768
    v_mfma_f32_16x16x32_bf16 v[128:131], v[116:119], v[88:91], v[128:131]
    ds_read_b64_tr_b16 v[84:85], v18 offset:0
    ds_read_b64_tr_b16 v[86:87], v18 offset:768
    v_mfma_f32_16x16x32_bf16 v[132:135], v[108:111], v[92:95], v[132:135]
    ds_read_b128 v[56:59], v14 offset:0
    ds_read_b128 v[60:63], v14 offset:2048
    v_mfma_f32_16x16x32_bf16 v[136:139], v[112:115], v[92:95], v[136:139]
    v_mfma_f32_16x16x32_bf16 v[140:143], v[116:119], v[92:95], v[140:143]
    s_barrier
    s_waitcnt lgkmcnt(0)
    v_mfma_f32_16x16x32_bf16 v[120:123], v[76:79], v[56:59], v[120:123]
    ds_read_b64_tr_b16 v[108:109], v16 offset:6144
    ds_read_b64_tr_b16 v[110:111], v16 offset:6912
    v_mfma_f32_16x16x32_bf16 v[124:127], v[80:83], v[56:59], v[124:127]
    ds_read_b64_tr_b16 v[112:113], v17 offset:6144
    ds_read_b64_tr_b16 v[114:115], v17 offset:6912
    v_mfma_f32_16x16x32_bf16 v[128:131], v[84:87], v[56:59], v[128:131]
    ds_read_b64_tr_b16 v[116:117], v18 offset:6144
    ds_read_b64_tr_b16 v[118:119], v18 offset:6912
    v_mfma_f32_16x16x32_bf16 v[132:135], v[76:79], v[60:63], v[132:135]
    ds_read_b128 v[88:91], v15 offset:0
    ds_read_b128 v[92:95], v15 offset:2048
    v_mfma_f32_16x16x32_bf16 v[136:139], v[80:83], v[60:63], v[136:139]
    v_mfma_f32_16x16x32_bf16 v[140:143], v[84:87], v[60:63], v[140:143]
    s_waitcnt lgkmcnt(0)
    v_mfma_f32_16x16x32_bf16 v[120:123], v[108:111], v[88:91], v[120:123]
    ds_read_b64_tr_b16 v[76:77], v214 offset:0
    ds_read_b64_tr_b16 v[78:79], v214 offset:768
    v_mfma_f32_16x16x32_bf16 v[124:127], v[112:115], v[88:91], v[124:127]
    ds_read_b64_tr_b16 v[80:81], v215 offset:0
    ds_read_b64_tr_b16 v[82:83], v215 offset:768
    v_mfma_f32_16x16x32_bf16 v[128:131], v[116:119], v[88:91], v[128:131]
    ds_read_b64_tr_b16 v[84:85], v216 offset:0
    ds_read_b64_tr_b16 v[86:87], v216 offset:768
    v_mfma_f32_16x16x32_bf16 v[132:135], v[108:111], v[92:95], v[132:135]
    ds_read_b128 v[56:59], v212 offset:0
    ds_read_b128 v[60:63], v212 offset:2048
    v_mfma_f32_16x16x32_bf16 v[136:139], v[112:115], v[92:95], v[136:139]
    v_mfma_f32_16x16x32_bf16 v[140:143], v[116:119], v[92:95], v[140:143]
    s_barrier
    s_waitcnt lgkmcnt(0)
    v_mfma_f32_16x16x32_bf16 v[120:123], v[76:79], v[56:59], v[120:123]
    ds_read_b64_tr_b16 v[108:109], v214 offset:6144
    ds_read_b64_tr_b16 v[110:111], v214 offset:6912
    v_mfma_f32_16x16x32_bf16 v[124:127], v[80:83], v[56:59], v[124:127]
    ds_read_b64_tr_b16 v[112:113], v215 offset:6144
    ds_read_b64_tr_b16 v[114:115], v215 offset:6912
    v_mfma_f32_16x16x32_bf16 v[128:131], v[84:87], v[56:59], v[128:131]
    ds_read_b64_tr_b16 v[116:117], v216 offset:6144
    ds_read_b64_tr_b16 v[118:119], v216 offset:6912
    v_mfma_f32_16x16x32_bf16 v[132:135], v[76:79], v[60:63], v[132:135]
    ds_read_b128 v[88:91], v213 offset:0
    ds_read_b128 v[92:95], v213 offset:2048
    v_mfma_f32_16x16x32_bf16 v[136:139], v[80:83], v[60:63], v[136:139]
    v_mfma_f32_16x16x32_bf16 v[140:143], v[84:87], v[60:63], v[140:143]
    s_waitcnt lgkmcnt(0)
    v_mfma_f32_16x16x32_bf16 v[120:123], v[108:111], v[88:91], v[120:123]
    ds_read_b64_tr_b16 v[76:77], v219 offset:0
    ds_read_b64_tr_b16 v[78:79], v219 offset:768
    v_mfma_f32_16x16x32_bf16 v[124:127], v[112:115], v[88:91], v[124:127]
    ds_read_b64_tr_b16 v[80:81], v220 offset:0
    ds_read_b64_tr_b16 v[82:83], v220 offset:768
    v_mfma_f32_16x16x32_bf16 v[128:131], v[116:119], v[88:91], v[128:131]
    ds_read_b64_tr_b16 v[84:85], v221 offset:0
    ds_read_b64_tr_b16 v[86:87], v221 offset:768
    v_mfma_f32_16x16x32_bf16 v[132:135], v[108:111], v[92:95], v[132:135]
    ds_read_b128 v[56:59], v217 offset:0
    ds_read_b128 v[60:63], v217 offset:2048
    v_mfma_f32_16x16x32_bf16 v[136:139], v[112:115], v[92:95], v[136:139]
    v_mfma_f32_16x16x32_bf16 v[140:143], v[116:119], v[92:95], v[140:143]
    s_barrier
    s_waitcnt lgkmcnt(0)
    v_mfma_f32_16x16x32_bf16 v[120:123], v[76:79], v[56:59], v[120:123]
    ds_read_b64_tr_b16 v[108:109], v219 offset:6144
    ds_read_b64_tr_b16 v[110:111], v219 offset:6912
    v_mfma_f32_16x16x32_bf16 v[124:127], v[80:83], v[56:59], v[124:127]
    ds_read_b64_tr_b16 v[112:113], v220 offset:6144
    ds_read_b64_tr_b16 v[114:115], v220 offset:6912
    v_mfma_f32_16x16x32_bf16 v[128:131], v[84:87], v[56:59], v[128:131]
    ds_read_b64_tr_b16 v[116:117], v221 offset:6144
    ds_read_b64_tr_b16 v[118:119], v221 offset:6912
    v_mfma_f32_16x16x32_bf16 v[132:135], v[76:79], v[60:63], v[132:135]
    ds_read_b128 v[88:91], v218 offset:0
    ds_read_b128 v[92:95], v218 offset:2048
    v_mfma_f32_16x16x32_bf16 v[136:139], v[80:83], v[60:63], v[136:139]
    v_mfma_f32_16x16x32_bf16 v[140:143], v[84:87], v[60:63], v[140:143]
    s_waitcnt lgkmcnt(0)
    v_mfma_f32_16x16x32_bf16 v[120:123], v[108:111], v[88:91], v[120:123]
    ds_read_b64_tr_b16 v[76:77], v224 offset:0
    ds_read_b64_tr_b16 v[78:79], v224 offset:768
    v_mfma_f32_16x16x32_bf16 v[124:127], v[112:115], v[88:91], v[124:127]
    ds_read_b64_tr_b16 v[80:81], v225 offset:0
    ds_read_b64_tr_b16 v[82:83], v225 offset:768
    v_mfma_f32_16x16x32_bf16 v[128:131], v[116:119], v[88:91], v[128:131]
    ds_read_b64_tr_b16 v[84:85], v226 offset:0
    ds_read_b64_tr_b16 v[86:87], v226 offset:768
    v_mfma_f32_16x16x32_bf16 v[132:135], v[108:111], v[92:95], v[132:135]
    ds_read_b128 v[56:59], v222 offset:0
    ds_read_b128 v[60:63], v222 offset:2048
    v_mfma_f32_16x16x32_bf16 v[136:139], v[112:115], v[92:95], v[136:139]
    v_mfma_f32_16x16x32_bf16 v[140:143], v[116:119], v[92:95], v[140:143]
    s_barrier
    s_waitcnt lgkmcnt(0)
    v_mfma_f32_16x16x32_bf16 v[120:123], v[76:79], v[56:59], v[120:123]
    ds_read_b64_tr_b16 v[108:109], v224 offset:6144
    ds_read_b64_tr_b16 v[110:111], v224 offset:6912
    v_mfma_f32_16x16x32_bf16 v[124:127], v[80:83], v[56:59], v[124:127]
    ds_read_b64_tr_b16 v[112:113], v225 offset:6144
    ds_read_b64_tr_b16 v[114:115], v225 offset:6912
    v_mfma_f32_16x16x32_bf16 v[128:131], v[84:87], v[56:59], v[128:131]
    ds_read_b64_tr_b16 v[116:117], v226 offset:6144
    ds_read_b64_tr_b16 v[118:119], v226 offset:6912
    v_mfma_f32_16x16x32_bf16 v[132:135], v[76:79], v[60:63], v[132:135]
    ds_read_b128 v[88:91], v223 offset:0
    ds_read_b128 v[92:95], v223 offset:2048
    v_mfma_f32_16x16x32_bf16 v[136:139], v[80:83], v[60:63], v[136:139]
    v_mfma_f32_16x16x32_bf16 v[140:143], v[84:87], v[60:63], v[140:143]
    s_waitcnt lgkmcnt(0)
    v_mfma_f32_16x16x32_bf16 v[120:123], v[108:111], v[88:91], v[120:123]
    v_mfma_f32_16x16x32_bf16 v[124:127], v[112:115], v[88:91], v[124:127]
    v_mfma_f32_16x16x32_bf16 v[128:131], v[116:119], v[88:91], v[128:131]
    v_mfma_f32_16x16x32_bf16 v[132:135], v[108:111], v[92:95], v[132:135]
    v_mfma_f32_16x16x32_bf16 v[136:139], v[112:115], v[92:95], v[136:139]
    v_mfma_f32_16x16x32_bf16 v[140:143], v[116:119], v[92:95], v[140:143]
    s_waitcnt vmcnt(0)
    s_nop 9
    v_lshlrev_b32 v28, 16, v28
    v_lshlrev_b32 v29, 16, v29
    v_cvt_pk_bf16_f32 v56, v120, v121
    v_lshlrev_b32 v120, 16, v56
    v_and_b32 v121, 0xffff0000, v56
    v_add_f32 v120, v120, v28
    v_add_f32 v121, v121, v28
    v_cvt_pk_bf16_f32 v56, v120, v121
    v_lshlrev_b32 v120, 16, v56
    v_and_b32 v121, 0xffff0000, v56
    v_lshlrev_b32 v57, 16, v40
    v_and_b32 v58, 0xffff0000, v40
    v_mul_f32 v120, v120, v57
    v_mul_f32 v121, v121, v58
    v_cvt_pk_bf16_f32 v56, v122, v123
    v_lshlrev_b32 v122, 16, v56
    v_and_b32 v123, 0xffff0000, v56
    v_add_f32 v122, v122, v28
    v_add_f32 v123, v123, v28
    v_cvt_pk_bf16_f32 v56, v122, v123
    v_lshlrev_b32 v122, 16, v56
    v_and_b32 v123, 0xffff0000, v56
    v_lshlrev_b32 v57, 16, v41
    v_and_b32 v58, 0xffff0000, v41
    v_mul_f32 v122, v122, v57
    v_mul_f32 v123, v123, v58
    v_cvt_pk_bf16_f32 v120, v120, v121
    v_cvt_pk_bf16_f32 v121, v122, v123
    buffer_store_dwordx2 v[120:121], v24, s[52:55], 0 offen
    v_cvt_pk_bf16_f32 v56, v124, v125
    v_lshlrev_b32 v124, 16, v56
    v_and_b32 v125, 0xffff0000, v56
    v_add_f32 v124, v124, v28
    v_add_f32 v125, v125, v28
    v_cvt_pk_bf16_f32 v56, v124, v125
    v_lshlrev_b32 v124, 16, v56
    v_and_b32 v125, 0xffff0000, v56
    v_lshlrev_b32 v57, 16, v42
    v_and_b32 v58, 0xffff0000, v42
    v_mul_f32 v124, v124, v57
    v_mul_f32 v125, v125, v58
    v_cvt_pk_bf16_f32 v56, v126, v127
    v_lshlrev_b32 v126, 16, v56
    v_and_b32 v127, 0xffff0000, v56
    v_add_f32 v126, v126, v28
    v_add_f32 v127, v127, v28
    v_cvt_pk_bf16_f32 v56, v126, v127
    v_lshlrev_b32 v126, 16, v56
    v_and_b32 v127, 0xffff0000, v56
    v_lshlrev_b32 v57, 16, v43
    v_and_b32 v58, 0xffff0000, v43
    v_mul_f32 v126, v126, v57
    v_mul_f32 v127, v127, v58
    v_cvt_pk_bf16_f32 v124, v124, v125
    v_cvt_pk_bf16_f32 v125, v126, v127
    buffer_store_dwordx2 v[124:125], v25, s[52:55], 0 offen
    v_cvt_pk_bf16_f32 v56, v128, v129
    v_lshlrev_b32 v128, 16, v56
    v_and_b32 v129, 0xffff0000, v56
    v_add_f32 v128, v128, v28
    v_add_f32 v129, v129, v28
    v_cvt_pk_bf16_f32 v56, v128, v129
    v_lshlrev_b32 v128, 16, v56
    v_and_b32 v129, 0xffff0000, v56
    v_lshlrev_b32 v57, 16, v44
    v_and_b32 v58, 0xffff0000, v44
    v_mul_f32 v128, v128, v57
    v_mul_f32 v129, v129, v58
    v_cvt_pk_bf16_f32 v56, v130, v131
    v_lshlrev_b32 v130, 16, v56
    v_and_b32 v131, 0xffff0000, v56
    v_add_f32 v130, v130, v28
    v_add_f32 v131, v131, v28
    v_cvt_pk_bf16_f32 v56, v130, v131
    v_lshlrev_b32 v130, 16, v56
    v_and_b32 v131, 0xffff0000, v56
    v_lshlrev_b32 v57, 16, v45
    v_and_b32 v58, 0xffff0000, v45
    v_mul_f32 v130, v130, v57
    v_mul_f32 v131, v131, v58
    v_cvt_pk_bf16_f32 v128, v128, v129
    v_cvt_pk_bf16_f32 v129, v130, v131
    buffer_store_dwordx2 v[128:129], v26, s[52:55], 0 offen
    v_cvt_pk_bf16_f32 v56, v132, v133
    v_lshlrev_b32 v132, 16, v56
    v_and_b32 v133, 0xffff0000, v56
    v_add_f32 v132, v132, v29
    v_add_f32 v133, v133, v29
    v_cvt_pk_bf16_f32 v56, v132, v133
    v_lshlrev_b32 v132, 16, v56
    v_and_b32 v133, 0xffff0000, v56
    v_lshlrev_b32 v57, 16, v46
    v_and_b32 v58, 0xffff0000, v46
    v_mul_f32 v132, v132, v57
    v_mul_f32 v133, v133, v58
    v_cvt_pk_bf16_f32 v56, v134, v135
    v_lshlrev_b32 v134, 16, v56
    v_and_b32 v135, 0xffff0000, v56
    v_add_f32 v134, v134, v29
    v_add_f32 v135, v135, v29
    v_cvt_pk_bf16_f32 v56, v134, v135
    v_lshlrev_b32 v134, 16, v56
    v_and_b32 v135, 0xffff0000, v56
    v_lshlrev_b32 v57, 16, v47
    v_and_b32 v58, 0xffff0000, v47
    v_mul_f32 v134, v134, v57
    v_mul_f32 v135, v135, v58
    v_cvt_pk_bf16_f32 v132, v132, v133
    v_cvt_pk_bf16_f32 v133, v134, v135
    buffer_store_dwordx2 v[132:133], v24, s[52:55], s13 offen
    v_cvt_pk_bf16_f32 v56, v136, v137
    v_lshlrev_b32 v136, 16, v56
    v_and_b32 v137, 0xffff0000, v56
    v_add_f32 v136, v136, v29
    v_add_f32 v137, v137, v29
    v_cvt_pk_bf16_f32 v56, v136, v137
    v_lshlrev_b32 v136, 16, v56
    v_and_b32 v137, 0xffff0000, v56
    v_lshlrev_b32 v57, 16, v48
    v_and_b32 v58, 0xffff0000, v48
    v_mul_f32 v136, v136, v57
    v_mul_f32 v137, v137, v58
    v_cvt_pk_bf16_f32 v56, v138, v139
    v_lshlrev_b32 v138, 16, v56
    v_and_b32 v139, 0xffff0000, v56
    v_add_f32 v138, v138, v29
    v_add_f32 v139, v139, v29
    v_cvt_pk_bf16_f32 v56, v138, v139
    v_lshlrev_b32 v138, 16, v56
    v_and_b32 v139, 0xffff0000, v56
    v_lshlrev_b32 v57, 16, v49
    v_and_b32 v58, 0xffff0000, v49
    v_mul_f32 v138, v138, v57
    v_mul_f32 v139, v139, v58
    v_cvt_pk_bf16_f32 v136, v136, v137
    v_cvt_pk_bf16_f32 v137, v138, v139
    buffer_store_dwordx2 v[136:137], v25, s[52:55], s13 offen
    v_cvt_pk_bf16_f32 v56, v140, v141
    v_lshlrev_b32 v140, 16, v56
    v_and_b32 v141, 0xffff0000, v56
    v_add_f32 v140, v140, v29
    v_add_f32 v141, v141, v29
    v_cvt_pk_bf16_f32 v56, v140, v141
    v_lshlrev_b32 v140, 16, v56
    v_and_b32 v141, 0xffff0000, v56
    v_lshlrev_b32 v57, 16, v50
    v_and_b32 v58, 0xffff0000, v50
    v_mul_f32 v140, v140, v57
    v_mul_f32 v141, v141, v58
    v_cvt_pk_bf16_f32 v56, v142, v143
    v_lshlrev_b32 v142, 16, v56
    v_and_b32 v143, 0xffff0000, v56
    v_add_f32 v142, v142, v29
    v_add_f32 v143, v143, v29
    v_cvt_pk_bf16_f32 v56, v142, v143
    v_lshlrev_b32 v142, 16, v56
    v_and_b32 v143, 0xffff0000, v56
    v_lshlrev_b32 v57, 16, v51
    v_and_b32 v58, 0xffff0000, v51
    v_mul_f32 v142, v142, v57
    v_mul_f32 v143, v143, v58
    v_cvt_pk_bf16_f32 v140, v140, v141
    v_cvt_pk_bf16_f32 v141, v142, v143
    buffer_store_dwordx2 v[140:141], v26, s[52:55], s13 offen
L_end_g4_kernel:
    s_endpgm
.globl g5r0_kernel
.p2align 8
.type g5r0_kernel,@function
g5r0_kernel:
    s_cmp_ge_u32 s2, 256
    s_cbranch_scc1 L_end_g5r0_kernel
    s_load_dwordx16 s[16:31], s[0:1], 0
    s_load_dwordx4 s[32:35], s[0:1], 64
    s_load_dwordx2 s[36:37], s[0:1], 80
    v_and_b32 v1, 63, v0
    v_lshrrev_b32 v5, 6, v0
    v_bfe_u32 v2, v0, 6, 2
    v_and_b32 v3, 15, v0
    v_bfe_u32 v4, v0, 4, 2
    v_readfirstlane_b32 s39, v5
    s_and_b32 s3, s39, 3
    s_lshr_b32 s38, s39, 2
    s_and_b32 s4, s2, 3
    s_lshl_b32 s4, s4, 3
    s_bfe_u32 s12, s2, 0x30003
    s_add_u32 s4, s4, s12
    s_bfe_u32 s5, s2, 0x10002
    s_lshl_b32 s5, s5, 2
    s_lshr_b32 s12, s2, 6
    s_add_u32 s5, s5, s12
    s_lshl_b32 s6, s4, 6
    s_mov_b32 s9, 0x3f803f80
    s_mul_i32 s10, s5, 128
    s_cmp_eq_u32 s38, 0
    s_cbranch_scc1 L_comp_g5r0_kernel
    s_lshl_b32 s14, s3, 11
    s_mul_i32 s15, s3, 2048
    s_add_u32 s15, s15, 8192
    s_and_b32 s13, s3, 1
    s_lshl_b32 s13, s13, 10
    s_add_u32 s13, s13, 8192
    v_lshrrev_b32 v5, 3, v1
    v_and_b32 v6, 7, v1
    v_xor_b32 v6, v6, v5
    v_lshl_add_u32 v7, v2, 4, v5
    v_add_u32 v7, s6, v7
    s_mov_b32 s11, 1408
    v_mul_lo_u32 v7, v7, s11
    v_lshl_add_u32 v36, v6, 4, v7
    v_add_u32 v37, 11264, v36
    v_mul_u32_u24 v5, 128, v2
    v_add_u32 v5, v5, v1
    s_mov_b32 s11, 1024
    v_add_u32 v6, 0, v5
    v_mul_u32_u24 v7, 8192, v6
    v_lshrrev_b32 v7, 16, v7
    v_mul_u32_u24 v8, 8, v7
    v_sub_u32 v8, v6, v8
    v_bfe_u32 v9, v7, 1, 1
    v_bfe_u32 v17, v7, 3, 1
    v_lshl_or_b32 v9, v17, 1, v9
    v_lshrrev_b32 v17, 1, v8
    v_xor_b32 v9, v9, v17
    v_and_b32 v8, 1, v8
    v_mul_lo_u32 v7, v7, s11
    v_lshl_add_u32 v7, v8, 4, v7
    v_lshl_add_u32 v7, v9, 5, v7
    v_add_u32 v40, s10, v7
    v_add_u32 v6, 64, v5
    v_mul_u32_u24 v7, 8192, v6
    v_lshrrev_b32 v7, 16, v7
    v_mul_u32_u24 v8, 8, v7
    v_sub_u32 v8, v6, v8
    v_bfe_u32 v9, v7, 1, 1
    v_bfe_u32 v17, v7, 3, 1
    v_lshl_or_b32 v9, v17, 1, v9
    v_lshrrev_b32 v17, 1, v8
    v_xor_b32 v9, v9, v17
    v_and_b32 v8, 1, v8
    v_mul_lo_u32 v7, v7, s11
    v_lshl_add_u32 v7, v8, 4, v7
    v_lshl_add_u32 v7, v9, 5, v7
    v_add_u32 v41, s10, v7
    s_waitcnt lgkmcnt(0)
    s_add_u32 s40, s36, 15728640
    s_addc_u32 s41, s37, 0
    s_mov_b32 s42, 2883584
    s_mov_b32 s43, 0x00020000
    s_mov_b32 s44, s30
    s_mov_b32 s45, s31
    s_mov_b32 s46, 704512
    s_mov_b32 s47, 0x00020000
    s_mov_b32 s7, 0
    s_mov_b32 s8, 0
    s_add_u32 m0, s15, 0
    s_nop 0
    buffer_load_dwordx4 v40, s[44:47], s8 offen lds
    s_add_u32 m0, s15, 1024
    s_nop 0
    buffer_load_dwordx4 v41, s[44:47], s8 offen lds
    s_add_u32 m0, s14, 0
    s_nop 0
    buffer_load_dwordx4 v36, s[40:43], s7 offen lds
    s_add_u32 m0, s14, 1024
    s_nop 0
    buffer_load_dwordx4 v37, s[40:43], s7 offen lds
    s_mov_b32 s7, 128
    s_mov_b32 s8, 65536
    s_add_u32 m0, s15, 16384
    s_nop 0
    buffer_load_dwordx4 v40, s[44:47], s8 offen lds
    s_add_u32 m0, s15, 17408
    s_nop 0
    buffer_load_dwordx4 v41, s[44:47], s8 offen lds
    s_add_u32 m0, s14, 16384
    s_nop 0
    buffer_load_dwordx4 v36, s[40:43], s7 offen lds
    s_add_u32 m0, s14, 17408
    s_nop 0
    buffer_load_dwordx4 v37, s[40:43], s7 offen lds
    s_waitcnt vmcnt(4)
    s_barrier
    s_mov_b32 s7, 256
    s_mov_b32 s8, 131072
    s_add_u32 m0, s15, 32768
    s_nop 0
    buffer_load_dwordx4 v40, s[44:47], s8 offen lds
    s_add_u32 m0, s15, 33792
    s_nop 0
    buffer_load_dwordx4 v41, s[44:47], s8 offen lds
    s_add_u32 m0, s14, 32768
    s_nop 0
    buffer_load_dwordx4 v36, s[40:43], s7 offen lds
    s_add_u32 m0, s14, 33792
    s_nop 0
    buffer_load_dwordx4 v37, s[40:43], s7 offen lds
    s_mov_b32 s7, 384
    s_mov_b32 s8, 196608
    s_add_u32 m0, s15, 49152
    s_nop 0
    buffer_load_dwordx4 v40, s[44:47], s8 offen lds
    s_add_u32 m0, s15, 50176
    s_nop 0
    buffer_load_dwordx4 v41, s[44:47], s8 offen lds
    s_add_u32 m0, s14, 49152
    s_nop 0
    buffer_load_dwordx4 v36, s[40:43], s7 offen lds
    s_add_u32 m0, s14, 50176
    s_nop 0
    buffer_load_dwordx4 v37, s[40:43], s7 offen lds
    s_waitcnt vmcnt(4)
    s_barrier
    s_mov_b32 s7, 512
    s_mov_b32 s8, 262144
    s_add_u32 m0, s15, 65536
    s_nop 0
    buffer_load_dwordx4 v40, s[44:47], s8 offen lds
    s_add_u32 m0, s15, 66560
    s_nop 0
    buffer_load_dwordx4 v41, s[44:47], s8 offen lds
    s_add_u32 m0, s14, 65536
    s_nop 0
    buffer_load_dwordx4 v36, s[40:43], s7 offen lds
    s_add_u32 m0, s14, 66560
    s_nop 0
    buffer_load_dwordx4 v37, s[40:43], s7 offen lds
    s_mov_b32 s7, 640
    s_mov_b32 s8, 327680
    s_add_u32 m0, s15, 81920
    s_nop 0
    buffer_load_dwordx4 v40, s[44:47], s8 offen lds
    s_add_u32 m0, s15, 82944
    s_nop 0
    buffer_load_dwordx4 v41, s[44:47], s8 offen lds
    s_add_u32 m0, s14, 81920
    s_nop 0
    buffer_load_dwordx4 v36, s[40:43], s7 offen lds
    s_add_u32 m0, s14, 82944
    s_nop 0
    buffer_load_dwordx4 v37, s[40:43], s7 offen lds
    s_waitcnt vmcnt(8)
    s_barrier
    s_mov_b32 s7, 768
    s_mov_b32 s8, 393216
    s_add_u32 m0, s15, 0
    s_nop 0
    buffer_load_dwordx4 v40, s[44:47], s8 offen lds
    s_add_u32 m0, s15, 1024
    s_nop 0
    buffer_load_dwordx4 v41, s[44:47], s8 offen lds
    s_add_u32 m0, s14, 0
    s_nop 0
    buffer_load_dwordx4 v36, s[40:43], s7 offen lds
    s_add_u32 m0, s14, 1024
    s_nop 0
    buffer_load_dwordx4 v37, s[40:43], s7 offen lds
    s_mov_b32 s7, 896
    s_mov_b32 s8, 458752
    s_add_u32 m0, s15, 16384
    s_nop 0
    buffer_load_dwordx4 v40, s[44:47], s8 offen lds
    s_add_u32 m0, s15, 17408
    s_nop 0
    buffer_load_dwordx4 v41, s[44:47], s8 offen lds
    s_add_u32 m0, s14, 16384
    s_nop 0
    buffer_load_dwordx4 v36, s[40:43], s7 offen lds
    s_add_u32 m0, s14, 17408
    s_nop 0
    buffer_load_dwordx4 v37, s[40:43], s7 offen lds
    s_waitcnt vmcnt(12)
    s_barrier
    s_mov_b32 s7, 1024
    s_mov_b32 s8, 524288
    s_add_u32 m0, s15, 32768
    s_nop 0
    buffer_load_dwordx4 v40, s[44:47], s8 offen lds
    s_add_u32 m0, s15, 33792
    s_nop 0
    buffer_load_dwordx4 v41, s[44:47], s8 offen lds
    s_add_u32 m0, s14, 32768
    s_nop 0
    buffer_load_dwordx4 v36, s[40:43], s7 offen lds
    s_add_u32 m0, s14, 33792
    s_nop 0
    buffer_load_dwordx4 v37, s[40:43], s7 offen lds
    s_waitcnt vmcnt(12)
    s_barrier
    s_mov_b32 s7, 1152
    s_mov_b32 s8, 589824
    s_add_u32 m0, s15, 49152
    s_nop 0
    buffer_load_dwordx4 v40, s[44:47], s8 offen lds
    s_add_u32 m0, s15, 50176
    s_nop 0
    buffer_load_dwordx4 v41, s[44:47], s8 offen lds
    s_add_u32 m0, s14, 49152
    s_nop 0
    buffer_load_dwordx4 v36, s[40:43], s7 offen lds
    s_add_u32 m0, s14, 50176
    s_nop 0
    buffer_load_dwordx4 v37, s[40:43], s7 offen lds
    s_waitcnt vmcnt(12)
    s_barrier
    s_mov_b32 s7, 1280
    s_mov_b32 s8, 655360
    s_add_u32 m0, s15, 65536
    s_nop 0
    buffer_load_dwordx4 v40, s[44:47], s8 offen lds
    s_add_u32 m0, s15, 66560
    s_nop 0
    buffer_load_dwordx4 v41, s[44:47], s8 offen lds
    s_add_u32 m0, s14, 65536
    s_nop 0
    buffer_load_dwordx4 v36, s[40:43], s7 offen lds
    s_add_u32 m0, s14, 66560
    s_nop 0
    buffer_load_dwordx4 v37, s[40:43], s7 offen lds
    s_waitcnt vmcnt(12)
    s_barrier
    s_waitcnt vmcnt(8)
    s_barrier
    s_waitcnt vmcnt(4)
    s_barrier
    s_waitcnt vmcnt(0)
    s_barrier
    s_waitcnt vmcnt(0)
    s_barrier
    s_endpgm
L_comp_g5r0_kernel:
    s_waitcnt lgkmcnt(0)
    s_add_u32 s48, s36, 2097152
    s_addc_u32 s49, s37, 0
    s_mov_b32 s50, 2097152
    s_mov_b32 s51, 0x00020000
    s_add_u32 s52, s36, 4194304
    s_addc_u32 s53, s37, 0
    s_mov_b32 s54, 2097152
    s_mov_b32 s55, 0x00020000
    v_lshrrev_b32 v5, 1, v2
    v_and_b32 v6, 1, v2
    v_lshl_add_u32 v5, v5, 5, v3
    v_add_u32 v5, s6, v5
    s_mul_i32 s12, s5, 64
    v_mul_u32_u24 v6, 32, v6
    v_lshl_add_u32 v6, v4, 2, v6
    v_add_u32 v6, s12, v6
    v_lshlrev_b32 v20, 10, v5
    v_lshl_add_u32 v20, v6, 1, v20
    v_add_u32 v21, 16384, v20
    buffer_load_dwordx2 v[40:41], v20, s[48:51], 0 offen offset:0
    buffer_load_dwordx2 v[42:43], v20, s[48:51], 0 offen offset:32
    buffer_load_dwordx2 v[44:45], v21, s[48:51], 0 offen offset:0
    buffer_load_dwordx2 v[46:47], v21, s[48:51], 0 offen offset:32
    v_lshrrev_b32 v9, 1, v2
    v_add_u32 v7, 0, v4
    v_and_b32 v17, 7, v3
    v_xor_b32 v7, v7, v17
    v_lshlrev_b32 v7, 4, v7
    v_lshl_add_u32 v14, v3, 7, v7
    v_lshl_add_u32 v14, v9, 12, v14
    v_add_u32 v7, 4, v4
    v_and_b32 v17, 7, v3
    v_xor_b32 v7, v7, v17
    v_lshlrev_b32 v7, 4, v7
    v_lshl_add_u32 v15, v3, 7, v7
    v_lshl_add_u32 v15, v9, 12, v15
    v_and_b32 v9, 1, v2
    v_mul_u32_u24 v9, 2, v9
    v_add_u32 v9, 0, v9
    v_lshrrev_b32 v5, 2, v3
    v_lshl_add_u32 v5, v4, 3, v5
    v_bfe_u32 v6, v5, 1, 1
    v_bfe_u32 v7, v5, 3, 1
    v_lshl_or_b32 v6, v7, 1, v6
    v_xor_b32 v6, v6, v9
    v_mul_u32_u24 v5, 128, v5
    v_lshl_add_u32 v5, v6, 5, v5
    v_and_b32 v6, 3, v3
    v_lshl_add_u32 v5, v6, 3, v5
    v_add_u32 v16, 8192, v5
    v_and_b32 v9, 1, v2
    v_mul_u32_u24 v9, 2, v9
    v_add_u32 v9, 1, v9
    v_lshrrev_b32 v5, 2, v3
    v_lshl_add_u32 v5, v4, 3, v5
    v_bfe_u32 v6, v5, 1, 1
    v_bfe_u32 v7, v5, 3, 1
    v_lshl_or_b32 v6, v7, 1, v6
    v_xor_b32 v6, v6, v9
    v_mul_u32_u24 v5, 128, v5
    v_lshl_add_u32 v5, v6, 5, v5
    v_and_b32 v6, 3, v3
    v_lshl_add_u32 v5, v6, 3, v5
    v_add_u32 v17, 8192, v5
    v_add_u32 v212, 16384, v14
    v_add_u32 v213, 16384, v15
    v_add_u32 v214, 16384, v16
    v_add_u32 v215, 16384, v17
    v_add_u32 v217, 32768, v14
    v_add_u32 v218, 32768, v15
    v_add_u32 v219, 32768, v16
    v_add_u32 v220, 32768, v17
    v_add_u32 v222, 49152, v14
    v_add_u32 v223, 49152, v15
    v_add_u32 v224, 49152, v16
    v_add_u32 v225, 49152, v17
    v_add_u32 v227, 65536, v14
    v_add_u32 v228, 65536, v15
    v_add_u32 v229, 65536, v16
    v_add_u32 v230, 65536, v17
    v_add_u32 v232, 81920, v14
    v_add_u32 v233, 81920, v15
    v_add_u32 v234, 81920, v16
    v_add_u32 v235, 81920, v17
    v_mov_b32 v120, 0
    v_mov_b32 v121, 0
    v_mov_b32 v122, 0
    v_mov_b32 v123, 0
    v_mov_b32 v124, 0
    v_mov_b32 v125, 0
    v_mov_b32 v126, 0
    v_mov_b32 v127, 0
    v_mov_b32 v128, 0
    v_mov_b32 v129, 0
    v_mov_b32 v130, 0
    v_mov_b32 v131, 0
    v_mov_b32 v132, 0
    v_mov_b32 v133, 0
    v_mov_b32 v134, 0
    v_mov_b32 v135, 0
    s_barrier
    ds_read_b64_tr_b16 v[76:77], v16 offset:0
    ds_read_b64_tr_b16 v[78:79], v16 offset:512
    ds_read_b64_tr_b16 v[80:81], v17 offset:0
    ds_read_b64_tr_b16 v[82:83], v17 offset:512
    ds_read_b128 v[56:59], v14 offset:0
    ds_read_b128 v[60:63], v14 offset:2048
    s_waitcnt lgkmcnt(0)
    v_mfma_f32_16x16x32_bf16 v[120:123], v[76:79], v[56:59], v[120:123]
    ds_read_b64_tr_b16 v[108:109], v16 offset:4096
    ds_read_b64_tr_b16 v[110:111], v16 offset:4608
    v_mfma_f32_16x16x32_bf16 v[124:127], v[80:83], v[56:59], v[124:127]
    ds_read_b64_tr_b16 v[112:113], v17 offset:4096
    ds_read_b64_tr_b16 v[114:115], v17 offset:4608
    v_mfma_f32_16x16x32_bf16 v[128:131], v[76:79], v[60:63], v[128:131]
    ds_read_b128 v[88:91], v15 offset:0
    ds_read_b128 v[92:95], v15 offset:2048
    v_mfma_f32_16x16x32_bf16 v[132:135], v[80:83], v[60:63], v[132:135]
    s_waitcnt lgkmcnt(0)
    v_mfma_f32_16x16x32_bf16 v[120:123], v[108:111], v[88:91], v[120:123]
    v_mfma_f32_16x16x32_bf16 v[124:127], v[112:115], v[88:91], v[124:127]
    v_mfma_f32_16x16x32_bf16 v[128:131], v[108:111], v[92:95], v[128:131]
    v_mfma_f32_16x16x32_bf16 v[132:135], v[112:115], v[92:95], v[132:135]
    s_barrier
    ds_read_b64_tr_b16 v[76:77], v214 offset:0
    ds_read_b64_tr_b16 v[78:79], v214 offset:512
    ds_read_b64_tr_b16 v[80:81], v215 offset:0
    ds_read_b64_tr_b16 v[82:83], v215 offset:512
    ds_read_b128 v[56:59], v212 offset:0
    ds_read_b128 v[60:63], v212 offset:2048
    s_waitcnt lgkmcnt(0)
    v_mfma_f32_16x16x32_bf16 v[120:123], v[76:79], v[56:59], v[120:123]
    ds_read_b64_tr_b16 v[108:109], v214 offset:4096
    ds_read_b64_tr_b16 v[110:111], v214 offset:4608
    v_mfma_f32_16x16x32_bf16 v[124:127], v[80:83], v[56:59], v[124:127]
    ds_read_b64_tr_b16 v[112:113], v215 offset:4096
    ds_read_b64_tr_b16 v[114:115], v215 offset:4608
    v_mfma_f32_16x16x32_bf16 v[128:131], v[76:79], v[60:63], v[128:131]
    ds_read_b128 v[88:91], v213 offset:0
    ds_read_b128 v[92:95], v213 offset:2048
    v_mfma_f32_16x16x32_bf16 v[132:135], v[80:83], v[60:63], v[132:135]
    s_waitcnt lgkmcnt(0)
    v_mfma_f32_16x16x32_bf16 v[120:123], v[108:111], v[88:91], v[120:123]
    ds_read_b64_tr_b16 v[76:77], v219 offset:0
    ds_read_b64_tr_b16 v[78:79], v219 offset:512
    v_mfma_f32_16x16x32_bf16 v[124:127], v[112:115], v[88:91], v[124:127]
    ds_read_b64_tr_b16 v[80:81], v220 offset:0
    ds_read_b64_tr_b16 v[82:83], v220 offset:512
    v_mfma_f32_16x16x32_bf16 v[128:131], v[108:111], v[92:95], v[128:131]
    ds_read_b128 v[56:59], v217 offset:0
    ds_read_b128 v[60:63], v217 offset:2048
    v_mfma_f32_16x16x32_bf16 v[132:135], v[112:115], v[92:95], v[132:135]
    s_barrier
    s_waitcnt lgkmcnt(0)
    v_mfma_f32_16x16x32_bf16 v[120:123], v[76:79], v[56:59], v[120:123]
    ds_read_b64_tr_b16 v[108:109], v219 offset:4096
    ds_read_b64_tr_b16 v[110:111], v219 offset:4608
    v_mfma_f32_16x16x32_bf16 v[124:127], v[80:83], v[56:59], v[124:127]
    ds_read_b64_tr_b16 v[112:113], v220 offset:4096
    ds_read_b64_tr_b16 v[114:115], v220 offset:4608
    v_mfma_f32_16x16x32_bf16 v[128:131], v[76:79], v[60:63], v[128:131]
    ds_read_b128 v[88:91], v218 offset:0
    ds_read_b128 v[92:95], v218 offset:2048
    v_mfma_f32_16x16x32_bf16 v[132:135], v[80:83], v[60:63], v[132:135]
    s_waitcnt lgkmcnt(0)
    v_mfma_f32_16x16x32_bf16 v[120:123], v[108:111], v[88:91], v[120:123]
    ds_read_b64_tr_b16 v[76:77], v224 offset:0
    ds_read_b64_tr_b16 v[78:79], v224 offset:512
    v_mfma_f32_16x16x32_bf16 v[124:127], v[112:115], v[88:91], v[124:127]
    ds_read_b64_tr_b16 v[80:81], v225 offset:0
    ds_read_b64_tr_b16 v[82:83], v225 offset:512
    v_mfma_f32_16x16x32_bf16 v[128:131], v[108:111], v[92:95], v[128:131]
    ds_read_b128 v[56:59], v222 offset:0
    ds_read_b128 v[60:63], v222 offset:2048
    v_mfma_f32_16x16x32_bf16 v[132:135], v[112:115], v[92:95], v[132:135]
    s_barrier
    s_waitcnt lgkmcnt(0)
    v_mfma_f32_16x16x32_bf16 v[120:123], v[76:79], v[56:59], v[120:123]
    ds_read_b64_tr_b16 v[108:109], v224 offset:4096
    ds_read_b64_tr_b16 v[110:111], v224 offset:4608
    v_mfma_f32_16x16x32_bf16 v[124:127], v[80:83], v[56:59], v[124:127]
    ds_read_b64_tr_b16 v[112:113], v225 offset:4096
    ds_read_b64_tr_b16 v[114:115], v225 offset:4608
    v_mfma_f32_16x16x32_bf16 v[128:131], v[76:79], v[60:63], v[128:131]
    ds_read_b128 v[88:91], v223 offset:0
    ds_read_b128 v[92:95], v223 offset:2048
    v_mfma_f32_16x16x32_bf16 v[132:135], v[80:83], v[60:63], v[132:135]
    s_waitcnt lgkmcnt(0)
    v_mfma_f32_16x16x32_bf16 v[120:123], v[108:111], v[88:91], v[120:123]
    ds_read_b64_tr_b16 v[76:77], v229 offset:0
    ds_read_b64_tr_b16 v[78:79], v229 offset:512
    v_mfma_f32_16x16x32_bf16 v[124:127], v[112:115], v[88:91], v[124:127]
    ds_read_b64_tr_b16 v[80:81], v230 offset:0
    ds_read_b64_tr_b16 v[82:83], v230 offset:512
    v_mfma_f32_16x16x32_bf16 v[128:131], v[108:111], v[92:95], v[128:131]
    ds_read_b128 v[56:59], v227 offset:0
    ds_read_b128 v[60:63], v227 offset:2048
    v_mfma_f32_16x16x32_bf16 v[132:135], v[112:115], v[92:95], v[132:135]
    s_barrier
    s_waitcnt lgkmcnt(0)
    v_mfma_f32_16x16x32_bf16 v[120:123], v[76:79], v[56:59], v[120:123]
    ds_read_b64_tr_b16 v[108:109], v229 offset:4096
    ds_read_b64_tr_b16 v[110:111], v229 offset:4608
    v_mfma_f32_16x16x32_bf16 v[124:127], v[80:83], v[56:59], v[124:127]
    ds_read_b64_tr_b16 v[112:113], v230 offset:4096
    ds_read_b64_tr_b16 v[114:115], v230 offset:4608
    v_mfma_f32_16x16x32_bf16 v[128:131], v[76:79], v[60:63], v[128:131]
    ds_read_b128 v[88:91], v228 offset:0
    ds_read_b128 v[92:95], v228 offset:2048
    v_mfma_f32_16x16x32_bf16 v[132:135], v[80:83], v[60:63], v[132:135]
    s_waitcnt lgkmcnt(0)
    v_mfma_f32_16x16x32_bf16 v[120:123], v[108:111], v[88:91], v[120:123]
    ds_read_b64_tr_b16 v[76:77], v234 offset:0
    ds_read_b64_tr_b16 v[78:79], v234 offset:512
    v_mfma_f32_16x16x32_bf16 v[124:127], v[112:115], v[88:91], v[124:127]
    ds_read_b64_tr_b16 v[80:81], v235 offset:0
    ds_read_b64_tr_b16 v[82:83], v235 offset:512
    v_mfma_f32_16x16x32_bf16 v[128:131], v[108:111], v[92:95], v[128:131]
    ds_read_b128 v[56:59], v232 offset:0
    ds_read_b128 v[60:63], v232 offset:2048
    v_mfma_f32_16x16x32_bf16 v[132:135], v[112:115], v[92:95], v[132:135]
    s_barrier
    s_waitcnt lgkmcnt(0)
    v_mfma_f32_16x16x32_bf16 v[120:123], v[76:79], v[56:59], v[120:123]
    ds_read_b64_tr_b16 v[108:109], v234 offset:4096
    ds_read_b64_tr_b16 v[110:111], v234 offset:4608
    v_mfma_f32_16x16x32_bf16 v[124:127], v[80:83], v[56:59], v[124:127]
    ds_read_b64_tr_b16 v[112:113], v235 offset:4096
    ds_read_b64_tr_b16 v[114:115], v235 offset:4608
    v_mfma_f32_16x16x32_bf16 v[128:131], v[76:79], v[60:63], v[128:131]
    ds_read_b128 v[88:91], v233 offset:0
    ds_read_b128 v[92:95], v233 offset:2048
    v_mfma_f32_16x16x32_bf16 v[132:135], v[80:83], v[60:63], v[132:135]
    s_waitcnt lgkmcnt(0)
    v_mfma_f32_16x16x32_bf16 v[120:123], v[108:111], v[88:91], v[120:123]
    ds_read_b64_tr_b16 v[76:77], v16 offset:0
    ds_read_b64_tr_b16 v[78:79], v16 offset:512
    v_mfma_f32_16x16x32_bf16 v[124:127], v[112:115], v[88:91], v[124:127]
    ds_read_b64_tr_b16 v[80:81], v17 offset:0
    ds_read_b64_tr_b16 v[82:83], v17 offset:512
    v_mfma_f32_16x16x32_bf16 v[128:131], v[108:111], v[92:95], v[128:131]
    ds_read_b128 v[56:59], v14 offset:0
    ds_read_b128 v[60:63], v14 offset:2048
    v_mfma_f32_16x16x32_bf16 v[132:135], v[112:115], v[92:95], v[132:135]
    s_barrier
    s_waitcnt lgkmcnt(0)
    v_mfma_f32_16x16x32_bf16 v[120:123], v[76:79], v[56:59], v[120:123]
    ds_read_b64_tr_b16 v[108:109], v16 offset:4096
    ds_read_b64_tr_b16 v[110:111], v16 offset:4608
    v_mfma_f32_16x16x32_bf16 v[124:127], v[80:83], v[56:59], v[124:127]
    ds_read_b64_tr_b16 v[112:113], v17 offset:4096
    ds_read_b64_tr_b16 v[114:115], v17 offset:4608
    v_mfma_f32_16x16x32_bf16 v[128:131], v[76:79], v[60:63], v[128:131]
    ds_read_b128 v[88:91], v15 offset:0
    ds_read_b128 v[92:95], v15 offset:2048
    v_mfma_f32_16x16x32_bf16 v[132:135], v[80:83], v[60:63], v[132:135]
    s_waitcnt lgkmcnt(0)
    v_mfma_f32_16x16x32_bf16 v[120:123], v[108:111], v[88:91], v[120:123]
    ds_read_b64_tr_b16 v[76:77], v214 offset:0
    ds_read_b64_tr_b16 v[78:79], v214 offset:512
    v_mfma_f32_16x16x32_bf16 v[124:127], v[112:115], v[88:91], v[124:127]
    ds_read_b64_tr_b16 v[80:81], v215 offset:0
    ds_read_b64_tr_b16 v[82:83], v215 offset:512
    v_mfma_f32_16x16x32_bf16 v[128:131], v[108:111], v[92:95], v[128:131]
    ds_read_b128 v[56:59], v212 offset:0
    ds_read_b128 v[60:63], v212 offset:2048
    v_mfma_f32_16x16x32_bf16 v[132:135], v[112:115], v[92:95], v[132:135]
    s_barrier
    s_waitcnt lgkmcnt(0)
    v_mfma_f32_16x16x32_bf16 v[120:123], v[76:79], v[56:59], v[120:123]
    ds_read_b64_tr_b16 v[108:109], v214 offset:4096
    ds_read_b64_tr_b16 v[110:111], v214 offset:4608
    v_mfma_f32_16x16x32_bf16 v[124:127], v[80:83], v[56:59], v[124:127]
    ds_read_b64_tr_b16 v[112:113], v215 offset:4096
    ds_read_b64_tr_b16 v[114:115], v215 offset:4608
    v_mfma_f32_16x16x32_bf16 v[128:131], v[76:79], v[60:63], v[128:131]
    ds_read_b128 v[88:91], v213 offset:0
    ds_read_b128 v[92:95], v213 offset:2048
    v_mfma_f32_16x16x32_bf16 v[132:135], v[80:83], v[60:63], v[132:135]
    s_waitcnt lgkmcnt(0)
    v_mfma_f32_16x16x32_bf16 v[120:123], v[108:111], v[88:91], v[120:123]
    ds_read_b64_tr_b16 v[76:77], v219 offset:0
    ds_read_b64_tr_b16 v[78:79], v219 offset:512
    v_mfma_f32_16x16x32_bf16 v[124:127], v[112:115], v[88:91], v[124:127]
    ds_read_b64_tr_b16 v[80:81], v220 offset:0
    ds_read_b64_tr_b16 v[82:83], v220 offset:512
    v_mfma_f32_16x16x32_bf16 v[128:131], v[108:111], v[92:95], v[128:131]
    ds_read_b128 v[56:59], v217 offset:0
    ds_read_b128 v[60:63], v217 offset:2048
    v_mfma_f32_16x16x32_bf16 v[132:135], v[112:115], v[92:95], v[132:135]
    s_barrier
    s_waitcnt lgkmcnt(0)
    v_mfma_f32_16x16x32_bf16 v[120:123], v[76:79], v[56:59], v[120:123]
    ds_read_b64_tr_b16 v[108:109], v219 offset:4096
    ds_read_b64_tr_b16 v[110:111], v219 offset:4608
    v_mfma_f32_16x16x32_bf16 v[124:127], v[80:83], v[56:59], v[124:127]
    ds_read_b64_tr_b16 v[112:113], v220 offset:4096
    ds_read_b64_tr_b16 v[114:115], v220 offset:4608
    v_mfma_f32_16x16x32_bf16 v[128:131], v[76:79], v[60:63], v[128:131]
    ds_read_b128 v[88:91], v218 offset:0
    ds_read_b128 v[92:95], v218 offset:2048
    v_mfma_f32_16x16x32_bf16 v[132:135], v[80:83], v[60:63], v[132:135]
    s_waitcnt lgkmcnt(0)
    v_mfma_f32_16x16x32_bf16 v[120:123], v[108:111], v[88:91], v[120:123]
    ds_read_b64_tr_b16 v[76:77], v224 offset:0
    ds_read_b64_tr_b16 v[78:79], v224 offset:512
    v_mfma_f32_16x16x32_bf16 v[124:127], v[112:115], v[88:91], v[124:127]
    ds_read_b64_tr_b16 v[80:81], v225 offset:0
    ds_read_b64_tr_b16 v[82:83], v225 offset:512
    v_mfma_f32_16x16x32_bf16 v[128:131], v[108:111], v[92:95], v[128:131]
    ds_read_b128 v[56:59], v222 offset:0
    ds_read_b128 v[60:63], v222 offset:2048
    v_mfma_f32_16x16x32_bf16 v[132:135], v[112:115], v[92:95], v[132:135]
    s_barrier
    s_waitcnt lgkmcnt(0)
    v_mfma_f32_16x16x32_bf16 v[120:123], v[76:79], v[56:59], v[120:123]
    ds_read_b64_tr_b16 v[108:109], v224 offset:4096
    ds_read_b64_tr_b16 v[110:111], v224 offset:4608
    v_mfma_f32_16x16x32_bf16 v[124:127], v[80:83], v[56:59], v[124:127]
    ds_read_b64_tr_b16 v[112:113], v225 offset:4096
    ds_read_b64_tr_b16 v[114:115], v225 offset:4608
    v_mfma_f32_16x16x32_bf16 v[128:131], v[76:79], v[60:63], v[128:131]
    ds_read_b128 v[88:91], v223 offset:0
    ds_read_b128 v[92:95], v223 offset:2048
    v_mfma_f32_16x16x32_bf16 v[132:135], v[80:83], v[60:63], v[132:135]
    s_waitcnt lgkmcnt(0)
    v_mfma_f32_16x16x32_bf16 v[120:123], v[108:111], v[88:91], v[120:123]
    ds_read_b64_tr_b16 v[76:77], v229 offset:0
    ds_read_b64_tr_b16 v[78:79], v229 offset:512
    v_mfma_f32_16x16x32_bf16 v[124:127], v[112:115], v[88:91], v[124:127]
    ds_read_b64_tr_b16 v[80:81], v230 offset:0
    ds_read_b64_tr_b16 v[82:83], v230 offset:512
    v_mfma_f32_16x16x32_bf16 v[128:131], v[108:111], v[92:95], v[128:131]
    ds_read_b128 v[56:59], v227 offset:0
    ds_read_b128 v[60:63], v227 offset:2048
    v_mfma_f32_16x16x32_bf16 v[132:135], v[112:115], v[92:95], v[132:135]
    s_barrier
    s_waitcnt lgkmcnt(0)
    v_mfma_f32_16x16x32_bf16 v[120:123], v[76:79], v[56:59], v[120:123]
    ds_read_b64_tr_b16 v[108:109], v229 offset:4096
    ds_read_b64_tr_b16 v[110:111], v229 offset:4608
    v_mfma_f32_16x16x32_bf16 v[124:127], v[80:83], v[56:59], v[124:127]
    ds_read_b64_tr_b16 v[112:113], v230 offset:4096
    ds_read_b64_tr_b16 v[114:115], v230 offset:4608
    v_mfma_f32_16x16x32_bf16 v[128:131], v[76:79], v[60:63], v[128:131]
    ds_read_b128 v[88:91], v228 offset:0
    ds_read_b128 v[92:95], v228 offset:2048
    v_mfma_f32_16x16x32_bf16 v[132:135], v[80:83], v[60:63], v[132:135]
    s_waitcnt lgkmcnt(0)
    v_mfma_f32_16x16x32_bf16 v[120:123], v[108:111], v[88:91], v[120:123]
    v_mfma_f32_16x16x32_bf16 v[124:127], v[112:115], v[88:91], v[124:127]
    v_mfma_f32_16x16x32_bf16 v[128:131], v[108:111], v[92:95], v[128:131]
    v_mfma_f32_16x16x32_bf16 v[132:135], v[112:115], v[92:95], v[132:135]
    s_waitcnt vmcnt(0)
    s_nop 9
    v_cvt_pk_bf16_f32 v56, v120, v121
    v_lshlrev_b32 v120, 16, v56
    v_and_b32 v121, 0xffff0000, v56
    v_lshlrev_b32 v57, 16, v40
    v_and_b32 v58, 0xffff0000, v40
    v_add_f32 v120, v120, v57
    v_add_f32 v121, v121, v58
    v_cvt_pk_bf16_f32 v56, v122, v123
    v_lshlrev_b32 v122, 16, v56
    v_and_b32 v123, 0xffff0000, v56
    v_lshlrev_b32 v57, 16, v41
    v_and_b32 v58, 0xffff0000, v41
    v_add_f32 v122, v122, v57
    v_add_f32 v123, v123, v58
    v_cvt_pk_bf16_f32 v120, v120, v121
    v_cvt_pk_bf16_f32 v121, v122, v123
    buffer_store_dwordx2 v[120:121], v20, s[52:55], 0 offen offset:0
    v_cvt_pk_bf16_f32 v56, v124, v125
    v_lshlrev_b32 v124, 16, v56
    v_and_b32 v125, 0xffff0000, v56
    v_lshlrev_b32 v57, 16, v42
    v_and_b32 v58, 0xffff0000, v42
    v_add_f32 v124, v124, v57
    v_add_f32 v125, v125, v58
    v_cvt_pk_bf16_f32 v56, v126, v127
    v_lshlrev_b32 v126, 16, v56
    v_and_b32 v127, 0xffff0000, v56
    v_lshlrev_b32 v57, 16, v43
    v_and_b32 v58, 0xffff0000, v43
    v_add_f32 v126, v126, v57
    v_add_f32 v127, v127, v58
    v_cvt_pk_bf16_f32 v124, v124, v125
    v_cvt_pk_bf16_f32 v125, v126, v127
    buffer_store_dwordx2 v[124:125], v20, s[52:55], 0 offen offset:32
    v_cvt_pk_bf16_f32 v56, v128, v129
    v_lshlrev_b32 v128, 16, v56
    v_and_b32 v129, 0xffff0000, v56
    v_lshlrev_b32 v57, 16, v44
    v_and_b32 v58, 0xffff0000, v44
    v_add_f32 v128, v128, v57
    v_add_f32 v129, v129, v58
    v_cvt_pk_bf16_f32 v56, v130, v131
    v_lshlrev_b32 v130, 16, v56
    v_and_b32 v131, 0xffff0000, v56
    v_lshlrev_b32 v57, 16, v45
    v_and_b32 v58, 0xffff0000, v45
    v_add_f32 v130, v130, v57
    v_add_f32 v131, v131, v58
    v_cvt_pk_bf16_f32 v128, v128, v129
    v_cvt_pk_bf16_f32 v129, v130, v131
    buffer_store_dwordx2 v[128:129], v21, s[52:55], 0 offen offset:0
    v_cvt_pk_bf16_f32 v56, v132, v133
    v_lshlrev_b32 v132, 16, v56
    v_and_b32 v133, 0xffff0000, v56
    v_lshlrev_b32 v57, 16, v46
    v_and_b32 v58, 0xffff0000, v46
    v_add_f32 v132, v132, v57
    v_add_f32 v133, v133, v58
    v_cvt_pk_bf16_f32 v56, v134, v135
    v_lshlrev_b32 v134, 16, v56
    v_and_b32 v135, 0xffff0000, v56
    v_lshlrev_b32 v57, 16, v47
    v_and_b32 v58, 0xffff0000, v47
    v_add_f32 v134, v134, v57
    v_add_f32 v135, v135, v58
    v_cvt_pk_bf16_f32 v132, v132, v133
    v_cvt_pk_bf16_f32 v133, v134, v135
    buffer_store_dwordx2 v[132:133], v21, s[52:55], 0 offen offset:32
L_end_g5r0_kernel:
    s_endpgm
.globl g1a1_kernel
.p2align 8
.type g1a1_kernel,@function
g1a1_kernel:
    s_cmp_ge_u32 s2, 256
    s_cbranch_scc1 L_end_g1a1_kernel
    s_load_dwordx16 s[16:31], s[0:1], 0
    s_load_dwordx4 s[32:35], s[0:1], 64
    s_load_dwordx2 s[36:37], s[0:1], 80
    v_and_b32 v1, 63, v0
    v_lshrrev_b32 v5, 6, v0
    v_bfe_u32 v2, v0, 6, 2
    v_and_b32 v3, 15, v0
    v_bfe_u32 v4, v0, 4, 2
    v_readfirstlane_b32 s39, v5
    s_and_b32 s3, s39, 3
    s_lshr_b32 s38, s39, 2
    s_and_b32 s4, s2, 3
    s_lshl_b32 s4, s4, 3
    s_bfe_u32 s12, s2, 0x30003
    s_add_u32 s4, s4, s12
    s_bfe_u32 s5, s2, 0x10002
    s_lshl_b32 s5, s5, 2
    s_lshr_b32 s12, s2, 6
    s_add_u32 s5, s5, s12
    s_lshl_b32 s6, s4, 6
    s_mov_b32 s9, 0x3f803f80
    s_lshl_b32 s10, s5, 7
    s_cmp_eq_u32 s38, 0
    s_cbranch_scc1 L_comp_g1a1_kernel
    s_lshl_b32 s14, s3, 11
    s_mul_i32 s15, s3, 6144
    s_add_u32 s15, s15, 10240
    s_and_b32 s13, s3, 1
    s_lshl_b32 s13, s13, 10
    s_add_u32 s13, s13, 8192
    v_lshrrev_b32 v5, 3, v1
    v_and_b32 v6, 7, v1
    v_xor_b32 v6, v6, v5
    v_lshl_add_u32 v7, v2, 4, v5
    v_add_u32 v7, s6, v7
    v_subrev_u32 v7, 16, v7
    s_mov_b32 s11, 1024
    v_mul_lo_u32 v7, v7, s11
    v_lshl_add_u32 v36, v6, 4, v7
    v_add_u32 v37, 8192, v36
    v_and_b32 v7, 1, v2
    v_lshl_add_u32 v7, v7, 3, v5
    v_add_u32 v7, 48, v7
    v_add_u32 v7, s6, v7
    v_mul_lo_u32 v7, v7, s11
    v_lshl_add_u32 v38, v6, 4, v7
    v_mul_u32_u24 v5, 384, v2
    v_add_u32 v5, v5, v1
    s_mov_b32 s11, 3072
    v_add_u32 v6, 0, v5
    v_mul_u32_u24 v7, 2731, v6
    v_lshrrev_b32 v7, 16, v7
    v_mul_u32_u24 v8, 24, v7
    v_sub_u32 v8, v6, v8
    v_bfe_u32 v9, v7, 1, 1
    v_bfe_u32 v17, v7, 3, 1
    v_lshl_or_b32 v9, v17, 1, v9
    v_lshrrev_b32 v17, 1, v8
    v_xor_b32 v9, v9, v17
    v_and_b32 v8, 1, v8
    v_mul_lo_u32 v7, v7, s11
    v_lshl_add_u32 v7, v8, 4, v7
    v_lshrrev_b32 v17, 2, v9
    v_lshl_add_u32 v7, v17, 10, v7
    v_and_b32 v9, 3, v9
    v_lshl_add_u32 v7, v9, 5, v7
    v_add_u32 v40, s10, v7
    v_add_u32 v6, 64, v5
    v_mul_u32_u24 v7, 2731, v6
    v_lshrrev_b32 v7, 16, v7
    v_mul_u32_u24 v8, 24, v7
    v_sub_u32 v8, v6, v8
    v_bfe_u32 v9, v7, 1, 1
    v_bfe_u32 v17, v7, 3, 1
    v_lshl_or_b32 v9, v17, 1, v9
    v_lshrrev_b32 v17, 1, v8
    v_xor_b32 v9, v9, v17
    v_and_b32 v8, 1, v8
    v_mul_lo_u32 v7, v7, s11
    v_lshl_add_u32 v7, v8, 4, v7
    v_lshrrev_b32 v17, 2, v9
    v_lshl_add_u32 v7, v17, 10, v7
    v_and_b32 v9, 3, v9
    v_lshl_add_u32 v7, v9, 5, v7
    v_add_u32 v41, s10, v7
    v_add_u32 v6, 128, v5
    v_mul_u32_u24 v7, 2731, v6
    v_lshrrev_b32 v7, 16, v7
    v_mul_u32_u24 v8, 24, v7
    v_sub_u32 v8, v6, v8
    v_bfe_u32 v9, v7, 1, 1
    v_bfe_u32 v17, v7, 3, 1
    v_lshl_or_b32 v9, v17, 1, v9
    v_lshrrev_b32 v17, 1, v8
    v_xor_b32 v9, v9, v17
    v_and_b32 v8, 1, v8
    v_mul_lo_u32 v7, v7, s11
    v_lshl_add_u32 v7, v8, 4, v7
    v_lshrrev_b32 v17, 2, v9
    v_lshl_add_u32 v7, v17, 10, v7
    v_and_b32 v9, 3, v9
    v_lshl_add_u32 v7, v9, 5, v7
    v_add_u32 v42, s10, v7
    v_add_u32 v6, 192, v5
    v_mul_u32_u24 v7, 2731, v6
    v_lshrrev_b32 v7, 16, v7
    v_mul_u32_u24 v8, 24, v7
    v_sub_u32 v8, v6, v8
    v_bfe_u32 v9, v7, 1, 1
    v_bfe_u32 v17, v7, 3, 1
    v_lshl_or_b32 v9, v17, 1, v9
    v_lshrrev_b32 v17, 1, v8
    v_xor_b32 v9, v9, v17
    v_and_b32 v8, 1, v8
    v_mul_lo_u32 v7, v7, s11
    v_lshl_add_u32 v7, v8, 4, v7
    v_lshrrev_b32 v17, 2, v9
    v_lshl_add_u32 v7, v17, 10, v7
    v_and_b32 v9, 3, v9
    v_lshl_add_u32 v7, v9, 5, v7
    v_add_u32 v43, s10, v7
    v_add_u32 v6, 256, v5
    v_mul_u32_u24 v7, 2731, v6
    v_lshrrev_b32 v7, 16, v7
    v_mul_u32_u24 v8, 24, v7
    v_sub_u32 v8, v6, v8
    v_bfe_u32 v9, v7, 1, 1
    v_bfe_u32 v17, v7, 3, 1
    v_lshl_or_b32 v9, v17, 1, v9
    v_lshrrev_b32 v17, 1, v8
    v_xor_b32 v9, v9, v17
    v_and_b32 v8, 1, v8
    v_mul_lo_u32 v7, v7, s11
    v_lshl_add_u32 v7, v8, 4, v7
    v_lshrrev_b32 v17, 2, v9
    v_lshl_add_u32 v7, v17, 10, v7
    v_and_b32 v9, 3, v9
    v_lshl_add_u32 v7, v9, 5, v7
    v_add_u32 v44, s10, v7
    v_add_u32 v6, 320, v5
    v_mul_u32_u24 v7, 2731, v6
    v_lshrrev_b32 v7, 16, v7
    v_mul_u32_u24 v8, 24, v7
    v_sub_u32 v8, v6, v8
    v_bfe_u32 v9, v7, 1, 1
    v_bfe_u32 v17, v7, 3, 1
    v_lshl_or_b32 v9, v17, 1, v9
    v_lshrrev_b32 v17, 1, v8
    v_xor_b32 v9, v9, v17
    v_and_b32 v8, 1, v8
    v_mul_lo_u32 v7, v7, s11
    v_lshl_add_u32 v7, v8, 4, v7
    v_lshrrev_b32 v17, 2, v9
    v_lshl_add_u32 v7, v17, 10, v7
    v_and_b32 v9, 3, v9
    v_lshl_add_u32 v7, v9, 5, v7
    v_add_u32 v45, s10, v7
    s_waitcnt lgkmcnt(0)
    s_add_u32 s40, s36, 4194304
    s_addc_u32 s41, s37, 0
    s_mov_b32 s42, 2097152
    s_mov_b32 s43, 0x00020000
    s_mov_b32 s44, s18
    s_mov_b32 s45, s19
    s_mov_b32 s46, 1572864
    s_mov_b32 s47, 0x00020000
    s_mov_b32 s7, 0
    s_mov_b32 s8, 0
    s_add_u32 m0, s15, 0
    s_nop 0
    buffer_load_dwordx4 v40, s[44:47], s8 offen lds
    s_add_u32 m0, s15, 1024
    s_nop 0
    buffer_load_dwordx4 v41, s[44:47], s8 offen lds
    s_add_u32 m0, s15, 2048
    s_nop 0
    buffer_load_dwordx4 v42, s[44:47], s8 offen lds
    s_add_u32 m0, s15, 3072
    s_nop 0
    buffer_load_dwordx4 v43, s[44:47], s8 offen lds
    s_add_u32 m0, s15, 4096
    s_nop 0
    buffer_load_dwordx4 v44, s[44:47], s8 offen lds
    s_add_u32 m0, s15, 5120
    s_nop 0
    buffer_load_dwordx4 v45, s[44:47], s8 offen lds
    s_add_u32 m0, s14, 0
    s_nop 0
    buffer_load_dwordx4 v36, s[40:43], s7 offen lds
    s_add_u32 m0, s14, 1024
    s_nop 0
    buffer_load_dwordx4 v37, s[40:43], s7 offen lds
    s_add_u32 m0, s13, 0
    s_nop 0
    buffer_load_dwordx4 v38, s[40:43], s7 offen lds
    s_mov_b32 s7, 128
    s_mov_b32 s8, 196608
    s_add_u32 m0, s15, 34816
    s_nop 0
    buffer_load_dwordx4 v40, s[44:47], s8 offen lds
    s_add_u32 m0, s15, 35840
    s_nop 0
    buffer_load_dwordx4 v41, s[44:47], s8 offen lds
    s_add_u32 m0, s15, 36864
    s_nop 0
    buffer_load_dwordx4 v42, s[44:47], s8 offen lds
    s_add_u32 m0, s15, 37888
    s_nop 0
    buffer_load_dwordx4 v43, s[44:47], s8 offen lds
    s_add_u32 m0, s15, 38912
    s_nop 0
    buffer_load_dwordx4 v44, s[44:47], s8 offen lds
    s_add_u32 m0, s15, 39936
    s_nop 0
    buffer_load_dwordx4 v45, s[44:47], s8 offen lds
    s_add_u32 m0, s14, 34816
    s_nop 0
    buffer_load_dwordx4 v36, s[40:43], s7 offen lds
    s_add_u32 m0, s14, 35840
    s_nop 0
    buffer_load_dwordx4 v37, s[40:43], s7 offen lds
    s_add_u32 m0, s13, 34816
    s_nop 0
    buffer_load_dwordx4 v38, s[40:43], s7 offen lds
    s_waitcnt vmcnt(9)
    s_barrier
    s_mov_b32 s7, 256
    s_mov_b32 s8, 393216
    s_add_u32 m0, s15, 69632
    s_nop 0
    buffer_load_dwordx4 v40, s[44:47], s8 offen lds
    s_add_u32 m0, s15, 70656
    s_nop 0
    buffer_load_dwordx4 v41, s[44:47], s8 offen lds
    s_add_u32 m0, s15, 71680
    s_nop 0
    buffer_load_dwordx4 v42, s[44:47], s8 offen lds
    s_add_u32 m0, s15, 72704
    s_nop 0
    buffer_load_dwordx4 v43, s[44:47], s8 offen lds
    s_add_u32 m0, s15, 73728
    s_nop 0
    buffer_load_dwordx4 v44, s[44:47], s8 offen lds
    s_add_u32 m0, s15, 74752
    s_nop 0
    buffer_load_dwordx4 v45, s[44:47], s8 offen lds
    s_add_u32 m0, s14, 69632
    s_nop 0
    buffer_load_dwordx4 v36, s[40:43], s7 offen lds
    s_add_u32 m0, s14, 70656
    s_nop 0
    buffer_load_dwordx4 v37, s[40:43], s7 offen lds
    s_add_u32 m0, s13, 69632
    s_nop 0
    buffer_load_dwordx4 v38, s[40:43], s7 offen lds
    s_mov_b32 s7, 384
    s_mov_b32 s8, 589824
    s_add_u32 m0, s15, 104448
    s_nop 0
    buffer_load_dwordx4 v40, s[44:47], s8 offen lds
    s_add_u32 m0, s15, 105472
    s_nop 0
    buffer_load_dwordx4 v41, s[44:47], s8 offen lds
    s_add_u32 m0, s15, 106496
    s_nop 0
    buffer_load_dwordx4 v42, s[44:47], s8 offen lds
    s_add_u32 m0, s15, 107520
    s_nop 0
    buffer_load_dwordx4 v43, s[44:47], s8 offen lds
    s_add_u32 m0, s15, 108544
    s_nop 0
    buffer_load_dwordx4 v44, s[44:47], s8 offen lds
    s_add_u32 m0, s15, 109568
    s_nop 0
    buffer_load_dwordx4 v45, s[44:47], s8 offen lds
    s_add_u32 m0, s14, 104448
    s_nop 0
    buffer_load_dwordx4 v36, s[40:43], s7 offen lds
    s_add_u32 m0, s14, 105472
    s_nop 0
    buffer_load_dwordx4 v37, s[40:43], s7 offen lds
    s_add_u32 m0, s13, 104448
    s_nop 0
    buffer_load_dwordx4 v38, s[40:43], s7 offen lds
    s_waitcnt vmcnt(9)
    s_barrier
    s_mov_b32 s7, 512
    s_mov_b32 s8, 786432
    s_add_u32 m0, s15, 0
    s_nop 0
    buffer_load_dwordx4 v40, s[44:47], s8 offen lds
    s_add_u32 m0, s15, 1024
    s_nop 0
    buffer_load_dwordx4 v41, s[44:47], s8 offen lds
    s_add_u32 m0, s15, 2048
    s_nop 0
    buffer_load_dwordx4 v42, s[44:47], s8 offen lds
    s_add_u32 m0, s15, 3072
    s_nop 0
    buffer_load_dwordx4 v43, s[44:47], s8 offen lds
    s_add_u32 m0, s15, 4096
    s_nop 0
    buffer_load_dwordx4 v44, s[44:47], s8 offen lds
    s_add_u32 m0, s15, 5120
    s_nop 0
    buffer_load_dwordx4 v45, s[44:47], s8 offen lds
    s_add_u32 m0, s14, 0
    s_nop 0
    buffer_load_dwordx4 v36, s[40:43], s7 offen lds
    s_add_u32 m0, s14, 1024
    s_nop 0
    buffer_load_dwordx4 v37, s[40:43], s7 offen lds
    s_add_u32 m0, s13, 0
    s_nop 0
    buffer_load_dwordx4 v38, s[40:43], s7 offen lds
    s_waitcnt vmcnt(9)
    s_barrier
    s_mov_b32 s7, 640
    s_mov_b32 s8, 983040
    s_add_u32 m0, s15, 34816
    s_nop 0
    buffer_load_dwordx4 v40, s[44:47], s8 offen lds
    s_add_u32 m0, s15, 35840
    s_nop 0
    buffer_load_dwordx4 v41, s[44:47], s8 offen lds
    s_add_u32 m0, s15, 36864
    s_nop 0
    buffer_load_dwordx4 v42, s[44:47], s8 offen lds
    s_add_u32 m0, s15, 37888
    s_nop 0
    buffer_load_dwordx4 v43, s[44:47], s8 offen lds
    s_add_u32 m0, s15, 38912
    s_nop 0
    buffer_load_dwordx4 v44, s[44:47], s8 offen lds
    s_add_u32 m0, s15, 39936
    s_nop 0
    buffer_load_dwordx4 v45, s[44:47], s8 offen lds
    s_add_u32 m0, s14, 34816
    s_nop 0
    buffer_load_dwordx4 v36, s[40:43], s7 offen lds
    s_add_u32 m0, s14, 35840
    s_nop 0
    buffer_load_dwordx4 v37, s[40:43], s7 offen lds
    s_add_u32 m0, s13, 34816
    s_nop 0
    buffer_load_dwordx4 v38, s[40:43], s7 offen lds
    s_waitcnt vmcnt(9)
    s_barrier
    s_mov_b32 s7, 768
    s_mov_b32 s8, 1179648
    s_add_u32 m0, s15, 69632
    s_nop 0
    buffer_load_dwordx4 v40, s[44:47], s8 offen lds
    s_add_u32 m0, s15, 70656
    s_nop 0
    buffer_load_dwordx4 v41, s[44:47], s8 offen lds
    s_add_u32 m0, s15, 71680
    s_nop 0
    buffer_load_dwordx4 v42, s[44:47], s8 offen lds
    s_add_u32 m0, s15, 72704
    s_nop 0
    buffer_load_dwordx4 v43, s[44:47], s8 offen lds
    s_add_u32 m0, s15, 73728
    s_nop 0
    buffer_load_dwordx4 v44, s[44:47], s8 offen lds
    s_add_u32 m0, s15, 74752
    s_nop 0
    buffer_load_dwordx4 v45, s[44:47], s8 offen lds
    s_add_u32 m0, s14, 69632
    s_nop 0
    buffer_load_dwordx4 v36, s[40:43], s7 offen lds
    s_add_u32 m0, s14, 70656
    s_nop 0
    buffer_load_dwordx4 v37, s[40:43], s7 offen lds
    s_add_u32 m0, s13, 69632
    s_nop 0
    buffer_load_dwordx4 v38, s[40:43], s7 offen lds
    s_waitcnt vmcnt(9)
    s_barrier
    s_mov_b32 s7, 896
    s_mov_b32 s8, 1376256
    s_add_u32 m0, s15, 104448
    s_nop 0
    buffer_load_dwordx4 v40, s[44:47], s8 offen lds
    s_add_u32 m0, s15, 105472
    s_nop 0
    buffer_load_dwordx4 v41, s[44:47], s8 offen lds
    s_add_u32 m0, s15, 106496
    s_nop 0
    buffer_load_dwordx4 v42, s[44:47], s8 offen lds
    s_add_u32 m0, s15, 107520
    s_nop 0
    buffer_load_dwordx4 v43, s[44:47], s8 offen lds
    s_add_u32 m0, s15, 108544
    s_nop 0
    buffer_load_dwordx4 v44, s[44:47], s8 offen lds
    s_add_u32 m0, s15, 109568
    s_nop 0
    buffer_load_dwordx4 v45, s[44:47], s8 offen lds
    s_add_u32 m0, s14, 104448
    s_nop 0
    buffer_load_dwordx4 v36, s[40:43], s7 offen lds
    s_add_u32 m0, s14, 105472
    s_nop 0
    buffer_load_dwordx4 v37, s[40:43], s7 offen lds
    s_add_u32 m0, s13, 104448
    s_nop 0
    buffer_load_dwordx4 v38, s[40:43], s7 offen lds
    s_waitcnt vmcnt(9)
    s_barrier
    s_waitcnt vmcnt(0)
    s_barrier
    s_waitcnt vmcnt(0)
    s_barrier
    s_endpgm
L_comp_g1a1_kernel:
    s_waitcnt lgkmcnt(0)
    s_mov_b32 s52, s36
    s_mov_b32 s53, s37
    s_mov_b32 s54, 2097152
    s_mov_b32 s55, 0x00020000
    v_add_u32 v7, 0, v4
    v_and_b32 v17, 7, v3
    v_xor_b32 v7, v7, v17
    v_lshlrev_b32 v7, 4, v7
    v_lshl_add_u32 v14, v3, 7, v7
    v_add_u32 v7, 4, v4
    v_and_b32 v17, 7, v3
    v_xor_b32 v7, v7, v17
    v_lshlrev_b32 v7, 4, v7
    v_lshl_add_u32 v15, v3, 7, v7
    v_mov_b32 v9, v2
    v_lshrrev_b32 v5, 2, v3
    v_lshl_add_u32 v5, v4, 3, v5
    v_bfe_u32 v6, v5, 1, 1
    v_bfe_u32 v7, v5, 3, 1
    v_lshl_or_b32 v6, v7, 1, v6
    v_xor_b32 v6, v6, v9
    v_mul_u32_u24 v5, 384, v5
    v_lshl_add_u32 v5, v6, 5, v5
    v_and_b32 v6, 3, v3
    v_lshl_add_u32 v5, v6, 3, v5
    v_add_u32 v16, 10240, v5
    v_add_u32 v212, 34816, v14
    v_add_u32 v213, 34816, v15
    v_add_u32 v214, 34816, v16
    v_add_u32 v217, 69632, v14
    v_add_u32 v218, 69632, v15
    v_add_u32 v219, 69632, v16
    v_add_u32 v222, 104448, v14
    v_add_u32 v223, 104448, v15
    v_add_u32 v224, 104448, v16
    v_mov_b32 v120, 0
    v_mov_b32 v121, 0
    v_mov_b32 v122, 0
    v_mov_b32 v123, 0
    v_mov_b32 v124, 0
    v_mov_b32 v125, 0
    v_mov_b32 v126, 0
    v_mov_b32 v127, 0
    v_mov_b32 v128, 0
    v_mov_b32 v129, 0
    v_mov_b32 v130, 0
    v_mov_b32 v131, 0
    v_mov_b32 v132, 0
    v_mov_b32 v133, 0
    v_mov_b32 v134, 0
    v_mov_b32 v135, 0
    v_mov_b32 v136, 0
    v_mov_b32 v137, 0
    v_mov_b32 v138, 0
    v_mov_b32 v139, 0
    v_mov_b32 v140, 0
    v_mov_b32 v141, 0
    v_mov_b32 v142, 0
    v_mov_b32 v143, 0
    v_mov_b32 v144, 0
    v_mov_b32 v145, 0
    v_mov_b32 v146, 0
    v_mov_b32 v147, 0
    v_mov_b32 v148, 0
    v_mov_b32 v149, 0
    v_mov_b32 v150, 0
    v_mov_b32 v151, 0
    v_mov_b32 v152, 0
    v_mov_b32 v153, 0
    v_mov_b32 v154, 0
    v_mov_b32 v155, 0
    v_mov_b32 v156, 0
    v_mov_b32 v157, 0
    v_mov_b32 v158, 0
    v_mov_b32 v159, 0
    v_mov_b32 v160, 0
    v_mov_b32 v161, 0
    v_mov_b32 v162, 0
    v_mov_b32 v163, 0
    v_mov_b32 v164, 0
    v_mov_b32 v165, 0
    v_mov_b32 v166, 0
    v_mov_b32 v167, 0
    v_mov_b32 v168, 0
    v_mov_b32 v169, 0
    v_mov_b32 v170, 0
    v_mov_b32 v171, 0
    v_mov_b32 v172, 0
    v_mov_b32 v173, 0
    v_mov_b32 v174, 0
    v_mov_b32 v175, 0
    v_mov_b32 v176, 0
    v_mov_b32 v177, 0
    v_mov_b32 v178, 0
    v_mov_b32 v179, 0
    v_mov_b32 v180, 0
    v_mov_b32 v181, 0
    v_mov_b32 v182, 0
    v_mov_b32 v183, 0
    v_mov_b32 v184, 0
    v_mov_b32 v185, 0
    v_mov_b32 v186, 0
    v_mov_b32 v187, 0
    v_mov_b32 v188, s9
    v_mov_b32 v189, s9
    v_mov_b32 v190, s9
    v_mov_b32 v191, s9
    v_mov_b32 v32, 0
    v_mov_b32 v33, 0
    v_mov_b32 v34, 0
    v_mov_b32 v35, 0
    v_mov_b32 v36, 0
    v_mov_b32 v37, 0
    v_mov_b32 v38, 0
    v_mov_b32 v39, 0
    v_mov_b32 v40, 0
    v_mov_b32 v41, 0
    v_mov_b32 v42, 0
    v_mov_b32 v43, 0
    v_mov_b32 v44, 0
    v_mov_b32 v45, 0
    v_mov_b32 v46, 0
    v_mov_b32 v47, 0
    v_lshlrev_b32 v30, 11, v2
    s_barrier
    ds_read_b64_tr_b16 v[76:77], v16 offset:0
    ds_read_b64_tr_b16 v[78:79], v16 offset:1536
    ds_read_b64_tr_b16 v[80:81], v16 offset:128
    ds_read_b64_tr_b16 v[82:83], v16 offset:1664
    ds_read_b64_tr_b16 v[84:85], v16 offset:256
    ds_read_b64_tr_b16 v[86:87], v16 offset:1792
    ds_read_b128 v[56:59], v14 offset:0
    ds_read_b128 v[60:63], v14 offset:2048
    ds_read_b128 v[64:67], v14 offset:4096
    ds_read_b128 v[68:71], v14 offset:6144
    ds_read_b128 v[72:75], v14 offset:8192
    v_add_u32 v31, v30, v14
    ds_read_b128 v[196:199], v31
    s_waitcnt lgkmcnt(0)
    v_mfma_f32_16x16x32_bf16 v[176:179], v[76:79], v[188:191], v[176:179]
    ds_read_b64_tr_b16 v[108:109], v16 offset:12288
    ds_read_b64_tr_b16 v[110:111], v16 offset:13824
    v_mfma_f32_16x16x32_bf16 v[180:183], v[80:83], v[188:191], v[180:183]
    ds_read_b64_tr_b16 v[112:113], v16 offset:12416
    ds_read_b64_tr_b16 v[114:115], v16 offset:13952
    v_mfma_f32_16x16x32_bf16 v[184:187], v[188:191], v[84:87], v[184:187]
    ds_read_b64_tr_b16 v[116:117], v16 offset:12544
    ds_read_b64_tr_b16 v[118:119], v16 offset:14080
    v_mfma_f32_16x16x32_bf16 v[136:139], v[80:83], v[56:59], v[136:139]
    ds_read_b128 v[88:91], v15 offset:0
    ds_read_b128 v[92:95], v15 offset:2048
    v_mfma_f32_16x16x32_bf16 v[156:159], v[56:59], v[84:87], v[156:159]
    ds_read_b128 v[96:99], v15 offset:4096
    ds_read_b128 v[100:103], v15 offset:6144
    v_mfma_f32_16x16x32_bf16 v[120:123], v[76:79], v[60:63], v[120:123]
    ds_read_b128 v[104:107], v15 offset:8192
    v_add_u32 v31, v30, v15
    v_mfma_f32_16x16x32_bf16 v[140:143], v[80:83], v[60:63], v[140:143]
    ds_read_b128 v[200:203], v31
    v_mfma_f32_16x16x32_bf16 v[160:163], v[60:63], v[84:87], v[160:163]
    v_mfma_f32_16x16x32_bf16 v[124:127], v[76:79], v[64:67], v[124:127]
    v_mfma_f32_16x16x32_bf16 v[144:147], v[80:83], v[64:67], v[144:147]
    v_mfma_f32_16x16x32_bf16 v[164:167], v[64:67], v[84:87], v[164:167]
    v_mfma_f32_16x16x32_bf16 v[128:131], v[76:79], v[68:71], v[128:131]
    v_mfma_f32_16x16x32_bf16 v[148:151], v[80:83], v[68:71], v[148:151]
    v_mfma_f32_16x16x32_bf16 v[168:171], v[68:71], v[84:87], v[168:171]
    v_mfma_f32_16x16x32_bf16 v[132:135], v[76:79], v[72:75], v[132:135]
    v_mfma_f32_16x16x32_bf16 v[152:155], v[80:83], v[72:75], v[152:155]
    v_mfma_f32_16x16x32_bf16 v[172:175], v[72:75], v[84:87], v[172:175]
    v_mfma_f32_16x16x32_bf16 v[32:35], v[188:191], v[196:199], v[32:35]
    v_mfma_f32_16x16x32_bf16 v[36:39], v[196:199], v[196:199], v[36:39]
    v_mfma_f32_16x16x32_bf16 v[40:43], v[188:191], v[72:75], v[40:43]
    v_mfma_f32_16x16x32_bf16 v[44:47], v[72:75], v[72:75], v[44:47]
    s_waitcnt lgkmcnt(0)
    v_mfma_f32_16x16x32_bf16 v[176:179], v[108:111], v[188:191], v[176:179]
    v_mfma_f32_16x16x32_bf16 v[180:183], v[112:115], v[188:191], v[180:183]
    v_mfma_f32_16x16x32_bf16 v[184:187], v[188:191], v[116:119], v[184:187]
    v_mfma_f32_16x16x32_bf16 v[136:139], v[112:115], v[88:91], v[136:139]
    v_mfma_f32_16x16x32_bf16 v[156:159], v[88:91], v[116:119], v[156:159]
    v_mfma_f32_16x16x32_bf16 v[120:123], v[108:111], v[92:95], v[120:123]
    v_mfma_f32_16x16x32_bf16 v[140:143], v[112:115], v[92:95], v[140:143]
    v_mfma_f32_16x16x32_bf16 v[160:163], v[92:95], v[116:119], v[160:163]
    v_mfma_f32_16x16x32_bf16 v[124:127], v[108:111], v[96:99], v[124:127]
    v_mfma_f32_16x16x32_bf16 v[144:147], v[112:115], v[96:99], v[144:147]
    v_mfma_f32_16x16x32_bf16 v[164:167], v[96:99], v[116:119], v[164:167]
    v_mfma_f32_16x16x32_bf16 v[128:131], v[108:111], v[100:103], v[128:131]
    v_mfma_f32_16x16x32_bf16 v[148:151], v[112:115], v[100:103], v[148:151]
    v_mfma_f32_16x16x32_bf16 v[168:171], v[100:103], v[116:119], v[168:171]
    v_mfma_f32_16x16x32_bf16 v[132:135], v[108:111], v[104:107], v[132:135]
    v_mfma_f32_16x16x32_bf16 v[152:155], v[112:115], v[104:107], v[152:155]
    v_mfma_f32_16x16x32_bf16 v[172:175], v[104:107], v[116:119], v[172:175]
    v_mfma_f32_16x16x32_bf16 v[32:35], v[188:191], v[200:203], v[32:35]
    v_mfma_f32_16x16x32_bf16 v[36:39], v[200:203], v[200:203], v[36:39]
    v_mfma_f32_16x16x32_bf16 v[40:43], v[188:191], v[104:107], v[40:43]
    v_mfma_f32_16x16x32_bf16 v[44:47], v[104:107], v[104:107], v[44:47]
    s_barrier
    ds_read_b64_tr_b16 v[76:77], v214 offset:0
    ds_read_b64_tr_b16 v[78:79], v214 offset:1536
    ds_read_b64_tr_b16 v[80:81], v214 offset:128
    ds_read_b64_tr_b16 v[82:83], v214 offset:1664
    ds_read_b64_tr_b16 v[84:85], v214 offset:256
    ds_read_b64_tr_b16 v[86:87], v214 offset:1792
    ds_read_b128 v[56:59], v212 offset:0
    ds_read_b128 v[60:63], v212 offset:2048
    ds_read_b128 v[64:67], v212 offset:4096
    ds_read_b128 v[68:71], v212 offset:6144
    ds_read_b128 v[72:75], v212 offset:8192
    v_add_u32 v31, v30, v212
    ds_read_b128 v[196:199], v31
    s_waitcnt lgkmcnt(0)
    v_mfma_f32_16x16x32_bf16 v[176:179], v[76:79], v[188:191], v[176:179]
    ds_read_b64_tr_b16 v[108:109], v214 offset:12288
    ds_read_b64_tr_b16 v[110:111], v214 offset:13824
    v_mfma_f32_16x16x32_bf16 v[180:183], v[80:83], v[188:191], v[180:183]
    ds_read_b64_tr_b16 v[112:113], v214 offset:12416
    ds_read_b64_tr_b16 v[114:115], v214 offset:13952
    v_mfma_f32_16x16x32_bf16 v[184:187], v[188:191], v[84:87], v[184:187]
    ds_read_b64_tr_b16 v[116:117], v214 offset:12544
    ds_read_b64_tr_b16 v[118:119], v214 offset:14080
    v_mfma_f32_16x16x32_bf16 v[136:139], v[80:83], v[56:59], v[136:139]
    ds_read_b128 v[88:91], v213 offset:0
    ds_read_b128 v[92:95], v213 offset:2048
    v_mfma_f32_16x16x32_bf16 v[156:159], v[56:59], v[84:87], v[156:159]
    ds_read_b128 v[96:99], v213 offset:4096
    ds_read_b128 v[100:103], v213 offset:6144
    v_mfma_f32_16x16x32_bf16 v[120:123], v[76:79], v[60:63], v[120:123]
    ds_read_b128 v[104:107], v213 offset:8192
    v_add_u32 v31, v30, v213
    v_mfma_f32_16x16x32_bf16 v[140:143], v[80:83], v[60:63], v[140:143]
    ds_read_b128 v[200:203], v31
    v_mfma_f32_16x16x32_bf16 v[160:163], v[60:63], v[84:87], v[160:163]
    v_mfma_f32_16x16x32_bf16 v[124:127], v[76:79], v[64:67], v[124:127]
    v_mfma_f32_16x16x32_bf16 v[144:147], v[80:83], v[64:67], v[144:147]
    v_mfma_f32_16x16x32_bf16 v[164:167], v[64:67], v[84:87], v[164:167]
    v_mfma_f32_16x16x32_bf16 v[128:131], v[76:79], v[68:71], v[128:131]
    v_mfma_f32_16x16x32_bf16 v[148:151], v[80:83], v[68:71], v[148:151]
    v_mfma_f32_16x16x32_bf16 v[168:171], v[68:71], v[84:87], v[168:171]
    v_mfma_f32_16x16x32_bf16 v[132:135], v[76:79], v[72:75], v[132:135]
    v_mfma_f32_16x16x32_bf16 v[152:155], v[80:83], v[72:75], v[152:155]
    v_mfma_f32_16x16x32_bf16 v[172:175], v[72:75], v[84:87], v[172:175]
    v_mfma_f32_16x16x32_bf16 v[32:35], v[188:191], v[196:199], v[32:35]
    v_mfma_f32_16x16x32_bf16 v[36:39], v[196:199], v[196:199], v[36:39]
    v_mfma_f32_16x16x32_bf16 v[40:43], v[188:191], v[72:75], v[40:43]
    v_mfma_f32_16x16x32_bf16 v[44:47], v[72:75], v[72:75], v[44:47]
    s_waitcnt lgkmcnt(0)
    v_mfma_f32_16x16x32_bf16 v[176:179], v[108:111], v[188:191], v[176:179]
    ds_read_b64_tr_b16 v[76:77], v219 offset:0
    ds_read_b64_tr_b16 v[78:79], v219 offset:1536
    v_mfma_f32_16x16x32_bf16 v[180:183], v[112:115], v[188:191], v[180:183]
    ds_read_b64_tr_b16 v[80:81], v219 offset:128
    ds_read_b64_tr_b16 v[82:83], v219 offset:1664
    v_mfma_f32_16x16x32_bf16 v[184:187], v[188:191], v[116:119], v[184:187]
    ds_read_b64_tr_b16 v[84:85], v219 offset:256
    ds_read_b64_tr_b16 v[86:87], v219 offset:1792
    v_mfma_f32_16x16x32_bf16 v[136:139], v[112:115], v[88:91], v[136:139]
    ds_read_b128 v[56:59], v217 offset:0
    ds_read_b128 v[60:63], v217 offset:2048
    v_mfma_f32_16x16x32_bf16 v[156:159], v[88:91], v[116:119], v[156:159]
    ds_read_b128 v[64:67], v217 offset:4096
    ds_read_b128 v[68:71], v217 offset:6144
    v_mfma_f32_16x16x32_bf16 v[120:123], v[108:111], v[92:95], v[120:123]
    ds_read_b128 v[72:75], v217 offset:8192
    v_add_u32 v31, v30, v217
    v_mfma_f32_16x16x32_bf16 v[140:143], v[112:115], v[92:95], v[140:143]
    ds_read_b128 v[196:199], v31
    v_mfma_f32_16x16x32_bf16 v[160:163], v[92:95], v[116:119], v[160:163]
    v_mfma_f32_16x16x32_bf16 v[124:127], v[108:111], v[96:99], v[124:127]
    v_mfma_f32_16x16x32_bf16 v[144:147], v[112:115], v[96:99], v[144:147]
    v_mfma_f32_16x16x32_bf16 v[164:167], v[96:99], v[116:119], v[164:167]
    v_mfma_f32_16x16x32_bf16 v[128:131], v[108:111], v[100:103], v[128:131]
    v_mfma_f32_16x16x32_bf16 v[148:151], v[112:115], v[100:103], v[148:151]
    v_mfma_f32_16x16x32_bf16 v[168:171], v[100:103], v[116:119], v[168:171]
    v_mfma_f32_16x16x32_bf16 v[132:135], v[108:111], v[104:107], v[132:135]
    v_mfma_f32_16x16x32_bf16 v[152:155], v[112:115], v[104:107], v[152:155]
    v_mfma_f32_16x16x32_bf16 v[172:175], v[104:107], v[116:119], v[172:175]
    v_mfma_f32_16x16x32_bf16 v[32:35], v[188:191], v[200:203], v[32:35]
    v_mfma_f32_16x16x32_bf16 v[36:39], v[200:203], v[200:203], v[36:39]
    v_mfma_f32_16x16x32_bf16 v[40:43], v[188:191], v[104:107], v[40:43]
    v_mfma_f32_16x16x32_bf16 v[44:47], v[104:107], v[104:107], v[44:47]
    s_barrier
    s_waitcnt lgkmcnt(0)
    v_mfma_f32_16x16x32_bf16 v[176:179], v[76:79], v[188:191], v[176:179]
    ds_read_b64_tr_b16 v[108:109], v219 offset:12288
    ds_read_b64_tr_b16 v[110:111], v219 offset:13824
    v_mfma_f32_16x16x32_bf16 v[180:183], v[80:83], v[188:191], v[180:183]
    ds_read_b64_tr_b16 v[112:113], v219 offset:12416
    ds_read_b64_tr_b16 v[114:115], v219 offset:13952
    v_mfma_f32_16x16x32_bf16 v[184:187], v[188:191], v[84:87], v[184:187]
    ds_read_b64_tr_b16 v[116:117], v219 offset:12544
    ds_read_b64_tr_b16 v[118:119], v219 offset:14080
    v_mfma_f32_16x16x32_bf16 v[136:139], v[80:83], v[56:59], v[136:139]
    ds_read_b128 v[88:91], v218 offset:0
    ds_read_b128 v[92:95], v218 offset:2048
    v_mfma_f32_16x16x32_bf16 v[156:159], v[56:59], v[84:87], v[156:159]
    ds_read_b128 v[96:99], v218 offset:4096
    ds_read_b128 v[100:103], v218 offset:6144
    v_mfma_f32_16x16x32_bf16 v[120:123], v[76:79], v[60:63], v[120:123]
    ds_read_b128 v[104:107], v218 offset:8192
    v_add_u32 v31, v30, v218
    v_mfma_f32_16x16x32_bf16 v[140:143], v[80:83], v[60:63], v[140:143]
    ds_read_b128 v[200:203], v31
    v_mfma_f32_16x16x32_bf16 v[160:163], v[60:63], v[84:87], v[160:163]
    v_mfma_f32_16x16x32_bf16 v[124:127], v[76:79], v[64:67], v[124:127]
    v_mfma_f32_16x16x32_bf16 v[144:147], v[80:83], v[64:67], v[144:147]
    v_mfma_f32_16x16x32_bf16 v[164:167], v[64:67], v[84:87], v[164:167]
    v_mfma_f32_16x16x32_bf16 v[128:131], v[76:79], v[68:71], v[128:131]
    v_mfma_f32_16x16x32_bf16 v[148:151], v[80:83], v[68:71], v[148:151]
    v_mfma_f32_16x16x32_bf16 v[168:171], v[68:71], v[84:87], v[168:171]
    v_mfma_f32_16x16x32_bf16 v[132:135], v[76:79], v[72:75], v[132:135]
    v_mfma_f32_16x16x32_bf16 v[152:155], v[80:83], v[72:75], v[152:155]
    v_mfma_f32_16x16x32_bf16 v[172:175], v[72:75], v[84:87], v[172:175]
    v_mfma_f32_16x16x32_bf16 v[32:35], v[188:191], v[196:199], v[32:35]
    v_mfma_f32_16x16x32_bf16 v[36:39], v[196:199], v[196:199], v[36:39]
    v_mfma_f32_16x16x32_bf16 v[40:43], v[188:191], v[72:75], v[40:43]
    v_mfma_f32_16x16x32_bf16 v[44:47], v[72:75], v[72:75], v[44:47]
    s_waitcnt lgkmcnt(0)
    v_mfma_f32_16x16x32_bf16 v[176:179], v[108:111], v[188:191], v[176:179]
    ds_read_b64_tr_b16 v[76:77], v224 offset:0
    ds_read_b64_tr_b16 v[78:79], v224 offset:1536
    v_mfma_f32_16x16x32_bf16 v[180:183], v[112:115], v[188:191], v[180:183]
    ds_read_b64_tr_b16 v[80:81], v224 offset:128
    ds_read_b64_tr_b16 v[82:83], v224 offset:1664
    v_mfma_f32_16x16x32_bf16 v[184:187], v[188:191], v[116:119], v[184:187]
    ds_read_b64_tr_b16 v[84:85], v224 offset:256
    ds_read_b64_tr_b16 v[86:87], v224 offset:1792
    v_mfma_f32_16x16x32_bf16 v[136:139], v[112:115], v[88:91], v[136:139]
    ds_read_b128 v[56:59], v222 offset:0
    ds_read_b128 v[60:63], v222 offset:2048
    v_mfma_f32_16x16x32_bf16 v[156:159], v[88:91], v[116:119], v[156:159]
    ds_read_b128 v[64:67], v222 offset:4096
    ds_read_b128 v[68:71], v222 offset:6144
    v_mfma_f32_16x16x32_bf16 v[120:123], v[108:111], v[92:95], v[120:123]
    ds_read_b128 v[72:75], v222 offset:8192
    v_add_u32 v31, v30, v222
    v_mfma_f32_16x16x32_bf16 v[140:143], v[112:115], v[92:95], v[140:143]
    ds_read_b128 v[196:199], v31
    v_mfma_f32_16x16x32_bf16 v[160:163], v[92:95], v[116:119], v[160:163]
    v_mfma_f32_16x16x32_bf16 v[124:127], v[108:111], v[96:99], v[124:127]
    v_mfma_f32_16x16x32_bf16 v[144:147], v[112:115], v[96:99], v[144:147]
    v_mfma_f32_16x16x32_bf16 v[164:167], v[96:99], v[116:119], v[164:167]
    v_mfma_f32_16x16x32_bf16 v[128:131], v[108:111], v[100:103], v[128:131]
    v_mfma_f32_16x16x32_bf16 v[148:151], v[112:115], v[100:103], v[148:151]
    v_mfma_f32_16x16x32_bf16 v[168:171], v[100:103], v[116:119], v[168:171]
    v_mfma_f32_16x16x32_bf16 v[132:135], v[108:111], v[104:107], v[132:135]
    v_mfma_f32_16x16x32_bf16 v[152:155], v[112:115], v[104:107], v[152:155]
    v_mfma_f32_16x16x32_bf16 v[172:175], v[104:107], v[116:119], v[172:175]
    v_mfma_f32_16x16x32_bf16 v[32:35], v[188:191], v[200:203], v[32:35]
    v_mfma_f32_16x16x32_bf16 v[36:39], v[200:203], v[200:203], v[36:39]
    v_mfma_f32_16x16x32_bf16 v[40:43], v[188:191], v[104:107], v[40:43]
    v_mfma_f32_16x16x32_bf16 v[44:47], v[104:107], v[104:107], v[44:47]
    s_barrier
    s_waitcnt lgkmcnt(0)
    v_mfma_f32_16x16x32_bf16 v[176:179], v[76:79], v[188:191], v[176:179]
    ds_read_b64_tr_b16 v[108:109], v224 offset:12288
    ds_read_b64_tr_b16 v[110:111], v224 offset:13824
    v_mfma_f32_16x16x32_bf16 v[180:183], v[80:83], v[188:191], v[180:183]
    ds_read_b64_tr_b16 v[112:113], v224 offset:12416
    ds_read_b64_tr_b16 v[114:115], v224 offset:13952
    v_mfma_f32_16x16x32_bf16 v[184:187], v[188:191], v[84:87], v[184:187]
    ds_read_b64_tr_b16 v[116:117], v224 offset:12544
    ds_read_b64_tr_b16 v[118:119], v224 offset:14080
    v_mfma_f32_16x16x32_bf16 v[136:139], v[80:83], v[56:59], v[136:139]
    ds_read_b128 v[88:91], v223 offset:0
    ds_read_b128 v[92:95], v223 offset:2048
    v_mfma_f32_16x16x32_bf16 v[156:159], v[56:59], v[84:87], v[156:159]
    ds_read_b128 v[96:99], v223 offset:4096
    ds_read_b128 v[100:103], v223 offset:6144
    v_mfma_f32_16x16x32_bf16 v[120:123], v[76:79], v[60:63], v[120:123]
    ds_read_b128 v[104:107], v223 offset:8192
    v_add_u32 v31, v30, v223
    v_mfma_f32_16x16x32_bf16 v[140:143], v[80:83], v[60:63], v[140:143]
    ds_read_b128 v[200:203], v31
    v_mfma_f32_16x16x32_bf16 v[160:163], v[60:63], v[84:87], v[160:163]
    v_mfma_f32_16x16x32_bf16 v[124:127], v[76:79], v[64:67], v[124:127]
    v_mfma_f32_16x16x32_bf16 v[144:147], v[80:83], v[64:67], v[144:147]
    v_mfma_f32_16x16x32_bf16 v[164:167], v[64:67], v[84:87], v[164:167]
    v_mfma_f32_16x16x32_bf16 v[128:131], v[76:79], v[68:71], v[128:131]
    v_mfma_f32_16x16x32_bf16 v[148:151], v[80:83], v[68:71], v[148:151]
    v_mfma_f32_16x16x32_bf16 v[168:171], v[68:71], v[84:87], v[168:171]
    v_mfma_f32_16x16x32_bf16 v[132:135], v[76:79], v[72:75], v[132:135]
    v_mfma_f32_16x16x32_bf16 v[152:155], v[80:83], v[72:75], v[152:155]
    v_mfma_f32_16x16x32_bf16 v[172:175], v[72:75], v[84:87], v[172:175]
    v_mfma_f32_16x16x32_bf16 v[32:35], v[188:191], v[196:199], v[32:35]
    v_mfma_f32_16x16x32_bf16 v[36:39], v[196:199], v[196:199], v[36:39]
    v_mfma_f32_16x16x32_bf16 v[40:43], v[188:191], v[72:75], v[40:43]
    v_mfma_f32_16x16x32_bf16 v[44:47], v[72:75], v[72:75], v[44:47]
    s_waitcnt lgkmcnt(0)
    v_mfma_f32_16x16x32_bf16 v[176:179], v[108:111], v[188:191], v[176:179]
    ds_read_b64_tr_b16 v[76:77], v16 offset:0
    ds_read_b64_tr_b16 v[78:79], v16 offset:1536
    v_mfma_f32_16x16x32_bf16 v[180:183], v[112:115], v[188:191], v[180:183]
    ds_read_b64_tr_b16 v[80:81], v16 offset:128
    ds_read_b64_tr_b16 v[82:83], v16 offset:1664
    v_mfma_f32_16x16x32_bf16 v[184:187], v[188:191], v[116:119], v[184:187]
    ds_read_b64_tr_b16 v[84:85], v16 offset:256
    ds_read_b64_tr_b16 v[86:87], v16 offset:1792
    v_mfma_f32_16x16x32_bf16 v[136:139], v[112:115], v[88:91], v[136:139]
    ds_read_b128 v[56:59], v14 offset:0
    ds_read_b128 v[60:63], v14 offset:2048
    v_mfma_f32_16x16x32_bf16 v[156:159], v[88:91], v[116:119], v[156:159]
    ds_read_b128 v[64:67], v14 offset:4096
    ds_read_b128 v[68:71], v14 offset:6144
    v_mfma_f32_16x16x32_bf16 v[120:123], v[108:111], v[92:95], v[120:123]
    ds_read_b128 v[72:75], v14 offset:8192
    v_add_u32 v31, v30, v14
    v_mfma_f32_16x16x32_bf16 v[140:143], v[112:115], v[92:95], v[140:143]
    ds_read_b128 v[196:199], v31
    v_mfma_f32_16x16x32_bf16 v[160:163], v[92:95], v[116:119], v[160:163]
    v_mfma_f32_16x16x32_bf16 v[124:127], v[108:111], v[96:99], v[124:127]
    v_mfma_f32_16x16x32_bf16 v[144:147], v[112:115], v[96:99], v[144:147]
    v_mfma_f32_16x16x32_bf16 v[164:167], v[96:99], v[116:119], v[164:167]
    v_mfma_f32_16x16x32_bf16 v[128:131], v[108:111], v[100:103], v[128:131]
    v_mfma_f32_16x16x32_bf16 v[148:151], v[112:115], v[100:103], v[148:151]
    v_mfma_f32_16x16x32_bf16 v[168:171], v[100:103], v[116:119], v[168:171]
    v_mfma_f32_16x16x32_bf16 v[132:135], v[108:111], v[104:107], v[132:135]
    v_mfma_f32_16x16x32_bf16 v[152:155], v[112:115], v[104:107], v[152:155]
    v_mfma_f32_16x16x32_bf16 v[172:175], v[104:107], v[116:119], v[172:175]
    v_mfma_f32_16x16x32_bf16 v[32:35], v[188:191], v[200:203], v[32:35]
    v_mfma_f32_16x16x32_bf16 v[36:39], v[200:203], v[200:203], v[36:39]
    v_mfma_f32_16x16x32_bf16 v[40:43], v[188:191], v[104:107], v[40:43]
    v_mfma_f32_16x16x32_bf16 v[44:47], v[104:107], v[104:107], v[44:47]
    s_barrier
    s_waitcnt lgkmcnt(0)
    v_mfma_f32_16x16x32_bf16 v[176:179], v[76:79], v[188:191], v[176:179]
    ds_read_b64_tr_b16 v[108:109], v16 offset:12288
    ds_read_b64_tr_b16 v[110:111], v16 offset:13824
    v_mfma_f32_16x16x32_bf16 v[180:183], v[80:83], v[188:191], v[180:183]
    ds_read_b64_tr_b16 v[112:113], v16 offset:12416
    ds_read_b64_tr_b16 v[114:115], v16 offset:13952
    v_mfma_f32_16x16x32_bf16 v[184:187], v[188:191], v[84:87], v[184:187]
    ds_read_b64_tr_b16 v[116:117], v16 offset:12544
    ds_read_b64_tr_b16 v[118:119], v16 offset:14080
    v_mfma_f32_16x16x32_bf16 v[136:139], v[80:83], v[56:59], v[136:139]
    ds_read_b128 v[88:91], v15 offset:0
    ds_read_b128 v[92:95], v15 offset:2048
    v_mfma_f32_16x16x32_bf16 v[156:159], v[56:59], v[84:87], v[156:159]
    ds_read_b128 v[96:99], v15 offset:4096
    ds_read_b128 v[100:103], v15 offset:6144
    v_mfma_f32_16x16x32_bf16 v[120:123], v[76:79], v[60:63], v[120:123]
    ds_read_b128 v[104:107], v15 offset:8192
    v_add_u32 v31, v30, v15
    v_mfma_f32_16x16x32_bf16 v[140:143], v[80:83], v[60:63], v[140:143]
    ds_read_b128 v[200:203], v31
    v_mfma_f32_16x16x32_bf16 v[160:163], v[60:63], v[84:87], v[160:163]
    v_mfma_f32_16x16x32_bf16 v[124:127], v[76:79], v[64:67], v[124:127]
    v_mfma_f32_16x16x32_bf16 v[144:147], v[80:83], v[64:67], v[144:147]
    v_mfma_f32_16x16x32_bf16 v[164:167], v[64:67], v[84:87], v[164:167]
    v_mfma_f32_16x16x32_bf16 v[128:131], v[76:79], v[68:71], v[128:131]
    v_mfma_f32_16x16x32_bf16 v[148:151], v[80:83], v[68:71], v[148:151]
    v_mfma_f32_16x16x32_bf16 v[168:171], v[68:71], v[84:87], v[168:171]
    v_mfma_f32_16x16x32_bf16 v[132:135], v[76:79], v[72:75], v[132:135]
    v_mfma_f32_16x16x32_bf16 v[152:155], v[80:83], v[72:75], v[152:155]
    v_mfma_f32_16x16x32_bf16 v[172:175], v[72:75], v[84:87], v[172:175]
    v_mfma_f32_16x16x32_bf16 v[32:35], v[188:191], v[196:199], v[32:35]
    v_mfma_f32_16x16x32_bf16 v[36:39], v[196:199], v[196:199], v[36:39]
    v_mfma_f32_16x16x32_bf16 v[40:43], v[188:191], v[72:75], v[40:43]
    v_mfma_f32_16x16x32_bf16 v[44:47], v[72:75], v[72:75], v[44:47]
    s_waitcnt lgkmcnt(0)
    v_mfma_f32_16x16x32_bf16 v[176:179], v[108:111], v[188:191], v[176:179]
    ds_read_b64_tr_b16 v[76:77], v214 offset:0
    ds_read_b64_tr_b16 v[78:79], v214 offset:1536
    v_mfma_f32_16x16x32_bf16 v[180:183], v[112:115], v[188:191], v[180:183]
    ds_read_b64_tr_b16 v[80:81], v214 offset:128
    ds_read_b64_tr_b16 v[82:83], v214 offset:1664
    v_mfma_f32_16x16x32_bf16 v[184:187], v[188:191], v[116:119], v[184:187]
    ds_read_b64_tr_b16 v[84:85], v214 offset:256
    ds_read_b64_tr_b16 v[86:87], v214 offset:1792
    v_mfma_f32_16x16x32_bf16 v[136:139], v[112:115], v[88:91], v[136:139]
    ds_read_b128 v[56:59], v212 offset:0
    ds_read_b128 v[60:63], v212 offset:2048
    v_mfma_f32_16x16x32_bf16 v[156:159], v[88:91], v[116:119], v[156:159]
    ds_read_b128 v[64:67], v212 offset:4096
    ds_read_b128 v[68:71], v212 offset:6144
    v_mfma_f32_16x16x32_bf16 v[120:123], v[108:111], v[92:95], v[120:123]
    ds_read_b128 v[72:75], v212 offset:8192
    v_add_u32 v31, v30, v212
    v_mfma_f32_16x16x32_bf16 v[140:143], v[112:115], v[92:95], v[140:143]
    ds_read_b128 v[196:199], v31
    v_mfma_f32_16x16x32_bf16 v[160:163], v[92:95], v[116:119], v[160:163]
    v_mfma_f32_16x16x32_bf16 v[124:127], v[108:111], v[96:99], v[124:127]
    v_mfma_f32_16x16x32_bf16 v[144:147], v[112:115], v[96:99], v[144:147]
    v_mfma_f32_16x16x32_bf16 v[164:167], v[96:99], v[116:119], v[164:167]
    v_mfma_f32_16x16x32_bf16 v[128:131], v[108:111], v[100:103], v[128:131]
    v_mfma_f32_16x16x32_bf16 v[148:151], v[112:115], v[100:103], v[148:151]
    v_mfma_f32_16x16x32_bf16 v[168:171], v[100:103], v[116:119], v[168:171]
    v_mfma_f32_16x16x32_bf16 v[132:135], v[108:111], v[104:107], v[132:135]
    v_mfma_f32_16x16x32_bf16 v[152:155], v[112:115], v[104:107], v[152:155]
    v_mfma_f32_16x16x32_bf16 v[172:175], v[104:107], v[116:119], v[172:175]
    v_mfma_f32_16x16x32_bf16 v[32:35], v[188:191], v[200:203], v[32:35]
    v_mfma_f32_16x16x32_bf16 v[36:39], v[200:203], v[200:203], v[36:39]
    v_mfma_f32_16x16x32_bf16 v[40:43], v[188:191], v[104:107], v[40:43]
    v_mfma_f32_16x16x32_bf16 v[44:47], v[104:107], v[104:107], v[44:47]
    s_barrier
    s_waitcnt lgkmcnt(0)
    v_mfma_f32_16x16x32_bf16 v[176:179], v[76:79], v[188:191], v[176:179]
    ds_read_b64_tr_b16 v[108:109], v214 offset:12288
    ds_read_b64_tr_b16 v[110:111], v214 offset:13824
    v_mfma_f32_16x16x32_bf16 v[180:183], v[80:83], v[188:191], v[180:183]
    ds_read_b64_tr_b16 v[112:113], v214 offset:12416
    ds_read_b64_tr_b16 v[114:115], v214 offset:13952
    v_mfma_f32_16x16x32_bf16 v[184:187], v[188:191], v[84:87], v[184:187]
    ds_read_b64_tr_b16 v[116:117], v214 offset:12544
    ds_read_b64_tr_b16 v[118:119], v214 offset:14080
    v_mfma_f32_16x16x32_bf16 v[136:139], v[80:83], v[56:59], v[136:139]
    ds_read_b128 v[88:91], v213 offset:0
    ds_read_b128 v[92:95], v213 offset:2048
    v_mfma_f32_16x16x32_bf16 v[156:159], v[56:59], v[84:87], v[156:159]
    ds_read_b128 v[96:99], v213 offset:4096
    ds_read_b128 v[100:103], v213 offset:6144
    v_mfma_f32_16x16x32_bf16 v[120:123], v[76:79], v[60:63], v[120:123]
    ds_read_b128 v[104:107], v213 offset:8192
    v_add_u32 v31, v30, v213
    v_mfma_f32_16x16x32_bf16 v[140:143], v[80:83], v[60:63], v[140:143]
    ds_read_b128 v[200:203], v31
    v_mfma_f32_16x16x32_bf16 v[160:163], v[60:63], v[84:87], v[160:163]
    v_mfma_f32_16x16x32_bf16 v[124:127], v[76:79], v[64:67], v[124:127]
    v_mfma_f32_16x16x32_bf16 v[144:147], v[80:83], v[64:67], v[144:147]
    v_mfma_f32_16x16x32_bf16 v[164:167], v[64:67], v[84:87], v[164:167]
    v_mfma_f32_16x16x32_bf16 v[128:131], v[76:79], v[68:71], v[128:131]
    v_mfma_f32_16x16x32_bf16 v[148:151], v[80:83], v[68:71], v[148:151]
    v_mfma_f32_16x16x32_bf16 v[168:171], v[68:71], v[84:87], v[168:171]
    v_mfma_f32_16x16x32_bf16 v[132:135], v[76:79], v[72:75], v[132:135]
    v_mfma_f32_16x16x32_bf16 v[152:155], v[80:83], v[72:75], v[152:155]
    v_mfma_f32_16x16x32_bf16 v[172:175], v[72:75], v[84:87], v[172:175]
    v_mfma_f32_16x16x32_bf16 v[32:35], v[188:191], v[196:199], v[32:35]
    v_mfma_f32_16x16x32_bf16 v[36:39], v[196:199], v[196:199], v[36:39]
    v_mfma_f32_16x16x32_bf16 v[40:43], v[188:191], v[72:75], v[40:43]
    v_mfma_f32_16x16x32_bf16 v[44:47], v[72:75], v[72:75], v[44:47]
    s_waitcnt lgkmcnt(0)
    v_mfma_f32_16x16x32_bf16 v[176:179], v[108:111], v[188:191], v[176:179]
    ds_read_b64_tr_b16 v[76:77], v219 offset:0
    ds_read_b64_tr_b16 v[78:79], v219 offset:1536
    v_mfma_f32_16x16x32_bf16 v[180:183], v[112:115], v[188:191], v[180:183]
    ds_read_b64_tr_b16 v[80:81], v219 offset:128
    ds_read_b64_tr_b16 v[82:83], v219 offset:1664
    v_mfma_f32_16x16x32_bf16 v[184:187], v[188:191], v[116:119], v[184:187]
    ds_read_b64_tr_b16 v[84:85], v219 offset:256
    ds_read_b64_tr_b16 v[86:87], v219 offset:1792
    v_mfma_f32_16x16x32_bf16 v[136:139], v[112:115], v[88:91], v[136:139]
    ds_read_b128 v[56:59], v217 offset:0
    ds_read_b128 v[60:63], v217 offset:2048
    v_mfma_f32_16x16x32_bf16 v[156:159], v[88:91], v[116:119], v[156:159]
    ds_read_b128 v[64:67], v217 offset:4096
    ds_read_b128 v[68:71], v217 offset:6144
    v_mfma_f32_16x16x32_bf16 v[120:123], v[108:111], v[92:95], v[120:123]
    ds_read_b128 v[72:75], v217 offset:8192
    v_add_u32 v31, v30, v217
    v_mfma_f32_16x16x32_bf16 v[140:143], v[112:115], v[92:95], v[140:143]
    ds_read_b128 v[196:199], v31
    v_mfma_f32_16x16x32_bf16 v[160:163], v[92:95], v[116:119], v[160:163]
    v_mfma_f32_16x16x32_bf16 v[124:127], v[108:111], v[96:99], v[124:127]
    v_mfma_f32_16x16x32_bf16 v[144:147], v[112:115], v[96:99], v[144:147]
    v_mfma_f32_16x16x32_bf16 v[164:167], v[96:99], v[116:119], v[164:167]
    v_mfma_f32_16x16x32_bf16 v[128:131], v[108:111], v[100:103], v[128:131]
    v_mfma_f32_16x16x32_bf16 v[148:151], v[112:115], v[100:103], v[148:151]
    v_mfma_f32_16x16x32_bf16 v[168:171], v[100:103], v[116:119], v[168:171]
    v_mfma_f32_16x16x32_bf16 v[132:135], v[108:111], v[104:107], v[132:135]
    v_mfma_f32_16x16x32_bf16 v[152:155], v[112:115], v[104:107], v[152:155]
    v_mfma_f32_16x16x32_bf16 v[172:175], v[104:107], v[116:119], v[172:175]
    v_mfma_f32_16x16x32_bf16 v[32:35], v[188:191], v[200:203], v[32:35]
    v_mfma_f32_16x16x32_bf16 v[36:39], v[200:203], v[200:203], v[36:39]
    v_mfma_f32_16x16x32_bf16 v[40:43], v[188:191], v[104:107], v[40:43]
    v_mfma_f32_16x16x32_bf16 v[44:47], v[104:107], v[104:107], v[44:47]
    s_barrier
    s_waitcnt lgkmcnt(0)
    v_mfma_f32_16x16x32_bf16 v[176:179], v[76:79], v[188:191], v[176:179]
    ds_read_b64_tr_b16 v[108:109], v219 offset:12288
    ds_read_b64_tr_b16 v[110:111], v219 offset:13824
    v_mfma_f32_16x16x32_bf16 v[180:183], v[80:83], v[188:191], v[180:183]
    ds_read_b64_tr_b16 v[112:113], v219 offset:12416
    ds_read_b64_tr_b16 v[114:115], v219 offset:13952
    v_mfma_f32_16x16x32_bf16 v[184:187], v[188:191], v[84:87], v[184:187]
    ds_read_b64_tr_b16 v[116:117], v219 offset:12544
    ds_read_b64_tr_b16 v[118:119], v219 offset:14080
    v_mfma_f32_16x16x32_bf16 v[136:139], v[80:83], v[56:59], v[136:139]
    ds_read_b128 v[88:91], v218 offset:0
    ds_read_b128 v[92:95], v218 offset:2048
    v_mfma_f32_16x16x32_bf16 v[156:159], v[56:59], v[84:87], v[156:159]
    ds_read_b128 v[96:99], v218 offset:4096
    ds_read_b128 v[100:103], v218 offset:6144
    v_mfma_f32_16x16x32_bf16 v[120:123], v[76:79], v[60:63], v[120:123]
    ds_read_b128 v[104:107], v218 offset:8192
    v_add_u32 v31, v30, v218
    v_mfma_f32_16x16x32_bf16 v[140:143], v[80:83], v[60:63], v[140:143]
    ds_read_b128 v[200:203], v31
    v_mfma_f32_16x16x32_bf16 v[160:163], v[60:63], v[84:87], v[160:163]
    v_mfma_f32_16x16x32_bf16 v[124:127], v[76:79], v[64:67], v[124:127]
    v_mfma_f32_16x16x32_bf16 v[144:147], v[80:83], v[64:67], v[144:147]
    v_mfma_f32_16x16x32_bf16 v[164:167], v[64:67], v[84:87], v[164:167]
    v_mfma_f32_16x16x32_bf16 v[128:131], v[76:79], v[68:71], v[128:131]
    v_mfma_f32_16x16x32_bf16 v[148:151], v[80:83], v[68:71], v[148:151]
    v_mfma_f32_16x16x32_bf16 v[168:171], v[68:71], v[84:87], v[168:171]
    v_mfma_f32_16x16x32_bf16 v[132:135], v[76:79], v[72:75], v[132:135]
    v_mfma_f32_16x16x32_bf16 v[152:155], v[80:83], v[72:75], v[152:155]
    v_mfma_f32_16x16x32_bf16 v[172:175], v[72:75], v[84:87], v[172:175]
    v_mfma_f32_16x16x32_bf16 v[32:35], v[188:191], v[196:199], v[32:35]
    v_mfma_f32_16x16x32_bf16 v[36:39], v[196:199], v[196:199], v[36:39]
    v_mfma_f32_16x16x32_bf16 v[40:43], v[188:191], v[72:75], v[40:43]
    v_mfma_f32_16x16x32_bf16 v[44:47], v[72:75], v[72:75], v[44:47]
    s_waitcnt lgkmcnt(0)
    v_mfma_f32_16x16x32_bf16 v[176:179], v[108:111], v[188:191], v[176:179]
    ds_read_b64_tr_b16 v[76:77], v224 offset:0
    ds_read_b64_tr_b16 v[78:79], v224 offset:1536
    v_mfma_f32_16x16x32_bf16 v[180:183], v[112:115], v[188:191], v[180:183]
    ds_read_b64_tr_b16 v[80:81], v224 offset:128
    ds_read_b64_tr_b16 v[82:83], v224 offset:1664
    v_mfma_f32_16x16x32_bf16 v[184:187], v[188:191], v[116:119], v[184:187]
    ds_read_b64_tr_b16 v[84:85], v224 offset:256
    ds_read_b64_tr_b16 v[86:87], v224 offset:1792
    v_mfma_f32_16x16x32_bf16 v[136:139], v[112:115], v[88:91], v[136:139]
    ds_read_b128 v[56:59], v222 offset:0
    ds_read_b128 v[60:63], v222 offset:2048
    v_mfma_f32_16x16x32_bf16 v[156:159], v[88:91], v[116:119], v[156:159]
    ds_read_b128 v[64:67], v222 offset:4096
    ds_read_b128 v[68:71], v222 offset:6144
    v_mfma_f32_16x16x32_bf16 v[120:123], v[108:111], v[92:95], v[120:123]
    ds_read_b128 v[72:75], v222 offset:8192
    v_add_u32 v31, v30, v222
    v_mfma_f32_16x16x32_bf16 v[140:143], v[112:115], v[92:95], v[140:143]
    ds_read_b128 v[196:199], v31
    v_mfma_f32_16x16x32_bf16 v[160:163], v[92:95], v[116:119], v[160:163]
    v_mfma_f32_16x16x32_bf16 v[124:127], v[108:111], v[96:99], v[124:127]
    v_mfma_f32_16x16x32_bf16 v[144:147], v[112:115], v[96:99], v[144:147]
    v_mfma_f32_16x16x32_bf16 v[164:167], v[96:99], v[116:119], v[164:167]
    v_mfma_f32_16x16x32_bf16 v[128:131], v[108:111], v[100:103], v[128:131]
    v_mfma_f32_16x16x32_bf16 v[148:151], v[112:115], v[100:103], v[148:151]
    v_mfma_f32_16x16x32_bf16 v[168:171], v[100:103], v[116:119], v[168:171]
    v_mfma_f32_16x16x32_bf16 v[132:135], v[108:111], v[104:107], v[132:135]
    v_mfma_f32_16x16x32_bf16 v[152:155], v[112:115], v[104:107], v[152:155]
    v_mfma_f32_16x16x32_bf16 v[172:175], v[104:107], v[116:119], v[172:175]
    v_mfma_f32_16x16x32_bf16 v[32:35], v[188:191], v[200:203], v[32:35]
    v_mfma_f32_16x16x32_bf16 v[36:39], v[200:203], v[200:203], v[36:39]
    v_mfma_f32_16x16x32_bf16 v[40:43], v[188:191], v[104:107], v[40:43]
    v_mfma_f32_16x16x32_bf16 v[44:47], v[104:107], v[104:107], v[44:47]
    s_barrier
    s_waitcnt lgkmcnt(0)
    v_mfma_f32_16x16x32_bf16 v[176:179], v[76:79], v[188:191], v[176:179]
    ds_read_b64_tr_b16 v[108:109], v224 offset:12288
    ds_read_b64_tr_b16 v[110:111], v224 offset:13824
    v_mfma_f32_16x16x32_bf16 v[180:183], v[80:83], v[188:191], v[180:183]
    ds_read_b64_tr_b16 v[112:113], v224 offset:12416
    ds_read_b64_tr_b16 v[114:115], v224 offset:13952
    v_mfma_f32_16x16x32_bf16 v[184:187], v[188:191], v[84:87], v[184:187]
    ds_read_b64_tr_b16 v[116:117], v224 offset:12544
    ds_read_b64_tr_b16 v[118:119], v224 offset:14080
    v_mfma_f32_16x16x32_bf16 v[136:139], v[80:83], v[56:59], v[136:139]
    ds_read_b128 v[88:91], v223 offset:0
    ds_read_b128 v[92:95], v223 offset:2048
    v_mfma_f32_16x16x32_bf16 v[156:159], v[56:59], v[84:87], v[156:159]
    ds_read_b128 v[96:99], v223 offset:4096
    ds_read_b128 v[100:103], v223 offset:6144
    v_mfma_f32_16x16x32_bf16 v[120:123], v[76:79], v[60:63], v[120:123]
    ds_read_b128 v[104:107], v223 offset:8192
    v_add_u32 v31, v30, v223
    v_mfma_f32_16x16x32_bf16 v[140:143], v[80:83], v[60:63], v[140:143]
    ds_read_b128 v[200:203], v31
    v_mfma_f32_16x16x32_bf16 v[160:163], v[60:63], v[84:87], v[160:163]
    v_mfma_f32_16x16x32_bf16 v[124:127], v[76:79], v[64:67], v[124:127]
    v_mfma_f32_16x16x32_bf16 v[144:147], v[80:83], v[64:67], v[144:147]
    v_mfma_f32_16x16x32_bf16 v[164:167], v[64:67], v[84:87], v[164:167]
    v_mfma_f32_16x16x32_bf16 v[128:131], v[76:79], v[68:71], v[128:131]
    v_mfma_f32_16x16x32_bf16 v[148:151], v[80:83], v[68:71], v[148:151]
    v_mfma_f32_16x16x32_bf16 v[168:171], v[68:71], v[84:87], v[168:171]
    v_mfma_f32_16x16x32_bf16 v[132:135], v[76:79], v[72:75], v[132:135]
    v_mfma_f32_16x16x32_bf16 v[152:155], v[80:83], v[72:75], v[152:155]
    v_mfma_f32_16x16x32_bf16 v[172:175], v[72:75], v[84:87], v[172:175]
    v_mfma_f32_16x16x32_bf16 v[32:35], v[188:191], v[196:199], v[32:35]
    v_mfma_f32_16x16x32_bf16 v[36:39], v[196:199], v[196:199], v[36:39]
    v_mfma_f32_16x16x32_bf16 v[40:43], v[188:191], v[72:75], v[40:43]
    v_mfma_f32_16x16x32_bf16 v[44:47], v[72:75], v[72:75], v[44:47]
    s_waitcnt lgkmcnt(0)
    v_mfma_f32_16x16x32_bf16 v[176:179], v[108:111], v[188:191], v[176:179]
    v_mfma_f32_16x16x32_bf16 v[180:183], v[112:115], v[188:191], v[180:183]
    v_mfma_f32_16x16x32_bf16 v[184:187], v[188:191], v[116:119], v[184:187]
    v_mfma_f32_16x16x32_bf16 v[136:139], v[112:115], v[88:91], v[136:139]
    v_mfma_f32_16x16x32_bf16 v[156:159], v[88:91], v[116:119], v[156:159]
    v_mfma_f32_16x16x32_bf16 v[120:123], v[108:111], v[92:95], v[120:123]
    v_mfma_f32_16x16x32_bf16 v[140:143], v[112:115], v[92:95], v[140:143]
    v_mfma_f32_16x16x32_bf16 v[160:163], v[92:95], v[116:119], v[160:163]
    v_mfma_f32_16x16x32_bf16 v[124:127], v[108:111], v[96:99], v[124:127]
    v_mfma_f32_16x16x32_bf16 v[144:147], v[112:115], v[96:99], v[144:147]
    v_mfma_f32_16x16x32_bf16 v[164:167], v[96:99], v[116:119], v[164:167]
    v_mfma_f32_16x16x32_bf16 v[128:131], v[108:111], v[100:103], v[128:131]
    v_mfma_f32_16x16x32_bf16 v[148:151], v[112:115], v[100:103], v[148:151]
    v_mfma_f32_16x16x32_bf16 v[168:171], v[100:103], v[116:119], v[168:171]
    v_mfma_f32_16x16x32_bf16 v[132:135], v[108:111], v[104:107], v[132:135]
    v_mfma_f32_16x16x32_bf16 v[152:155], v[112:115], v[104:107], v[152:155]
    v_mfma_f32_16x16x32_bf16 v[172:175], v[104:107], v[116:119], v[172:175]
    v_mfma_f32_16x16x32_bf16 v[32:35], v[188:191], v[200:203], v[32:35]
    v_mfma_f32_16x16x32_bf16 v[36:39], v[200:203], v[200:203], v[36:39]
    v_mfma_f32_16x16x32_bf16 v[40:43], v[188:191], v[104:107], v[40:43]
    v_mfma_f32_16x16x32_bf16 v[44:47], v[104:107], v[104:107], v[44:47]
    s_nop 7
    v_lshrrev_b32 v5, 2, v3
    v_and_b32 v6, 3, v3
    v_cmp_eq_u32 s[60:61], v5, v4
    v_cmp_eq_u32 s[62:63], 1, v6
    v_cmp_eq_u32 s[64:65], 2, v6
    v_cmp_eq_u32 s[66:67], 3, v6
    s_nop 1
    v_cndmask_b32 v36, v36, v37, s[62:63]
    v_cndmask_b32 v36, v36, v38, s[64:65]
    v_cndmask_b32 v36, v36, v39, s[66:67]
    v_cndmask_b32 v36, 0, v36, s[60:61]
    v_mov_b32 v208, v36
    s_nop 1
    v_permlane16_swap_b32 v36, v208
    s_nop 0
    v_add_f32 v36, v36, v208
    v_mov_b32 v208, v36
    s_nop 1
    v_permlane32_swap_b32 v36, v208
    s_nop 0
    v_add_f32 v36, v36, v208
    v_mul_f32 v32, 0x3b000000, v32
    v_mul_f32 v36, 0x3b000000, v36
    v_fma_f32 v36, -v32, v32, v36
    v_max_f32 v36, 0, v36
    v_cvt_pk_bf16_f32 v208, v32, v32
    v_lshlrev_b32 v32, 16, v208
    v_cvt_pk_bf16_f32 v208, v36, v36
    v_lshlrev_b32 v36, 16, v208
    v_add_f32 v36, 0x3727c5ac, v36
    v_cvt_pk_bf16_f32 v208, v36, v36
    v_lshlrev_b32 v36, 16, v208
    v_sqrt_f32 v36, v36
    s_nop 0
    v_cvt_pk_bf16_f32 v208, v36, v36
    v_lshlrev_b32 v36, 16, v208
    v_rcp_f32 v52, v36
    s_nop 0
    v_mov_b32 v53, v52
    v_mul_f32 v54, v32, v52
    v_sub_f32 v54, 0, v54
    v_mov_b32 v55, v54
    v_mov_b32 v53, v54
    v_lshl_add_u32 v5, v2, 4, v3
    v_lshlrev_b32 v5, 3, v5
    v_add_u32 v5, 139264, v5
    ds_write_b64 v5, v[52:53]
    v_cndmask_b32 v44, v44, v45, s[62:63]
    v_cndmask_b32 v44, v44, v46, s[64:65]
    v_cndmask_b32 v44, v44, v47, s[66:67]
    v_cndmask_b32 v44, 0, v44, s[60:61]
    v_mov_b32 v208, v44
    s_nop 1
    v_permlane16_swap_b32 v44, v208
    s_nop 0
    v_add_f32 v44, v44, v208
    v_mov_b32 v208, v44
    s_nop 1
    v_permlane32_swap_b32 v44, v208
    s_nop 0
    v_add_f32 v44, v44, v208
    v_mul_f32 v40, 0x3b000000, v40
    v_mul_f32 v44, 0x3b000000, v44
    v_fma_f32 v44, -v40, v40, v44
    v_max_f32 v44, 0, v44
    v_cvt_pk_bf16_f32 v208, v40, v40
    v_lshlrev_b32 v40, 16, v208
    v_cvt_pk_bf16_f32 v208, v44, v44
    v_lshlrev_b32 v44, 16, v208
    v_add_f32 v44, 0x3727c5ac, v44
    v_cvt_pk_bf16_f32 v208, v44, v44
    v_lshlrev_b32 v44, 16, v208
    v_sqrt_f32 v44, v44
    s_nop 0
    v_cvt_pk_bf16_f32 v208, v44, v44
    v_lshlrev_b32 v44, 16, v208
    v_rcp_f32 v52, v44
    s_nop 0
    v_mov_b32 v53, v52
    v_mul_f32 v54, v40, v52
    v_sub_f32 v54, 0, v54
    v_mov_b32 v55, v54
    v_mov_b32 v53, v54
    v_add_u32 v5, 64, v3
    v_lshlrev_b32 v5, 3, v5
    v_add_u32 v5, 139264, v5
    ds_write_b64 v5, v[52:53]
    s_waitcnt lgkmcnt(0)
    s_barrier
    v_lshlrev_b32 v5, 3, v3
    v_lshlrev_b32 v6, 5, v4
    v_add_u32 v5, 139264, v5
    v_add_u32 v6, 139264, v6
    ds_read_b64 v[56:57], v5 offset:0
    ds_read_b64 v[58:59], v5 offset:128
    ds_read_b64 v[60:61], v5 offset:256
    ds_read_b64 v[62:63], v5 offset:384
    ds_read_b64 v[64:65], v5 offset:512
    ds_read_b128 v[68:71], v6 offset:0
    ds_read_b128 v[72:75], v6 offset:16
    ds_read_b128 v[76:79], v6 offset:128
    ds_read_b128 v[80:83], v6 offset:144
    ds_read_b128 v[84:87], v6 offset:256
    ds_read_b128 v[88:91], v6 offset:272
    ds_read_b128 v[92:95], v6 offset:384
    ds_read_b128 v[96:99], v6 offset:400
    ds_read_b128 v[100:103], v6 offset:512
    ds_read_b128 v[104:107], v6 offset:528
    s_waitcnt lgkmcnt(0)
    s_nop 5
    v_mul_f32 v136, v136, v56
    v_fmac_f32 v136, v180, v57
    v_mul_f32 v156, v156, v68
    v_fmac_f32 v156, v184, v69
    v_mul_f32 v137, v137, v56
    v_fmac_f32 v137, v181, v57
    v_mul_f32 v157, v157, v70
    v_fmac_f32 v157, v184, v71
    v_mul_f32 v138, v138, v56
    v_fmac_f32 v138, v182, v57
    v_mul_f32 v158, v158, v72
    v_fmac_f32 v158, v184, v73
    v_mul_f32 v139, v139, v56
    v_fmac_f32 v139, v183, v57
    v_mul_f32 v159, v159, v74
    v_fmac_f32 v159, v184, v75
    v_mul_f32 v120, v120, v58
    v_fmac_f32 v120, v176, v59
    v_mul_f32 v140, v140, v58
    v_fmac_f32 v140, v180, v59
    v_mul_f32 v160, v160, v76
    v_fmac_f32 v160, v184, v77
    v_mul_f32 v121, v121, v58
    v_fmac_f32 v121, v177, v59
    v_mul_f32 v141, v141, v58
    v_fmac_f32 v141, v181, v59
    v_mul_f32 v161, v161, v78
    v_fmac_f32 v161, v184, v79
    v_mul_f32 v122, v122, v58
    v_fmac_f32 v122, v178, v59
    v_mul_f32 v142, v142, v58
    v_fmac_f32 v142, v182, v59
    v_mul_f32 v162, v162, v80
    v_fmac_f32 v162, v184, v81
    v_mul_f32 v123, v123, v58
    v_fmac_f32 v123, v179, v59
    v_mul_f32 v143, v143, v58
    v_fmac_f32 v143, v183, v59
    v_mul_f32 v163, v163, v82
    v_fmac_f32 v163, v184, v83
    v_mul_f32 v124, v124, v60
    v_fmac_f32 v124, v176, v61
    v_mul_f32 v144, v144, v60
    v_fmac_f32 v144, v180, v61
    v_mul_f32 v164, v164, v84
    v_fmac_f32 v164, v184, v85
    v_mul_f32 v125, v125, v60
    v_fmac_f32 v125, v177, v61
    v_mul_f32 v145, v145, v60
    v_fmac_f32 v145, v181, v61
    v_mul_f32 v165, v165, v86
    v_fmac_f32 v165, v184, v87
    v_mul_f32 v126, v126, v60
    v_fmac_f32 v126, v178, v61
    v_mul_f32 v146, v146, v60
    v_fmac_f32 v146, v182, v61
    v_mul_f32 v166, v166, v88
    v_fmac_f32 v166, v184, v89
    v_mul_f32 v127, v127, v60
    v_fmac_f32 v127, v179, v61
    v_mul_f32 v147, v147, v60
    v_fmac_f32 v147, v183, v61
    v_mul_f32 v167, v167, v90
    v_fmac_f32 v167, v184, v91
    v_mul_f32 v128, v128, v62
    v_fmac_f32 v128, v176, v63
    v_mul_f32 v148, v148, v62
    v_fmac_f32 v148, v180, v63
    v_mul_f32 v168, v168, v92
    v_fmac_f32 v168, v184, v93
    v_mul_f32 v129, v129, v62
    v_fmac_f32 v129, v177, v63
    v_mul_f32 v149, v149, v62
    v_fmac_f32 v149, v181, v63
    v_mul_f32 v169, v169, v94
    v_fmac_f32 v169, v184, v95
    v_mul_f32 v130, v130, v62
    v_fmac_f32 v130, v178, v63
    v_mul_f32 v150, v150, v62
    v_fmac_f32 v150, v182, v63
    v_mul_f32 v170, v170, v96
    v_fmac_f32 v170, v184, v97
    v_mul_f32 v131, v131, v62
    v_fmac_f32 v131, v179, v63
    v_mul_f32 v151, v151, v62
    v_fmac_f32 v151, v183, v63
    v_mul_f32 v171, v171, v98
    v_fmac_f32 v171, v184, v99
    v_mul_f32 v132, v132, v64
    v_fmac_f32 v132, v176, v65
    v_mul_f32 v152, v152, v64
    v_fmac_f32 v152, v180, v65
    v_mul_f32 v172, v172, v100
    v_fmac_f32 v172, v184, v101
    v_mul_f32 v133, v133, v64
    v_fmac_f32 v133, v177, v65
    v_mul_f32 v153, v153, v64
    v_fmac_f32 v153, v181, v65
    v_mul_f32 v173, v173, v102
    v_fmac_f32 v173, v184, v103
    v_mul_f32 v134, v134, v64
    v_fmac_f32 v134, v178, v65
    v_mul_f32 v154, v154, v64
    v_fmac_f32 v154, v182, v65
    v_mul_f32 v174, v174, v104
    v_fmac_f32 v174, v184, v105
    v_mul_f32 v135, v135, v64
    v_fmac_f32 v135, v179, v65
    v_mul_f32 v155, v155, v64
    v_fmac_f32 v155, v183, v65
    v_mul_f32 v175, v175, v106
    v_fmac_f32 v175, v184, v107
    v_cvt_pk_bf16_f32 v56, v120, v121
    v_cvt_pk_bf16_f32 v57, v122, v123
    v_cvt_pk_bf16_f32 v58, v124, v125
    v_cvt_pk_bf16_f32 v59, v126, v127
    v_cvt_pk_bf16_f32 v60, v128, v129
    v_cvt_pk_bf16_f32 v61, v130, v131
    v_cvt_pk_bf16_f32 v62, v132, v133
    v_cvt_pk_bf16_f32 v63, v134, v135
    v_cvt_pk_bf16_f32 v64, v136, v137
    v_cvt_pk_bf16_f32 v74, v156, v157
    v_cvt_pk_bf16_f32 v65, v138, v139
    v_cvt_pk_bf16_f32 v75, v158, v159
    v_cvt_pk_bf16_f32 v66, v140, v141
    v_cvt_pk_bf16_f32 v76, v160, v161
    v_cvt_pk_bf16_f32 v67, v142, v143
    v_cvt_pk_bf16_f32 v77, v162, v163
    v_cvt_pk_bf16_f32 v68, v144, v145
    v_cvt_pk_bf16_f32 v78, v164, v165
    v_cvt_pk_bf16_f32 v69, v146, v147
    v_cvt_pk_bf16_f32 v79, v166, v167
    v_cvt_pk_bf16_f32 v70, v148, v149
    v_cvt_pk_bf16_f32 v80, v168, v169
    v_cvt_pk_bf16_f32 v71, v150, v151
    v_cvt_pk_bf16_f32 v81, v170, v171
    v_cvt_pk_bf16_f32 v72, v152, v153
    v_cvt_pk_bf16_f32 v82, v172, v173
    v_cvt_pk_bf16_f32 v73, v154, v155
    v_cvt_pk_bf16_f32 v83, v174, v175
    s_nop 1
    v_mfma_f32_16x16x16_bf16 v[120:123], v[64:65], v[56:57], 0
    v_mfma_f32_16x16x16_bf16 v[124:127], v[66:67], v[56:57], 0
    v_mfma_f32_16x16x16_bf16 v[128:131], v[66:67], v[58:59], 0
    v_mfma_f32_16x16x16_bf16 v[132:135], v[68:69], v[58:59], 0
    v_mfma_f32_16x16x16_bf16 v[136:139], v[68:69], v[60:61], 0
    v_mfma_f32_16x16x16_bf16 v[140:143], v[70:71], v[60:61], 0
    v_mfma_f32_16x16x16_bf16 v[144:147], v[70:71], v[62:63], 0
    v_mfma_f32_16x16x16_bf16 v[148:151], v[72:73], v[62:63], 0
    v_mov_b32 v7, 0xce6e6b28
    v_lshlrev_b32 v5, 2, v4
    v_sub_u32 v5, v3, v5
    v_add_u32 v6, 16, v5
    v_and_b32 v8, 0xfffffff1, v6
    v_cmp_eq_u32 vcc, 0, v8
    s_nop 1
    v_cndmask_b32 v20, v7, 0, vcc
    v_add_u32 v6, 15, v5
    v_and_b32 v8, 0xfffffff1, v6
    v_cmp_eq_u32 vcc, 0, v8
    s_nop 1
    v_cndmask_b32 v21, v7, 0, vcc
    v_add_u32 v6, 14, v5
    v_and_b32 v8, 0xfffffff1, v6
    v_cmp_eq_u32 vcc, 0, v8
    s_nop 1
    v_cndmask_b32 v22, v7, 0, vcc
    v_add_u32 v6, 13, v5
    v_and_b32 v8, 0xfffffff1, v6
    v_cmp_eq_u32 vcc, 0, v8
    s_nop 1
    v_cndmask_b32 v23, v7, 0, vcc
    v_add_u32 v6, 0, v5
    v_and_b32 v8, 0xfffffff1, v6
    v_cmp_eq_u32 vcc, 0, v8
    s_nop 1
    v_cndmask_b32 v24, v7, 0, vcc
    v_add_u32 v6, 4294967295, v5
    v_and_b32 v8, 0xfffffff1, v6
    v_cmp_eq_u32 vcc, 0, v8
    s_nop 1
    v_cndmask_b32 v25, v7, 0, vcc
    v_add_u32 v6, 4294967294, v5
    v_and_b32 v8, 0xfffffff1, v6
    v_cmp_eq_u32 vcc, 0, v8
    s_nop 1
    v_cndmask_b32 v26, v7, 0, vcc
    v_add_u32 v6, 4294967293, v5
    v_and_b32 v8, 0xfffffff1, v6
    v_cmp_eq_u32 vcc, 0, v8
    s_nop 1
    v_cndmask_b32 v27, v7, 0, vcc
    s_cmp_eq_u32 s4, 0
    s_cselect_b32 s12, 0xce6e6b28, 0
    s_lshl_b32 s13, s5, 2
    s_add_u32 s13, s13, s3
    s_lshl_b32 s13, s13, 5
    v_add_u32 v5, s6, v3
    v_lshlrev_b32 v5, 10, v5
    v_lshl_add_u32 v5, v4, 3, v5
    v_add_u32 v28, s13, v5
    s_mov_b32 s14, 0x3eb8aa3b
    v_cvt_pk_bf16_f32 v96, v120, v121
    v_cvt_pk_bf16_f32 v97, v128, v129
    v_cvt_pk_bf16_f32 v98, v136, v137
    v_cvt_pk_bf16_f32 v99, v144, v145
    v_lshlrev_b32 v120, 16, v96
    v_and_b32 v121, 0xffff0000, v96
    v_lshlrev_b32 v128, 16, v97
    v_and_b32 v129, 0xffff0000, v97
    v_lshlrev_b32 v136, 16, v98
    v_and_b32 v137, 0xffff0000, v98
    v_lshlrev_b32 v144, 16, v99
    v_and_b32 v145, 0xffff0000, v99
    v_cvt_pk_bf16_f32 v96, v122, v123
    v_cvt_pk_bf16_f32 v97, v130, v131
    v_cvt_pk_bf16_f32 v98, v138, v139
    v_cvt_pk_bf16_f32 v99, v146, v147
    v_lshlrev_b32 v122, 16, v96
    v_and_b32 v123, 0xffff0000, v96
    v_lshlrev_b32 v130, 16, v97
    v_and_b32 v131, 0xffff0000, v97
    v_lshlrev_b32 v138, 16, v98
    v_and_b32 v139, 0xffff0000, v98
    v_lshlrev_b32 v146, 16, v99
    v_and_b32 v147, 0xffff0000, v99
    v_cvt_pk_bf16_f32 v96, v124, v125
    v_cvt_pk_bf16_f32 v97, v132, v133
    v_cvt_pk_bf16_f32 v98, v140, v141
    v_cvt_pk_bf16_f32 v99, v148, v149
    v_lshlrev_b32 v124, 16, v96
    v_and_b32 v125, 0xffff0000, v96
    v_lshlrev_b32 v132, 16, v97
    v_and_b32 v133, 0xffff0000, v97
    v_lshlrev_b32 v140, 16, v98
    v_and_b32 v141, 0xffff0000, v98
    v_lshlrev_b32 v148, 16, v99
    v_and_b32 v149, 0xffff0000, v99
    v_cvt_pk_bf16_f32 v96, v126, v127
    v_cvt_pk_bf16_f32 v97, v134, v135
    v_cvt_pk_bf16_f32 v98, v142, v143
    v_cvt_pk_bf16_f32 v99, v150, v151
    v_lshlrev_b32 v126, 16, v96
    v_and_b32 v127, 0xffff0000, v96
    v_lshlrev_b32 v134, 16, v97
    v_and_b32 v135, 0xffff0000, v97
    v_lshlrev_b32 v142, 16, v98
    v_and_b32 v143, 0xffff0000, v98
    v_lshlrev_b32 v150, 16, v99
    v_and_b32 v151, 0xffff0000, v99
    v_fma_f32 v120, v120, s14, v20
    v_fma_f32 v128, v128, s14, v20
    v_fma_f32 v136, v136, s14, v20
    v_fma_f32 v144, v144, s14, v20
    v_fma_f32 v121, v121, s14, v21
    v_fma_f32 v129, v129, s14, v21
    v_fma_f32 v137, v137, s14, v21
    v_fma_f32 v145, v145, s14, v21
    v_fma_f32 v122, v122, s14, v22
    v_fma_f32 v130, v130, s14, v22
    v_fma_f32 v138, v138, s14, v22
    v_fma_f32 v146, v146, s14, v22
    v_fma_f32 v123, v123, s14, v23
    v_fma_f32 v131, v131, s14, v23
    v_fma_f32 v139, v139, s14, v23
    v_fma_f32 v147, v147, s14, v23
    v_fma_f32 v124, v124, s14, v24
    v_fma_f32 v132, v132, s14, v24
    v_fma_f32 v140, v140, s14, v24
    v_fma_f32 v148, v148, s14, v24
    v_fma_f32 v125, v125, s14, v25
    v_fma_f32 v133, v133, s14, v25
    v_fma_f32 v141, v141, s14, v25
    v_fma_f32 v149, v149, s14, v25
    v_fma_f32 v126, v126, s14, v26
    v_fma_f32 v134, v134, s14, v26
    v_fma_f32 v142, v142, s14, v26
    v_fma_f32 v150, v150, s14, v26
    v_fma_f32 v127, v127, s14, v27
    v_fma_f32 v135, v135, s14, v27
    v_fma_f32 v143, v143, s14, v27
    v_fma_f32 v151, v151, s14, v27
    v_add_f32 v120, s12, v120
    v_add_f32 v121, s12, v121
    v_add_f32 v122, s12, v122
    v_add_f32 v123, s12, v123
    v_max3_f32 v88, v120, v121, v122
    v_max3_f32 v89, v128, v129, v130
    v_max3_f32 v90, v136, v137, v138
    v_max3_f32 v91, v144, v145, v146
    v_max3_f32 v88, v88, v123, v124
    v_max3_f32 v89, v89, v131, v132
    v_max3_f32 v90, v90, v139, v140
    v_max3_f32 v91, v91, v147, v148
    v_max3_f32 v88, v88, v125, v126
    v_max3_f32 v89, v89, v133, v134
    v_max3_f32 v90, v90, v141, v142
    v_max3_f32 v91, v91, v149, v150
    v_max_f32 v88, v88, v127
    v_max_f32 v89, v89, v135
    v_max_f32 v90, v90, v143
    v_max_f32 v91, v91, v151
    v_mov_b32 v92, v88
    v_mov_b32 v93, v89
    v_mov_b32 v94, v90
    v_mov_b32 v95, v91
    s_nop 0
    v_permlane16_swap_b32 v88, v92
    v_permlane16_swap_b32 v89, v93
    v_permlane16_swap_b32 v90, v94
    v_permlane16_swap_b32 v91, v95
    s_nop 0
    v_max_f32 v88, v88, v92
    v_max_f32 v89, v89, v93
    v_max_f32 v90, v90, v94
    v_max_f32 v91, v91, v95
    v_mov_b32 v92, v88
    v_mov_b32 v93, v89
    v_mov_b32 v94, v90
    v_mov_b32 v95, v91
    s_nop 0
    v_permlane32_swap_b32 v88, v92
    v_permlane32_swap_b32 v89, v93
    v_permlane32_swap_b32 v90, v94
    v_permlane32_swap_b32 v91, v95
    s_nop 0
    v_max_f32 v88, v88, v92
    v_max_f32 v89, v89, v93
    v_max_f32 v90, v90, v94
    v_max_f32 v91, v91, v95
    v_sub_f32 v120, v120, v88
    v_sub_f32 v128, v128, v89
    v_sub_f32 v136, v136, v90
    v_sub_f32 v144, v144, v91
    v_sub_f32 v121, v121, v88
    v_sub_f32 v129, v129, v89
    v_sub_f32 v137, v137, v90
    v_sub_f32 v145, v145, v91
    v_sub_f32 v122, v122, v88
    v_sub_f32 v130, v130, v89
    v_sub_f32 v138, v138, v90
    v_sub_f32 v146, v146, v91
    v_sub_f32 v123, v123, v88
    v_sub_f32 v131, v131, v89
    v_sub_f32 v139, v139, v90
    v_sub_f32 v147, v147, v91
    v_sub_f32 v124, v124, v88
    v_sub_f32 v132, v132, v89
    v_sub_f32 v140, v140, v90
    v_sub_f32 v148, v148, v91
    v_sub_f32 v125, v125, v88
    v_sub_f32 v133, v133, v89
    v_sub_f32 v141, v141, v90
    v_sub_f32 v149, v149, v91
    v_sub_f32 v126, v126, v88
    v_sub_f32 v134, v134, v89
    v_sub_f32 v142, v142, v90
    v_sub_f32 v150, v150, v91
    v_sub_f32 v127, v127, v88
    v_sub_f32 v135, v135, v89
    v_sub_f32 v143, v143, v90
    v_sub_f32 v151, v151, v91
    v_exp_f32 v120, v120
    v_exp_f32 v128, v128
    v_exp_f32 v136, v136
    v_exp_f32 v144, v144
    v_exp_f32 v121, v121
    v_exp_f32 v129, v129
    v_exp_f32 v137, v137
    v_exp_f32 v145, v145
    v_exp_f32 v122, v122
    v_exp_f32 v130, v130
    v_exp_f32 v138, v138
    v_exp_f32 v146, v146
    v_exp_f32 v123, v123
    v_exp_f32 v131, v131
    v_exp_f32 v139, v139
    v_exp_f32 v147, v147
    v_exp_f32 v124, v124
    v_exp_f32 v132, v132
    v_exp_f32 v140, v140
    v_exp_f32 v148, v148
    v_exp_f32 v125, v125
    v_exp_f32 v133, v133
    v_exp_f32 v141, v141
    v_exp_f32 v149, v149
    v_exp_f32 v126, v126
    v_exp_f32 v134, v134
    v_exp_f32 v142, v142
    v_exp_f32 v150, v150
    v_exp_f32 v127, v127
    v_exp_f32 v135, v135
    v_exp_f32 v143, v143
    v_exp_f32 v151, v151
    s_nop 0
    v_add_f32 v88, v120, v121
    v_add_f32 v89, v128, v129
    v_add_f32 v90, v136, v137
    v_add_f32 v91, v144, v145
    v_add_f32 v88, v88, v122
    v_add_f32 v89, v89, v130
    v_add_f32 v90, v90, v138
    v_add_f32 v91, v91, v146
    v_add_f32 v88, v88, v123
    v_add_f32 v89, v89, v131
    v_add_f32 v90, v90, v139
    v_add_f32 v91, v91, v147
    v_add_f32 v88, v88, v124
    v_add_f32 v89, v89, v132
    v_add_f32 v90, v90, v140
    v_add_f32 v91, v91, v148
    v_add_f32 v88, v88, v125
    v_add_f32 v89, v89, v133
    v_add_f32 v90, v90, v141
    v_add_f32 v91, v91, v149
    v_add_f32 v88, v88, v126
    v_add_f32 v89, v89, v134
    v_add_f32 v90, v90, v142
    v_add_f32 v91, v91, v150
    v_add_f32 v88, v88, v127
    v_add_f32 v89, v89, v135
    v_add_f32 v90, v90, v143
    v_add_f32 v91, v91, v151
    v_mov_b32 v92, v88
    v_mov_b32 v93, v89
    v_mov_b32 v94, v90
    v_mov_b32 v95, v91
    s_nop 0
    v_permlane16_swap_b32 v88, v92
    v_permlane16_swap_b32 v89, v93
    v_permlane16_swap_b32 v90, v94
    v_permlane16_swap_b32 v91, v95
    s_nop 0
    v_add_f32 v88, v88, v92
    v_add_f32 v89, v89, v93
    v_add_f32 v90, v90, v94
    v_add_f32 v91, v91, v95
    v_mov_b32 v92, v88
    v_mov_b32 v93, v89
    v_mov_b32 v94, v90
    v_mov_b32 v95, v91
    s_nop 0
    v_permlane32_swap_b32 v88, v92
    v_permlane32_swap_b32 v89, v93
    v_permlane32_swap_b32 v90, v94
    v_permlane32_swap_b32 v91, v95
    s_nop 0
    v_add_f32 v88, v88, v92
    v_add_f32 v89, v89, v93
    v_add_f32 v90, v90, v94
    v_add_f32 v91, v91, v95
    v_rcp_f32 v88, v88
    v_rcp_f32 v89, v89
    v_rcp_f32 v90, v90
    v_rcp_f32 v91, v91
    s_nop 0
    v_mul_f32 v120, v120, v88
    v_mul_f32 v128, v128, v89
    v_mul_f32 v136, v136, v90
    v_mul_f32 v144, v144, v91
    v_mul_f32 v121, v121, v88
    v_mul_f32 v129, v129, v89
    v_mul_f32 v137, v137, v90
    v_mul_f32 v145, v145, v91
    v_mul_f32 v122, v122, v88
    v_mul_f32 v130, v130, v89
    v_mul_f32 v138, v138, v90
    v_mul_f32 v146, v146, v91
    v_mul_f32 v123, v123, v88
    v_mul_f32 v131, v131, v89
    v_mul_f32 v139, v139, v90
    v_mul_f32 v147, v147, v91
    v_mul_f32 v124, v124, v88
    v_mul_f32 v132, v132, v89
    v_mul_f32 v140, v140, v90
    v_mul_f32 v148, v148, v91
    v_mul_f32 v125, v125, v88
    v_mul_f32 v133, v133, v89
    v_mul_f32 v141, v141, v90
    v_mul_f32 v149, v149, v91
    v_mul_f32 v126, v126, v88
    v_mul_f32 v134, v134, v89
    v_mul_f32 v142, v142, v90
    v_mul_f32 v150, v150, v91
    v_mul_f32 v127, v127, v88
    v_mul_f32 v135, v135, v89
    v_mul_f32 v143, v143, v90
    v_mul_f32 v151, v151, v91
    v_cvt_pk_bf16_f32 v96, v120, v121
    v_cvt_pk_bf16_f32 v100, v128, v129
    v_cvt_pk_bf16_f32 v104, v136, v137
    v_cvt_pk_bf16_f32 v108, v144, v145
    v_cvt_pk_bf16_f32 v97, v122, v123
    v_cvt_pk_bf16_f32 v101, v130, v131
    v_cvt_pk_bf16_f32 v105, v138, v139
    v_cvt_pk_bf16_f32 v109, v146, v147
    v_cvt_pk_bf16_f32 v98, v124, v125
    v_cvt_pk_bf16_f32 v102, v132, v133
    v_cvt_pk_bf16_f32 v106, v140, v141
    v_cvt_pk_bf16_f32 v110, v148, v149
    v_cvt_pk_bf16_f32 v99, v126, v127
    v_cvt_pk_bf16_f32 v103, v134, v135
    v_cvt_pk_bf16_f32 v107, v142, v143
    v_cvt_pk_bf16_f32 v111, v150, v151
    s_nop 1
    v_mfma_f32_16x16x16_bf16 v[152:155], v[74:75], v[96:97], 0
    v_mfma_f32_16x16x16_bf16 v[156:159], v[76:77], v[100:101], 0
    v_mfma_f32_16x16x16_bf16 v[160:163], v[78:79], v[104:105], 0
    v_mfma_f32_16x16x16_bf16 v[164:167], v[80:81], v[108:109], 0
    v_mfma_f32_16x16x16_bf16 v[152:155], v[76:77], v[98:99], v[152:155]
    v_mfma_f32_16x16x16_bf16 v[156:159], v[78:79], v[102:103], v[156:159]
    v_mfma_f32_16x16x16_bf16 v[160:163], v[80:81], v[106:107], v[160:163]
    v_mfma_f32_16x16x16_bf16 v[164:167], v[82:83], v[110:111], v[164:167]
    s_nop 9
    v_cvt_pk_bf16_f32 v88, v152, v153
    v_cvt_pk_bf16_f32 v89, v154, v155
    v_cvt_pk_bf16_f32 v90, v156, v157
    v_cvt_pk_bf16_f32 v91, v158, v159
    v_cvt_pk_bf16_f32 v92, v160, v161
    v_cvt_pk_bf16_f32 v93, v162, v163
    v_cvt_pk_bf16_f32 v94, v164, v165
    v_cvt_pk_bf16_f32 v95, v166, v167
    s_mov_b32 s13, 0
    buffer_store_dwordx2 v[88:89], v28, s[52:55], s13 offen
    s_mov_b32 s13, 16384
    buffer_store_dwordx2 v[90:91], v28, s[52:55], s13 offen
    s_mov_b32 s13, 32768
    buffer_store_dwordx2 v[92:93], v28, s[52:55], s13 offen
    s_mov_b32 s13, 49152
    buffer_store_dwordx2 v[94:95], v28, s[52:55], s13 offen
L_end_g1a1_kernel:
    s_endpgm
.globl g2r1_kernel
.p2align 8
.type g2r1_kernel,@function
g2r1_kernel:
    s_cmp_ge_u32 s2, 256
    s_cbranch_scc1 L_end_g2r1_kernel
    s_load_dwordx16 s[16:31], s[0:1], 0
    s_load_dwordx4 s[32:35], s[0:1], 64
    s_load_dwordx2 s[36:37], s[0:1], 80
    v_and_b32 v1, 63, v0
    v_lshrrev_b32 v5, 6, v0
    v_bfe_u32 v2, v0, 6, 2
    v_and_b32 v3, 15, v0
    v_bfe_u32 v4, v0, 4, 2
    v_readfirstlane_b32 s39, v5
    s_and_b32 s3, s39, 3
    s_lshr_b32 s38, s39, 2
    s_and_b32 s4, s2, 3
    s_lshl_b32 s4, s4, 3
    s_bfe_u32 s12, s2, 0x30003
    s_add_u32 s4, s4, s12
    s_bfe_u32 s5, s2, 0x10002
    s_lshl_b32 s5, s5, 2
    s_lshr_b32 s12, s2, 6
    s_add_u32 s5, s5, s12
    s_lshl_b32 s6, s4, 6
    s_mov_b32 s9, 0x3f803f80
    s_mul_i32 s10, s5, 128
    s_cmp_eq_u32 s38, 0
    s_cbranch_scc1 L_comp_g2r1_kernel
    s_lshl_b32 s14, s3, 11
    s_mul_i32 s15, s3, 2048
    s_add_u32 s15, s15, 8192
    s_and_b32 s13, s3, 1
    s_lshl_b32 s13, s13, 10
    s_add_u32 s13, s13, 8192
    v_lshrrev_b32 v5, 3, v1
    v_and_b32 v6, 7, v1
    v_xor_b32 v6, v6, v5
    v_lshl_add_u32 v7, v2, 4, v5
    v_add_u32 v7, s6, v7
    s_mov_b32 s11, 1024
    v_mul_lo_u32 v7, v7, s11
    v_lshl_add_u32 v36, v6, 4, v7
    v_add_u32 v37, 8192, v36
    v_mul_u32_u24 v5, 128, v2
    v_add_u32 v5, v5, v1
    s_mov_b32 s11, 1024
    v_add_u32 v6, 0, v5
    v_mul_u32_u24 v7, 8192, v6
    v_lshrrev_b32 v7, 16, v7
    v_mul_u32_u24 v8, 8, v7
    v_sub_u32 v8, v6, v8
    v_bfe_u32 v9, v7, 1, 1
    v_bfe_u32 v17, v7, 3, 1
    v_lshl_or_b32 v9, v17, 1, v9
    v_lshrrev_b32 v17, 1, v8
    v_xor_b32 v9, v9, v17
    v_and_b32 v8, 1, v8
    v_mul_lo_u32 v7, v7, s11
    v_lshl_add_u32 v7, v8, 4, v7
    v_lshl_add_u32 v7, v9, 5, v7
    v_add_u32 v40, s10, v7
    v_add_u32 v6, 64, v5
    v_mul_u32_u24 v7, 8192, v6
    v_lshrrev_b32 v7, 16, v7
    v_mul_u32_u24 v8, 8, v7
    v_sub_u32 v8, v6, v8
    v_bfe_u32 v9, v7, 1, 1
    v_bfe_u32 v17, v7, 3, 1
    v_lshl_or_b32 v9, v17, 1, v9
    v_lshrrev_b32 v17, 1, v8
    v_xor_b32 v9, v9, v17
    v_and_b32 v8, 1, v8
    v_mul_lo_u32 v7, v7, s11
    v_lshl_add_u32 v7, v8, 4, v7
    v_lshl_add_u32 v7, v9, 5, v7
    v_add_u32 v41, s10, v7
    s_waitcnt lgkmcnt(0)
    s_mov_b32 s40, s36
    s_mov_b32 s41, s37
    s_mov_b32 s42, 2097152
    s_mov_b32 s43, 0x00020000
    s_mov_b32 s44, s20
    s_mov_b32 s45, s21
    s_mov_b32 s46, 524288
    s_mov_b32 s47, 0x00020000
    s_mov_b32 s7, 0
    s_mov_b32 s8, 0
    s_add_u32 m0, s15, 0
    s_nop 0
    buffer_load_dwordx4 v40, s[44:47], s8 offen lds
    s_add_u32 m0, s15, 1024
    s_nop 0
    buffer_load_dwordx4 v41, s[44:47], s8 offen lds
    s_add_u32 m0, s14, 0
    s_nop 0
    buffer_load_dwordx4 v36, s[40:43], s7 offen lds
    s_add_u32 m0, s14, 1024
    s_nop 0
    buffer_load_dwordx4 v37, s[40:43], s7 offen lds
    s_mov_b32 s7, 128
    s_mov_b32 s8, 65536
    s_add_u32 m0, s15, 16384
    s_nop 0
    buffer_load_dwordx4 v40, s[44:47], s8 offen lds
    s_add_u32 m0, s15, 17408
    s_nop 0
    buffer_load_dwordx4 v41, s[44:47], s8 offen lds
    s_add_u32 m0, s14, 16384
    s_nop 0
    buffer_load_dwordx4 v36, s[40:43], s7 offen lds
    s_add_u32 m0, s14, 17408
    s_nop 0
    buffer_load_dwordx4 v37, s[40:43], s7 offen lds
    s_waitcnt vmcnt(4)
    s_barrier
    s_mov_b32 s7, 256
    s_mov_b32 s8, 131072
    s_add_u32 m0, s15, 32768
    s_nop 0
    buffer_load_dwordx4 v40, s[44:47], s8 offen lds
    s_add_u32 m0, s15, 33792
    s_nop 0
    buffer_load_dwordx4 v41, s[44:47], s8 offen lds
    s_add_u32 m0, s14, 32768
    s_nop 0
    buffer_load_dwordx4 v36, s[40:43], s7 offen lds
    s_add_u32 m0, s14, 33792
    s_nop 0
    buffer_load_dwordx4 v37, s[40:43], s7 offen lds
    s_mov_b32 s7, 384
    s_mov_b32 s8, 196608
    s_add_u32 m0, s15, 49152
    s_nop 0
    buffer_load_dwordx4 v40, s[44:47], s8 offen lds
    s_add_u32 m0, s15, 50176
    s_nop 0
    buffer_load_dwordx4 v41, s[44:47], s8 offen lds
    s_add_u32 m0, s14, 49152
    s_nop 0
    buffer_load_dwordx4 v36, s[40:43], s7 offen lds
    s_add_u32 m0, s14, 50176
    s_nop 0
    buffer_load_dwordx4 v37, s[40:43], s7 offen lds
    s_waitcnt vmcnt(4)
    s_barrier
    s_mov_b32 s7, 512
    s_mov_b32 s8, 262144
    s_add_u32 m0, s15, 65536
    s_nop 0
    buffer_load_dwordx4 v40, s[44:47], s8 offen lds
    s_add_u32 m0, s15, 66560
    s_nop 0
    buffer_load_dwordx4 v41, s[44:47], s8 offen lds
    s_add_u32 m0, s14, 65536
    s_nop 0
    buffer_load_dwordx4 v36, s[40:43], s7 offen lds
    s_add_u32 m0, s14, 66560
    s_nop 0
    buffer_load_dwordx4 v37, s[40:43], s7 offen lds
    s_mov_b32 s7, 640
    s_mov_b32 s8, 327680
    s_add_u32 m0, s15, 81920
    s_nop 0
    buffer_load_dwordx4 v40, s[44:47], s8 offen lds
    s_add_u32 m0, s15, 82944
    s_nop 0
    buffer_load_dwordx4 v41, s[44:47], s8 offen lds
    s_add_u32 m0, s14, 81920
    s_nop 0
    buffer_load_dwordx4 v36, s[40:43], s7 offen lds
    s_add_u32 m0, s14, 82944
    s_nop 0
    buffer_load_dwordx4 v37, s[40:43], s7 offen lds
    s_waitcnt vmcnt(8)
    s_barrier
    s_mov_b32 s7, 768
    s_mov_b32 s8, 393216
    s_add_u32 m0, s15, 0
    s_nop 0
    buffer_load_dwordx4 v40, s[44:47], s8 offen lds
    s_add_u32 m0, s15, 1024
    s_nop 0
    buffer_load_dwordx4 v41, s[44:47], s8 offen lds
    s_add_u32 m0, s14, 0
    s_nop 0
    buffer_load_dwordx4 v36, s[40:43], s7 offen lds
    s_add_u32 m0, s14, 1024
    s_nop 0
    buffer_load_dwordx4 v37, s[40:43], s7 offen lds
    s_mov_b32 s7, 896
    s_mov_b32 s8, 458752
    s_add_u32 m0, s15, 16384
    s_nop 0
    buffer_load_dwordx4 v40, s[44:47], s8 offen lds
    s_add_u32 m0, s15, 17408
    s_nop 0
    buffer_load_dwordx4 v41, s[44:47], s8 offen lds
    s_add_u32 m0, s14, 16384
    s_nop 0
    buffer_load_dwordx4 v36, s[40:43], s7 offen lds
    s_add_u32 m0, s14, 17408
    s_nop 0
    buffer_load_dwordx4 v37, s[40:43], s7 offen lds
    s_waitcnt vmcnt(12)
    s_barrier
    s_waitcnt vmcnt(8)
    s_barrier
    s_waitcnt vmcnt(4)
    s_barrier
    s_waitcnt vmcnt(0)
    s_barrier
    s_waitcnt vmcnt(0)
    s_barrier
    s_endpgm
L_comp_g2r1_kernel:
    s_waitcnt lgkmcnt(0)
    s_add_u32 s48, s36, 4194304
    s_addc_u32 s49, s37, 0
    s_mov_b32 s50, 2097152
    s_mov_b32 s51, 0x00020000
    s_add_u32 s52, s36, 2097152
    s_addc_u32 s53, s37, 0
    s_mov_b32 s54, 2097152
    s_mov_b32 s55, 0x00020000
    v_lshrrev_b32 v5, 1, v2
    v_and_b32 v6, 1, v2
    v_lshl_add_u32 v5, v5, 5, v3
    v_add_u32 v5, s6, v5
    s_mul_i32 s12, s5, 64
    v_mul_u32_u24 v6, 32, v6
    v_lshl_add_u32 v6, v4, 2, v6
    v_add_u32 v6, s12, v6
    v_lshlrev_b32 v20, 10, v5
    v_lshl_add_u32 v20, v6, 1, v20
    v_add_u32 v21, 16384, v20
    buffer_load_dwordx2 v[40:41], v20, s[48:51], 0 offen offset:0
    buffer_load_dwordx2 v[42:43], v20, s[48:51], 0 offen offset:32
    buffer_load_dwordx2 v[44:45], v21, s[48:51], 0 offen offset:0
    buffer_load_dwordx2 v[46:47], v21, s[48:51], 0 offen offset:32
    v_lshrrev_b32 v9, 1, v2
    v_add_u32 v7, 0, v4
    v_and_b32 v17, 7, v3
    v_xor_b32 v7, v7, v17
    v_lshlrev_b32 v7, 4, v7
    v_lshl_add_u32 v14, v3, 7, v7
    v_lshl_add_u32 v14, v9, 12, v14
    v_add_u32 v7, 4, v4
    v_and_b32 v17, 7, v3
    v_xor_b32 v7, v7, v17
    v_lshlrev_b32 v7, 4, v7
    v_lshl_add_u32 v15, v3, 7, v7
    v_lshl_add_u32 v15, v9, 12, v15
    v_and_b32 v9, 1, v2
    v_mul_u32_u24 v9, 2, v9
    v_add_u32 v9, 0, v9
    v_lshrrev_b32 v5, 2, v3
    v_lshl_add_u32 v5, v4, 3, v5
    v_bfe_u32 v6, v5, 1, 1
    v_bfe_u32 v7, v5, 3, 1
    v_lshl_or_b32 v6, v7, 1, v6
    v_xor_b32 v6, v6, v9
    v_mul_u32_u24 v5, 128, v5
    v_lshl_add_u32 v5, v6, 5, v5
    v_and_b32 v6, 3, v3
    v_lshl_add_u32 v5, v6, 3, v5
    v_add_u32 v16, 8192, v5
    v_and_b32 v9, 1, v2
    v_mul_u32_u24 v9, 2, v9
    v_add_u32 v9, 1, v9
    v_lshrrev_b32 v5, 2, v3
    v_lshl_add_u32 v5, v4, 3, v5
    v_bfe_u32 v6, v5, 1, 1
    v_bfe_u32 v7, v5, 3, 1
    v_lshl_or_b32 v6, v7, 1, v6
    v_xor_b32 v6, v6, v9
    v_mul_u32_u24 v5, 128, v5
    v_lshl_add_u32 v5, v6, 5, v5
    v_and_b32 v6, 3, v3
    v_lshl_add_u32 v5, v6, 3, v5
    v_add_u32 v17, 8192, v5
    v_add_u32 v212, 16384, v14
    v_add_u32 v213, 16384, v15
    v_add_u32 v214, 16384, v16
    v_add_u32 v215, 16384, v17
    v_add_u32 v217, 32768, v14
    v_add_u32 v218, 32768, v15
    v_add_u32 v219, 32768, v16
    v_add_u32 v220, 32768, v17
    v_add_u32 v222, 49152, v14
    v_add_u32 v223, 49152, v15
    v_add_u32 v224, 49152, v16
    v_add_u32 v225, 49152, v17
    v_add_u32 v227, 65536, v14
    v_add_u32 v228, 65536, v15
    v_add_u32 v229, 65536, v16
    v_add_u32 v230, 65536, v17
    v_add_u32 v232, 81920, v14
    v_add_u32 v233, 81920, v15
    v_add_u32 v234, 81920, v16
    v_add_u32 v235, 81920, v17
    v_mov_b32 v120, 0
    v_mov_b32 v121, 0
    v_mov_b32 v122, 0
    v_mov_b32 v123, 0
    v_mov_b32 v124, 0
    v_mov_b32 v125, 0
    v_mov_b32 v126, 0
    v_mov_b32 v127, 0
    v_mov_b32 v128, 0
    v_mov_b32 v129, 0
    v_mov_b32 v130, 0
    v_mov_b32 v131, 0
    v_mov_b32 v132, 0
    v_mov_b32 v133, 0
    v_mov_b32 v134, 0
    v_mov_b32 v135, 0
    s_barrier
    ds_read_b64_tr_b16 v[76:77], v16 offset:0
    ds_read_b64_tr_b16 v[78:79], v16 offset:512
    ds_read_b64_tr_b16 v[80:81], v17 offset:0
    ds_read_b64_tr_b16 v[82:83], v17 offset:512
    ds_read_b128 v[56:59], v14 offset:0
    ds_read_b128 v[60:63], v14 offset:2048
    s_waitcnt lgkmcnt(0)
    v_mfma_f32_16x16x32_bf16 v[120:123], v[76:79], v[56:59], v[120:123]
    ds_read_b64_tr_b16 v[108:109], v16 offset:4096
    ds_read_b64_tr_b16 v[110:111], v16 offset:4608
    v_mfma_f32_16x16x32_bf16 v[124:127], v[80:83], v[56:59], v[124:127]
    ds_read_b64_tr_b16 v[112:113], v17 offset:4096
    ds_read_b64_tr_b16 v[114:115], v17 offset:4608
    v_mfma_f32_16x16x32_bf16 v[128:131], v[76:79], v[60:63], v[128:131]
    ds_read_b128 v[88:91], v15 offset:0
    ds_read_b128 v[92:95], v15 offset:2048
    v_mfma_f32_16x16x32_bf16 v[132:135], v[80:83], v[60:63], v[132:135]
    s_waitcnt lgkmcnt(0)
    v_mfma_f32_16x16x32_bf16 v[120:123], v[108:111], v[88:91], v[120:123]
    v_mfma_f32_16x16x32_bf16 v[124:127], v[112:115], v[88:91], v[124:127]
    v_mfma_f32_16x16x32_bf16 v[128:131], v[108:111], v[92:95], v[128:131]
    v_mfma_f32_16x16x32_bf16 v[132:135], v[112:115], v[92:95], v[132:135]
    s_barrier
    ds_read_b64_tr_b16 v[76:77], v214 offset:0
    ds_read_b64_tr_b16 v[78:79], v214 offset:512
    ds_read_b64_tr_b16 v[80:81], v215 offset:0
    ds_read_b64_tr_b16 v[82:83], v215 offset:512
    ds_read_b128 v[56:59], v212 offset:0
    ds_read_b128 v[60:63], v212 offset:2048
    s_waitcnt lgkmcnt(0)
    v_mfma_f32_16x16x32_bf16 v[120:123], v[76:79], v[56:59], v[120:123]
    ds_read_b64_tr_b16 v[108:109], v214 offset:4096
    ds_read_b64_tr_b16 v[110:111], v214 offset:4608
    v_mfma_f32_16x16x32_bf16 v[124:127], v[80:83], v[56:59], v[124:127]
    ds_read_b64_tr_b16 v[112:113], v215 offset:4096
    ds_read_b64_tr_b16 v[114:115], v215 offset:4608
    v_mfma_f32_16x16x32_bf16 v[128:131], v[76:79], v[60:63], v[128:131]
    ds_read_b128 v[88:91], v213 offset:0
    ds_read_b128 v[92:95], v213 offset:2048
    v_mfma_f32_16x16x32_bf16 v[132:135], v[80:83], v[60:63], v[132:135]
    s_waitcnt lgkmcnt(0)
    v_mfma_f32_16x16x32_bf16 v[120:123], v[108:111], v[88:91], v[120:123]
    ds_read_b64_tr_b16 v[76:77], v219 offset:0
    ds_read_b64_tr_b16 v[78:79], v219 offset:512
    v_mfma_f32_16x16x32_bf16 v[124:127], v[112:115], v[88:91], v[124:127]
    ds_read_b64_tr_b16 v[80:81], v220 offset:0
    ds_read_b64_tr_b16 v[82:83], v220 offset:512
    v_mfma_f32_16x16x32_bf16 v[128:131], v[108:111], v[92:95], v[128:131]
    ds_read_b128 v[56:59], v217 offset:0
    ds_read_b128 v[60:63], v217 offset:2048
    v_mfma_f32_16x16x32_bf16 v[132:135], v[112:115], v[92:95], v[132:135]
    s_barrier
    s_waitcnt lgkmcnt(0)
    v_mfma_f32_16x16x32_bf16 v[120:123], v[76:79], v[56:59], v[120:123]
    ds_read_b64_tr_b16 v[108:109], v219 offset:4096
    ds_read_b64_tr_b16 v[110:111], v219 offset:4608
    v_mfma_f32_16x16x32_bf16 v[124:127], v[80:83], v[56:59], v[124:127]
    ds_read_b64_tr_b16 v[112:113], v220 offset:4096
    ds_read_b64_tr_b16 v[114:115], v220 offset:4608
    v_mfma_f32_16x16x32_bf16 v[128:131], v[76:79], v[60:63], v[128:131]
    ds_read_b128 v[88:91], v218 offset:0
    ds_read_b128 v[92:95], v218 offset:2048
    v_mfma_f32_16x16x32_bf16 v[132:135], v[80:83], v[60:63], v[132:135]
    s_waitcnt lgkmcnt(0)
    v_mfma_f32_16x16x32_bf16 v[120:123], v[108:111], v[88:91], v[120:123]
    ds_read_b64_tr_b16 v[76:77], v224 offset:0
    ds_read_b64_tr_b16 v[78:79], v224 offset:512
    v_mfma_f32_16x16x32_bf16 v[124:127], v[112:115], v[88:91], v[124:127]
    ds_read_b64_tr_b16 v[80:81], v225 offset:0
    ds_read_b64_tr_b16 v[82:83], v225 offset:512
    v_mfma_f32_16x16x32_bf16 v[128:131], v[108:111], v[92:95], v[128:131]
    ds_read_b128 v[56:59], v222 offset:0
    ds_read_b128 v[60:63], v222 offset:2048
    v_mfma_f32_16x16x32_bf16 v[132:135], v[112:115], v[92:95], v[132:135]
    s_barrier
    s_waitcnt lgkmcnt(0)
    v_mfma_f32_16x16x32_bf16 v[120:123], v[76:79], v[56:59], v[120:123]
    ds_read_b64_tr_b16 v[108:109], v224 offset:4096
    ds_read_b64_tr_b16 v[110:111], v224 offset:4608
    v_mfma_f32_16x16x32_bf16 v[124:127], v[80:83], v[56:59], v[124:127]
    ds_read_b64_tr_b16 v[112:113], v225 offset:4096
    ds_read_b64_tr_b16 v[114:115], v225 offset:4608
    v_mfma_f32_16x16x32_bf16 v[128:131], v[76:79], v[60:63], v[128:131]
    ds_read_b128 v[88:91], v223 offset:0
    ds_read_b128 v[92:95], v223 offset:2048
    v_mfma_f32_16x16x32_bf16 v[132:135], v[80:83], v[60:63], v[132:135]
    s_waitcnt lgkmcnt(0)
    v_mfma_f32_16x16x32_bf16 v[120:123], v[108:111], v[88:91], v[120:123]
    ds_read_b64_tr_b16 v[76:77], v229 offset:0
    ds_read_b64_tr_b16 v[78:79], v229 offset:512
    v_mfma_f32_16x16x32_bf16 v[124:127], v[112:115], v[88:91], v[124:127]
    ds_read_b64_tr_b16 v[80:81], v230 offset:0
    ds_read_b64_tr_b16 v[82:83], v230 offset:512
    v_mfma_f32_16x16x32_bf16 v[128:131], v[108:111], v[92:95], v[128:131]
    ds_read_b128 v[56:59], v227 offset:0
    ds_read_b128 v[60:63], v227 offset:2048
    v_mfma_f32_16x16x32_bf16 v[132:135], v[112:115], v[92:95], v[132:135]
    s_barrier
    s_waitcnt lgkmcnt(0)
    v_mfma_f32_16x16x32_bf16 v[120:123], v[76:79], v[56:59], v[120:123]
    ds_read_b64_tr_b16 v[108:109], v229 offset:4096
    ds_read_b64_tr_b16 v[110:111], v229 offset:4608
    v_mfma_f32_16x16x32_bf16 v[124:127], v[80:83], v[56:59], v[124:127]
    ds_read_b64_tr_b16 v[112:113], v230 offset:4096
    ds_read_b64_tr_b16 v[114:115], v230 offset:4608
    v_mfma_f32_16x16x32_bf16 v[128:131], v[76:79], v[60:63], v[128:131]
    ds_read_b128 v[88:91], v228 offset:0
    ds_read_b128 v[92:95], v228 offset:2048
    v_mfma_f32_16x16x32_bf16 v[132:135], v[80:83], v[60:63], v[132:135]
    s_waitcnt lgkmcnt(0)
    v_mfma_f32_16x16x32_bf16 v[120:123], v[108:111], v[88:91], v[120:123]
    ds_read_b64_tr_b16 v[76:77], v234 offset:0
    ds_read_b64_tr_b16 v[78:79], v234 offset:512
    v_mfma_f32_16x16x32_bf16 v[124:127], v[112:115], v[88:91], v[124:127]
    ds_read_b64_tr_b16 v[80:81], v235 offset:0
    ds_read_b64_tr_b16 v[82:83], v235 offset:512
    v_mfma_f32_16x16x32_bf16 v[128:131], v[108:111], v[92:95], v[128:131]
    ds_read_b128 v[56:59], v232 offset:0
    ds_read_b128 v[60:63], v232 offset:2048
    v_mfma_f32_16x16x32_bf16 v[132:135], v[112:115], v[92:95], v[132:135]
    s_barrier
    s_waitcnt lgkmcnt(0)
    v_mfma_f32_16x16x32_bf16 v[120:123], v[76:79], v[56:59], v[120:123]
    ds_read_b64_tr_b16 v[108:109], v234 offset:4096
    ds_read_b64_tr_b16 v[110:111], v234 offset:4608
    v_mfma_f32_16x16x32_bf16 v[124:127], v[80:83], v[56:59], v[124:127]
    ds_read_b64_tr_b16 v[112:113], v235 offset:4096
    ds_read_b64_tr_b16 v[114:115], v235 offset:4608
    v_mfma_f32_16x16x32_bf16 v[128:131], v[76:79], v[60:63], v[128:131]
    ds_read_b128 v[88:91], v233 offset:0
    ds_read_b128 v[92:95], v233 offset:2048
    v_mfma_f32_16x16x32_bf16 v[132:135], v[80:83], v[60:63], v[132:135]
    s_waitcnt lgkmcnt(0)
    v_mfma_f32_16x16x32_bf16 v[120:123], v[108:111], v[88:91], v[120:123]
    ds_read_b64_tr_b16 v[76:77], v16 offset:0
    ds_read_b64_tr_b16 v[78:79], v16 offset:512
    v_mfma_f32_16x16x32_bf16 v[124:127], v[112:115], v[88:91], v[124:127]
    ds_read_b64_tr_b16 v[80:81], v17 offset:0
    ds_read_b64_tr_b16 v[82:83], v17 offset:512
    v_mfma_f32_16x16x32_bf16 v[128:131], v[108:111], v[92:95], v[128:131]
    ds_read_b128 v[56:59], v14 offset:0
    ds_read_b128 v[60:63], v14 offset:2048
    v_mfma_f32_16x16x32_bf16 v[132:135], v[112:115], v[92:95], v[132:135]
    s_barrier
    s_waitcnt lgkmcnt(0)
    v_mfma_f32_16x16x32_bf16 v[120:123], v[76:79], v[56:59], v[120:123]
    ds_read_b64_tr_b16 v[108:109], v16 offset:4096
    ds_read_b64_tr_b16 v[110:111], v16 offset:4608
    v_mfma_f32_16x16x32_bf16 v[124:127], v[80:83], v[56:59], v[124:127]
    ds_read_b64_tr_b16 v[112:113], v17 offset:4096
    ds_read_b64_tr_b16 v[114:115], v17 offset:4608
    v_mfma_f32_16x16x32_bf16 v[128:131], v[76:79], v[60:63], v[128:131]
    ds_read_b128 v[88:91], v15 offset:0
    ds_read_b128 v[92:95], v15 offset:2048
    v_mfma_f32_16x16x32_bf16 v[132:135], v[80:83], v[60:63], v[132:135]
    s_waitcnt lgkmcnt(0)
    v_mfma_f32_16x16x32_bf16 v[120:123], v[108:111], v[88:91], v[120:123]
    ds_read_b64_tr_b16 v[76:77], v214 offset:0
    ds_read_b64_tr_b16 v[78:79], v214 offset:512
    v_mfma_f32_16x16x32_bf16 v[124:127], v[112:115], v[88:91], v[124:127]
    ds_read_b64_tr_b16 v[80:81], v215 offset:0
    ds_read_b64_tr_b16 v[82:83], v215 offset:512
    v_mfma_f32_16x16x32_bf16 v[128:131], v[108:111], v[92:95], v[128:131]
    ds_read_b128 v[56:59], v212 offset:0
    ds_read_b128 v[60:63], v212 offset:2048
    v_mfma_f32_16x16x32_bf16 v[132:135], v[112:115], v[92:95], v[132:135]
    s_barrier
    s_waitcnt lgkmcnt(0)
    v_mfma_f32_16x16x32_bf16 v[120:123], v[76:79], v[56:59], v[120:123]
    ds_read_b64_tr_b16 v[108:109], v214 offset:4096
    ds_read_b64_tr_b16 v[110:111], v214 offset:4608
    v_mfma_f32_16x16x32_bf16 v[124:127], v[80:83], v[56:59], v[124:127]
    ds_read_b64_tr_b16 v[112:113], v215 offset:4096
    ds_read_b64_tr_b16 v[114:115], v215 offset:4608
    v_mfma_f32_16x16x32_bf16 v[128:131], v[76:79], v[60:63], v[128:131]
    ds_read_b128 v[88:91], v213 offset:0
    ds_read_b128 v[92:95], v213 offset:2048
    v_mfma_f32_16x16x32_bf16 v[132:135], v[80:83], v[60:63], v[132:135]
    s_waitcnt lgkmcnt(0)
    v_mfma_f32_16x16x32_bf16 v[120:123], v[108:111], v[88:91], v[120:123]
    v_mfma_f32_16x16x32_bf16 v[124:127], v[112:115], v[88:91], v[124:127]
    v_mfma_f32_16x16x32_bf16 v[128:131], v[108:111], v[92:95], v[128:131]
    v_mfma_f32_16x16x32_bf16 v[132:135], v[112:115], v[92:95], v[132:135]
    s_waitcnt vmcnt(0)
    s_nop 9
    v_cvt_pk_bf16_f32 v56, v120, v121
    v_lshlrev_b32 v120, 16, v56
    v_and_b32 v121, 0xffff0000, v56
    v_lshlrev_b32 v57, 16, v40
    v_and_b32 v58, 0xffff0000, v40
    v_add_f32 v120, v120, v57
    v_add_f32 v121, v121, v58
    v_cvt_pk_bf16_f32 v56, v122, v123
    v_lshlrev_b32 v122, 16, v56
    v_and_b32 v123, 0xffff0000, v56
    v_lshlrev_b32 v57, 16, v41
    v_and_b32 v58, 0xffff0000, v41
    v_add_f32 v122, v122, v57
    v_add_f32 v123, v123, v58
    v_cvt_pk_bf16_f32 v120, v120, v121
    v_cvt_pk_bf16_f32 v121, v122, v123
    buffer_store_dwordx2 v[120:121], v20, s[52:55], 0 offen offset:0
    v_cvt_pk_bf16_f32 v56, v124, v125
    v_lshlrev_b32 v124, 16, v56
    v_and_b32 v125, 0xffff0000, v56
    v_lshlrev_b32 v57, 16, v42
    v_and_b32 v58, 0xffff0000, v42
    v_add_f32 v124, v124, v57
    v_add_f32 v125, v125, v58
    v_cvt_pk_bf16_f32 v56, v126, v127
    v_lshlrev_b32 v126, 16, v56
    v_and_b32 v127, 0xffff0000, v56
    v_lshlrev_b32 v57, 16, v43
    v_and_b32 v58, 0xffff0000, v43
    v_add_f32 v126, v126, v57
    v_add_f32 v127, v127, v58
    v_cvt_pk_bf16_f32 v124, v124, v125
    v_cvt_pk_bf16_f32 v125, v126, v127
    buffer_store_dwordx2 v[124:125], v20, s[52:55], 0 offen offset:32
    v_cvt_pk_bf16_f32 v56, v128, v129
    v_lshlrev_b32 v128, 16, v56
    v_and_b32 v129, 0xffff0000, v56
    v_lshlrev_b32 v57, 16, v44
    v_and_b32 v58, 0xffff0000, v44
    v_add_f32 v128, v128, v57
    v_add_f32 v129, v129, v58
    v_cvt_pk_bf16_f32 v56, v130, v131
    v_lshlrev_b32 v130, 16, v56
    v_and_b32 v131, 0xffff0000, v56
    v_lshlrev_b32 v57, 16, v45
    v_and_b32 v58, 0xffff0000, v45
    v_add_f32 v130, v130, v57
    v_add_f32 v131, v131, v58
    v_cvt_pk_bf16_f32 v128, v128, v129
    v_cvt_pk_bf16_f32 v129, v130, v131
    buffer_store_dwordx2 v[128:129], v21, s[52:55], 0 offen offset:0
    v_cvt_pk_bf16_f32 v56, v132, v133
    v_lshlrev_b32 v132, 16, v56
    v_and_b32 v133, 0xffff0000, v56
    v_lshlrev_b32 v57, 16, v46
    v_and_b32 v58, 0xffff0000, v46
    v_add_f32 v132, v132, v57
    v_add_f32 v133, v133, v58
    v_cvt_pk_bf16_f32 v56, v134, v135
    v_lshlrev_b32 v134, 16, v56
    v_and_b32 v135, 0xffff0000, v56
    v_lshlrev_b32 v57, 16, v47
    v_and_b32 v58, 0xffff0000, v47
    v_add_f32 v134, v134, v57
    v_add_f32 v135, v135, v58
    v_cvt_pk_bf16_f32 v132, v132, v133
    v_cvt_pk_bf16_f32 v133, v134, v135
    buffer_store_dwordx2 v[132:133], v21, s[52:55], 0 offen offset:32
L_end_g2r1_kernel:
    s_endpgm
.globl g5r1_kernel
.p2align 8
.type g5r1_kernel,@function
g5r1_kernel:
    s_cmp_ge_u32 s2, 256
    s_cbranch_scc1 L_end_g5r1_kernel
    s_load_dwordx16 s[16:31], s[0:1], 0
    s_load_dwordx4 s[32:35], s[0:1], 64
    s_load_dwordx2 s[36:37], s[0:1], 80
    v_and_b32 v1, 63, v0
    v_lshrrev_b32 v5, 6, v0
    v_bfe_u32 v2, v0, 6, 2
    v_and_b32 v3, 15, v0
    v_bfe_u32 v4, v0, 4, 2
    v_readfirstlane_b32 s39, v5
    s_and_b32 s3, s39, 3
    s_lshr_b32 s38, s39, 2
    s_and_b32 s4, s2, 3
    s_lshl_b32 s4, s4, 3
    s_bfe_u32 s12, s2, 0x30003
    s_add_u32 s4, s4, s12
    s_bfe_u32 s5, s2, 0x10002
    s_lshl_b32 s5, s5, 2
    s_lshr_b32 s12, s2, 6
    s_add_u32 s5, s5, s12
    s_lshl_b32 s6, s4, 6
    s_mov_b32 s9, 0x3f803f80
    s_mul_i32 s10, s5, 128
    s_cmp_eq_u32 s38, 0
    s_cbranch_scc1 L_comp_g5r1_kernel
    s_lshl_b32 s14, s3, 11
    s_mul_i32 s15, s3, 2048
    s_add_u32 s15, s15, 8192
    s_and_b32 s13, s3, 1
    s_lshl_b32 s13, s13, 10
    s_add_u32 s13, s13, 8192
    v_lshrrev_b32 v5, 3, v1
    v_and_b32 v6, 7, v1
    v_xor_b32 v6, v6, v5
    v_lshl_add_u32 v7, v2, 4, v5
    v_add_u32 v7, s6, v7
    s_mov_b32 s11, 1408
    v_mul_lo_u32 v7, v7, s11
    v_lshl_add_u32 v36, v6, 4, v7
    v_add_u32 v37, 11264, v36
    v_mul_u32_u24 v5, 128, v2
    v_add_u32 v5, v5, v1
    s_mov_b32 s11, 1024
    v_add_u32 v6, 0, v5
    v_mul_u32_u24 v7, 8192, v6
    v_lshrrev_b32 v7, 16, v7
    v_mul_u32_u24 v8, 8, v7
    v_sub_u32 v8, v6, v8
    v_bfe_u32 v9, v7, 1, 1
    v_bfe_u32 v17, v7, 3, 1
    v_lshl_or_b32 v9, v17, 1, v9
    v_lshrrev_b32 v17, 1, v8
    v_xor_b32 v9, v9, v17
    v_and_b32 v8, 1, v8
    v_mul_lo_u32 v7, v7, s11
    v_lshl_add_u32 v7, v8, 4, v7
    v_lshl_add_u32 v7, v9, 5, v7
    v_add_u32 v40, s10, v7
    v_add_u32 v6, 64, v5
    v_mul_u32_u24 v7, 8192, v6
    v_lshrrev_b32 v7, 16, v7
    v_mul_u32_u24 v8, 8, v7
    v_sub_u32 v8, v6, v8
    v_bfe_u32 v9, v7, 1, 1
    v_bfe_u32 v17, v7, 3, 1
    v_lshl_or_b32 v9, v17, 1, v9
    v_lshrrev_b32 v17, 1, v8
    v_xor_b32 v9, v9, v17
    v_and_b32 v8, 1, v8
    v_mul_lo_u32 v7, v7, s11
    v_lshl_add_u32 v7, v8, 4, v7
    v_lshl_add_u32 v7, v9, 5, v7
    v_add_u32 v41, s10, v7
    s_waitcnt lgkmcnt(0)
    s_add_u32 s40, s36, 15728640
    s_addc_u32 s41, s37, 0
    s_mov_b32 s42, 2883584
    s_mov_b32 s43, 0x00020000
    s_mov_b32 s44, s30
    s_mov_b32 s45, s31
    s_mov_b32 s46, 704512
    s_mov_b32 s47, 0x00020000
    s_mov_b32 s7, 0
    s_mov_b32 s8, 0
    s_add_u32 m0, s15, 0
    s_nop 0
    buffer_load_dwordx4 v40, s[44:47], s8 offen lds
    s_add_u32 m0, s15, 1024
    s_nop 0
    buffer_load_dwordx4 v41, s[44:47], s8 offen lds
    s_add_u32 m0, s14, 0
    s_nop 0
    buffer_load_dwordx4 v36, s[40:43], s7 offen lds
    s_add_u32 m0, s14, 1024
    s_nop 0
    buffer_load_dwordx4 v37, s[40:43], s7 offen lds
    s_mov_b32 s7, 128
    s_mov_b32 s8, 65536
    s_add_u32 m0, s15, 16384
    s_nop 0
    buffer_load_dwordx4 v40, s[44:47], s8 offen lds
    s_add_u32 m0, s15, 17408
    s_nop 0
    buffer_load_dwordx4 v41, s[44:47], s8 offen lds
    s_add_u32 m0, s14, 16384
    s_nop 0
    buffer_load_dwordx4 v36, s[40:43], s7 offen lds
    s_add_u32 m0, s14, 17408
    s_nop 0
    buffer_load_dwordx4 v37, s[40:43], s7 offen lds
    s_waitcnt vmcnt(4)
    s_barrier
    s_mov_b32 s7, 256
    s_mov_b32 s8, 131072
    s_add_u32 m0, s15, 32768
    s_nop 0
    buffer_load_dwordx4 v40, s[44:47], s8 offen lds
    s_add_u32 m0, s15, 33792
    s_nop 0
    buffer_load_dwordx4 v41, s[44:47], s8 offen lds
    s_add_u32 m0, s14, 32768
    s_nop 0
    buffer_load_dwordx4 v36, s[40:43], s7 offen lds
    s_add_u32 m0, s14, 33792
    s_nop 0
    buffer_load_dwordx4 v37, s[40:43], s7 offen lds
    s_mov_b32 s7, 384
    s_mov_b32 s8, 196608
    s_add_u32 m0, s15, 49152
    s_nop 0
    buffer_load_dwordx4 v40, s[44:47], s8 offen lds
    s_add_u32 m0, s15, 50176
    s_nop 0
    buffer_load_dwordx4 v41, s[44:47], s8 offen lds
    s_add_u32 m0, s14, 49152
    s_nop 0
    buffer_load_dwordx4 v36, s[40:43], s7 offen lds
    s_add_u32 m0, s14, 50176
    s_nop 0
    buffer_load_dwordx4 v37, s[40:43], s7 offen lds
    s_waitcnt vmcnt(4)
    s_barrier
    s_mov_b32 s7, 512
    s_mov_b32 s8, 262144
    s_add_u32 m0, s15, 65536
    s_nop 0
    buffer_load_dwordx4 v40, s[44:47], s8 offen lds
    s_add_u32 m0, s15, 66560
    s_nop 0
    buffer_load_dwordx4 v41, s[44:47], s8 offen lds
    s_add_u32 m0, s14, 65536
    s_nop 0
    buffer_load_dwordx4 v36, s[40:43], s7 offen lds
    s_add_u32 m0, s14, 66560
    s_nop 0
    buffer_load_dwordx4 v37, s[40:43], s7 offen lds
    s_mov_b32 s7, 640
    s_mov_b32 s8, 327680
    s_add_u32 m0, s15, 81920
    s_nop 0
    buffer_load_dwordx4 v40, s[44:47], s8 offen lds
    s_add_u32 m0, s15, 82944
    s_nop 0
    buffer_load_dwordx4 v41, s[44:47], s8 offen lds
    s_add_u32 m0, s14, 81920
    s_nop 0
    buffer_load_dwordx4 v36, s[40:43], s7 offen lds
    s_add_u32 m0, s14, 82944
    s_nop 0
    buffer_load_dwordx4 v37, s[40:43], s7 offen lds
    s_waitcnt vmcnt(8)
    s_barrier
    s_mov_b32 s7, 768
    s_mov_b32 s8, 393216
    s_add_u32 m0, s15, 0
    s_nop 0
    buffer_load_dwordx4 v40, s[44:47], s8 offen lds
    s_add_u32 m0, s15, 1024
    s_nop 0
    buffer_load_dwordx4 v41, s[44:47], s8 offen lds
    s_add_u32 m0, s14, 0
    s_nop 0
    buffer_load_dwordx4 v36, s[40:43], s7 offen lds
    s_add_u32 m0, s14, 1024
    s_nop 0
    buffer_load_dwordx4 v37, s[40:43], s7 offen lds
    s_mov_b32 s7, 896
    s_mov_b32 s8, 458752
    s_add_u32 m0, s15, 16384
    s_nop 0
    buffer_load_dwordx4 v40, s[44:47], s8 offen lds
    s_add_u32 m0, s15, 17408
    s_nop 0
    buffer_load_dwordx4 v41, s[44:47], s8 offen lds
    s_add_u32 m0, s14, 16384
    s_nop 0
    buffer_load_dwordx4 v36, s[40:43], s7 offen lds
    s_add_u32 m0, s14, 17408
    s_nop 0
    buffer_load_dwordx4 v37, s[40:43], s7 offen lds
    s_waitcnt vmcnt(12)
    s_barrier
    s_mov_b32 s7, 1024
    s_mov_b32 s8, 524288
    s_add_u32 m0, s15, 32768
    s_nop 0
    buffer_load_dwordx4 v40, s[44:47], s8 offen lds
    s_add_u32 m0, s15, 33792
    s_nop 0
    buffer_load_dwordx4 v41, s[44:47], s8 offen lds
    s_add_u32 m0, s14, 32768
    s_nop 0
    buffer_load_dwordx4 v36, s[40:43], s7 offen lds
    s_add_u32 m0, s14, 33792
    s_nop 0
    buffer_load_dwordx4 v37, s[40:43], s7 offen lds
    s_waitcnt vmcnt(12)
    s_barrier
    s_mov_b32 s7, 1152
    s_mov_b32 s8, 589824
    s_add_u32 m0, s15, 49152
    s_nop 0
    buffer_load_dwordx4 v40, s[44:47], s8 offen lds
    s_add_u32 m0, s15, 50176
    s_nop 0
    buffer_load_dwordx4 v41, s[44:47], s8 offen lds
    s_add_u32 m0, s14, 49152
    s_nop 0
    buffer_load_dwordx4 v36, s[40:43], s7 offen lds
    s_add_u32 m0, s14, 50176
    s_nop 0
    buffer_load_dwordx4 v37, s[40:43], s7 offen lds
    s_waitcnt vmcnt(12)
    s_barrier
    s_mov_b32 s7, 1280
    s_mov_b32 s8, 655360
    s_add_u32 m0, s15, 65536
    s_nop 0
    buffer_load_dwordx4 v40, s[44:47], s8 offen lds
    s_add_u32 m0, s15, 66560
    s_nop 0
    buffer_load_dwordx4 v41, s[44:47], s8 offen lds
    s_add_u32 m0, s14, 65536
    s_nop 0
    buffer_load_dwordx4 v36, s[40:43], s7 offen lds
    s_add_u32 m0, s14, 66560
    s_nop 0
    buffer_load_dwordx4 v37, s[40:43], s7 offen lds
    s_waitcnt vmcnt(12)
    s_barrier
    s_waitcnt vmcnt(8)
    s_barrier
    s_waitcnt vmcnt(4)
    s_barrier
    s_waitcnt vmcnt(0)
    s_barrier
    s_waitcnt vmcnt(0)
    s_barrier
    s_endpgm
L_comp_g5r1_kernel:
    s_waitcnt lgkmcnt(0)
    s_add_u32 s48, s36, 2097152
    s_addc_u32 s49, s37, 0
    s_mov_b32 s50, 2097152
    s_mov_b32 s51, 0x00020000
    s_mov_b32 s52, s32
    s_mov_b32 s53, s33
    s_mov_b32 s54, 2097152
    s_mov_b32 s55, 0x00020000
    v_lshrrev_b32 v5, 1, v2
    v_and_b32 v6, 1, v2
    v_lshl_add_u32 v5, v5, 5, v3
    v_add_u32 v5, s6, v5
    s_mul_i32 s12, s5, 64
    v_mul_u32_u24 v6, 32, v6
    v_lshl_add_u32 v6, v4, 2, v6
    v_add_u32 v6, s12, v6
    v_lshlrev_b32 v20, 10, v5
    v_lshl_add_u32 v20, v6, 1, v20
    v_add_u32 v21, 16384, v20
    buffer_load_dwordx2 v[40:41], v20, s[48:51], 0 offen offset:0
    buffer_load_dwordx2 v[42:43], v20, s[48:51], 0 offen offset:32
    buffer_load_dwordx2 v[44:45], v21, s[48:51], 0 offen offset:0
    buffer_load_dwordx2 v[46:47], v21, s[48:51], 0 offen offset:32
    v_lshrrev_b32 v9, 1, v2
    v_add_u32 v7, 0, v4
    v_and_b32 v17, 7, v3
    v_xor_b32 v7, v7, v17
    v_lshlrev_b32 v7, 4, v7
    v_lshl_add_u32 v14, v3, 7, v7
    v_lshl_add_u32 v14, v9, 12, v14
    v_add_u32 v7, 4, v4
    v_and_b32 v17, 7, v3
    v_xor_b32 v7, v7, v17
    v_lshlrev_b32 v7, 4, v7
    v_lshl_add_u32 v15, v3, 7, v7
    v_lshl_add_u32 v15, v9, 12, v15
    v_and_b32 v9, 1, v2
    v_mul_u32_u24 v9, 2, v9
    v_add_u32 v9, 0, v9
    v_lshrrev_b32 v5, 2, v3
    v_lshl_add_u32 v5, v4, 3, v5
    v_bfe_u32 v6, v5, 1, 1
    v_bfe_u32 v7, v5, 3, 1
    v_lshl_or_b32 v6, v7, 1, v6
    v_xor_b32 v6, v6, v9
    v_mul_u32_u24 v5, 128, v5
    v_lshl_add_u32 v5, v6, 5, v5
    v_and_b32 v6, 3, v3
    v_lshl_add_u32 v5, v6, 3, v5
    v_add_u32 v16, 8192, v5
    v_and_b32 v9, 1, v2
    v_mul_u32_u24 v9, 2, v9
    v_add_u32 v9, 1, v9
    v_lshrrev_b32 v5, 2, v3
    v_lshl_add_u32 v5, v4, 3, v5
    v_bfe_u32 v6, v5, 1, 1
    v_bfe_u32 v7, v5, 3, 1
    v_lshl_or_b32 v6, v7, 1, v6
    v_xor_b32 v6, v6, v9
    v_mul_u32_u24 v5, 128, v5
    v_lshl_add_u32 v5, v6, 5, v5
    v_and_b32 v6, 3, v3
    v_lshl_add_u32 v5, v6, 3, v5
    v_add_u32 v17, 8192, v5
    v_add_u32 v212, 16384, v14
    v_add_u32 v213, 16384, v15
    v_add_u32 v214, 16384, v16
    v_add_u32 v215, 16384, v17
    v_add_u32 v217, 32768, v14
    v_add_u32 v218, 32768, v15
    v_add_u32 v219, 32768, v16
    v_add_u32 v220, 32768, v17
    v_add_u32 v222, 49152, v14
    v_add_u32 v223, 49152, v15
    v_add_u32 v224, 49152, v16
    v_add_u32 v225, 49152, v17
    v_add_u32 v227, 65536, v14
    v_add_u32 v228, 65536, v15
    v_add_u32 v229, 65536, v16
    v_add_u32 v230, 65536, v17
    v_add_u32 v232, 81920, v14
    v_add_u32 v233, 81920, v15
    v_add_u32 v234, 81920, v16
    v_add_u32 v235, 81920, v17
    v_mov_b32 v120, 0
    v_mov_b32 v121, 0
    v_mov_b32 v122, 0
    v_mov_b32 v123, 0
    v_mov_b32 v124, 0
    v_mov_b32 v125, 0
    v_mov_b32 v126, 0
    v_mov_b32 v127, 0
    v_mov_b32 v128, 0
    v_mov_b32 v129, 0
    v_mov_b32 v130, 0
    v_mov_b32 v131, 0
    v_mov_b32 v132, 0
    v_mov_b32 v133, 0
    v_mov_b32 v134, 0
    v_mov_b32 v135, 0
    s_barrier
    ds_read_b64_tr_b16 v[76:77], v16 offset:0
    ds_read_b64_tr_b16 v[78:79], v16 offset:512
    ds_read_b64_tr_b16 v[80:81], v17 offset:0
    ds_read_b64_tr_b16 v[82:83], v17 offset:512
    ds_read_b128 v[56:59], v14 offset:0
    ds_read_b128 v[60:63], v14 offset:2048
    s_waitcnt lgkmcnt(0)
    v_mfma_f32_16x16x32_bf16 v[120:123], v[76:79], v[56:59], v[120:123]
    ds_read_b64_tr_b16 v[108:109], v16 offset:4096
    ds_read_b64_tr_b16 v[110:111], v16 offset:4608
    v_mfma_f32_16x16x32_bf16 v[124:127], v[80:83], v[56:59], v[124:127]
    ds_read_b64_tr_b16 v[112:113], v17 offset:4096
    ds_read_b64_tr_b16 v[114:115], v17 offset:4608
    v_mfma_f32_16x16x32_bf16 v[128:131], v[76:79], v[60:63], v[128:131]
    ds_read_b128 v[88:91], v15 offset:0
    ds_read_b128 v[92:95], v15 offset:2048
    v_mfma_f32_16x16x32_bf16 v[132:135], v[80:83], v[60:63], v[132:135]
    s_waitcnt lgkmcnt(0)
    v_mfma_f32_16x16x32_bf16 v[120:123], v[108:111], v[88:91], v[120:123]
    v_mfma_f32_16x16x32_bf16 v[124:127], v[112:115], v[88:91], v[124:127]
    v_mfma_f32_16x16x32_bf16 v[128:131], v[108:111], v[92:95], v[128:131]
    v_mfma_f32_16x16x32_bf16 v[132:135], v[112:115], v[92:95], v[132:135]
    s_barrier
    ds_read_b64_tr_b16 v[76:77], v214 offset:0
    ds_read_b64_tr_b16 v[78:79], v214 offset:512
    ds_read_b64_tr_b16 v[80:81], v215 offset:0
    ds_read_b64_tr_b16 v[82:83], v215 offset:512
    ds_read_b128 v[56:59], v212 offset:0
    ds_read_b128 v[60:63], v212 offset:2048
    s_waitcnt lgkmcnt(0)
    v_mfma_f32_16x16x32_bf16 v[120:123], v[76:79], v[56:59], v[120:123]
    ds_read_b64_tr_b16 v[108:109], v214 offset:4096
    ds_read_b64_tr_b16 v[110:111], v214 offset:4608
    v_mfma_f32_16x16x32_bf16 v[124:127], v[80:83], v[56:59], v[124:127]
    ds_read_b64_tr_b16 v[112:113], v215 offset:4096
    ds_read_b64_tr_b16 v[114:115], v215 offset:4608
    v_mfma_f32_16x16x32_bf16 v[128:131], v[76:79], v[60:63], v[128:131]
    ds_read_b128 v[88:91], v213 offset:0
    ds_read_b128 v[92:95], v213 offset:2048
    v_mfma_f32_16x16x32_bf16 v[132:135], v[80:83], v[60:63], v[132:135]
    s_waitcnt lgkmcnt(0)
    v_mfma_f32_16x16x32_bf16 v[120:123], v[108:111], v[88:91], v[120:123]
    ds_read_b64_tr_b16 v[76:77], v219 offset:0
    ds_read_b64_tr_b16 v[78:79], v219 offset:512
    v_mfma_f32_16x16x32_bf16 v[124:127], v[112:115], v[88:91], v[124:127]
    ds_read_b64_tr_b16 v[80:81], v220 offset:0
    ds_read_b64_tr_b16 v[82:83], v220 offset:512
    v_mfma_f32_16x16x32_bf16 v[128:131], v[108:111], v[92:95], v[128:131]
    ds_read_b128 v[56:59], v217 offset:0
    ds_read_b128 v[60:63], v217 offset:2048
    v_mfma_f32_16x16x32_bf16 v[132:135], v[112:115], v[92:95], v[132:135]
    s_barrier
    s_waitcnt lgkmcnt(0)
    v_mfma_f32_16x16x32_bf16 v[120:123], v[76:79], v[56:59], v[120:123]
    ds_read_b64_tr_b16 v[108:109], v219 offset:4096
    ds_read_b64_tr_b16 v[110:111], v219 offset:4608
    v_mfma_f32_16x16x32_bf16 v[124:127], v[80:83], v[56:59], v[124:127]
    ds_read_b64_tr_b16 v[112:113], v220 offset:4096
    ds_read_b64_tr_b16 v[114:115], v220 offset:4608
    v_mfma_f32_16x16x32_bf16 v[128:131], v[76:79], v[60:63], v[128:131]
    ds_read_b128 v[88:91], v218 offset:0
    ds_read_b128 v[92:95], v218 offset:2048
    v_mfma_f32_16x16x32_bf16 v[132:135], v[80:83], v[60:63], v[132:135]
    s_waitcnt lgkmcnt(0)
    v_mfma_f32_16x16x32_bf16 v[120:123], v[108:111], v[88:91], v[120:123]
    ds_read_b64_tr_b16 v[76:77], v224 offset:0
    ds_read_b64_tr_b16 v[78:79], v224 offset:512
    v_mfma_f32_16x16x32_bf16 v[124:127], v[112:115], v[88:91], v[124:127]
    ds_read_b64_tr_b16 v[80:81], v225 offset:0
    ds_read_b64_tr_b16 v[82:83], v225 offset:512
    v_mfma_f32_16x16x32_bf16 v[128:131], v[108:111], v[92:95], v[128:131]
    ds_read_b128 v[56:59], v222 offset:0
    ds_read_b128 v[60:63], v222 offset:2048
    v_mfma_f32_16x16x32_bf16 v[132:135], v[112:115], v[92:95], v[132:135]
    s_barrier
    s_waitcnt lgkmcnt(0)
    v_mfma_f32_16x16x32_bf16 v[120:123], v[76:79], v[56:59], v[120:123]
    ds_read_b64_tr_b16 v[108:109], v224 offset:4096
    ds_read_b64_tr_b16 v[110:111], v224 offset:4608
    v_mfma_f32_16x16x32_bf16 v[124:127], v[80:83], v[56:59], v[124:127]
    ds_read_b64_tr_b16 v[112:113], v225 offset:4096
    ds_read_b64_tr_b16 v[114:115], v225 offset:4608
    v_mfma_f32_16x16x32_bf16 v[128:131], v[76:79], v[60:63], v[128:131]
    ds_read_b128 v[88:91], v223 offset:0
    ds_read_b128 v[92:95], v223 offset:2048
    v_mfma_f32_16x16x32_bf16 v[132:135], v[80:83], v[60:63], v[132:135]
    s_waitcnt lgkmcnt(0)
    v_mfma_f32_16x16x32_bf16 v[120:123], v[108:111], v[88:91], v[120:123]
    ds_read_b64_tr_b16 v[76:77], v229 offset:0
    ds_read_b64_tr_b16 v[78:79], v229 offset:512
    v_mfma_f32_16x16x32_bf16 v[124:127], v[112:115], v[88:91], v[124:127]
    ds_read_b64_tr_b16 v[80:81], v230 offset:0
    ds_read_b64_tr_b16 v[82:83], v230 offset:512
    v_mfma_f32_16x16x32_bf16 v[128:131], v[108:111], v[92:95], v[128:131]
    ds_read_b128 v[56:59], v227 offset:0
    ds_read_b128 v[60:63], v227 offset:2048
    v_mfma_f32_16x16x32_bf16 v[132:135], v[112:115], v[92:95], v[132:135]
    s_barrier
    s_waitcnt lgkmcnt(0)
    v_mfma_f32_16x16x32_bf16 v[120:123], v[76:79], v[56:59], v[120:123]
    ds_read_b64_tr_b16 v[108:109], v229 offset:4096
    ds_read_b64_tr_b16 v[110:111], v229 offset:4608
    v_mfma_f32_16x16x32_bf16 v[124:127], v[80:83], v[56:59], v[124:127]
    ds_read_b64_tr_b16 v[112:113], v230 offset:4096
    ds_read_b64_tr_b16 v[114:115], v230 offset:4608
    v_mfma_f32_16x16x32_bf16 v[128:131], v[76:79], v[60:63], v[128:131]
    ds_read_b128 v[88:91], v228 offset:0
    ds_read_b128 v[92:95], v228 offset:2048
    v_mfma_f32_16x16x32_bf16 v[132:135], v[80:83], v[60:63], v[132:135]
    s_waitcnt lgkmcnt(0)
    v_mfma_f32_16x16x32_bf16 v[120:123], v[108:111], v[88:91], v[120:123]
    ds_read_b64_tr_b16 v[76:77], v234 offset:0
    ds_read_b64_tr_b16 v[78:79], v234 offset:512
    v_mfma_f32_16x16x32_bf16 v[124:127], v[112:115], v[88:91], v[124:127]
    ds_read_b64_tr_b16 v[80:81], v235 offset:0
    ds_read_b64_tr_b16 v[82:83], v235 offset:512
    v_mfma_f32_16x16x32_bf16 v[128:131], v[108:111], v[92:95], v[128:131]
    ds_read_b128 v[56:59], v232 offset:0
    ds_read_b128 v[60:63], v232 offset:2048
    v_mfma_f32_16x16x32_bf16 v[132:135], v[112:115], v[92:95], v[132:135]
    s_barrier
    s_waitcnt lgkmcnt(0)
    v_mfma_f32_16x16x32_bf16 v[120:123], v[76:79], v[56:59], v[120:123]
    ds_read_b64_tr_b16 v[108:109], v234 offset:4096
    ds_read_b64_tr_b16 v[110:111], v234 offset:4608
    v_mfma_f32_16x16x32_bf16 v[124:127], v[80:83], v[56:59], v[124:127]
    ds_read_b64_tr_b16 v[112:113], v235 offset:4096
    ds_read_b64_tr_b16 v[114:115], v235 offset:4608
    v_mfma_f32_16x16x32_bf16 v[128:131], v[76:79], v[60:63], v[128:131]
    ds_read_b128 v[88:91], v233 offset:0
    ds_read_b128 v[92:95], v233 offset:2048
    v_mfma_f32_16x16x32_bf16 v[132:135], v[80:83], v[60:63], v[132:135]
    s_waitcnt lgkmcnt(0)
    v_mfma_f32_16x16x32_bf16 v[120:123], v[108:111], v[88:91], v[120:123]
    ds_read_b64_tr_b16 v[76:77], v16 offset:0
    ds_read_b64_tr_b16 v[78:79], v16 offset:512
    v_mfma_f32_16x16x32_bf16 v[124:127], v[112:115], v[88:91], v[124:127]
    ds_read_b64_tr_b16 v[80:81], v17 offset:0
    ds_read_b64_tr_b16 v[82:83], v17 offset:512
    v_mfma_f32_16x16x32_bf16 v[128:131], v[108:111], v[92:95], v[128:131]
    ds_read_b128 v[56:59], v14 offset:0
    ds_read_b128 v[60:63], v14 offset:2048
    v_mfma_f32_16x16x32_bf16 v[132:135], v[112:115], v[92:95], v[132:135]
    s_barrier
    s_waitcnt lgkmcnt(0)
    v_mfma_f32_16x16x32_bf16 v[120:123], v[76:79], v[56:59], v[120:123]
    ds_read_b64_tr_b16 v[108:109], v16 offset:4096
    ds_read_b64_tr_b16 v[110:111], v16 offset:4608
    v_mfma_f32_16x16x32_bf16 v[124:127], v[80:83], v[56:59], v[124:127]
    ds_read_b64_tr_b16 v[112:113], v17 offset:4096
    ds_read_b64_tr_b16 v[114:115], v17 offset:4608
    v_mfma_f32_16x16x32_bf16 v[128:131], v[76:79], v[60:63], v[128:131]
    ds_read_b128 v[88:91], v15 offset:0
    ds_read_b128 v[92:95], v15 offset:2048
    v_mfma_f32_16x16x32_bf16 v[132:135], v[80:83], v[60:63], v[132:135]
    s_waitcnt lgkmcnt(0)
    v_mfma_f32_16x16x32_bf16 v[120:123], v[108:111], v[88:91], v[120:123]
    ds_read_b64_tr_b16 v[76:77], v214 offset:0
    ds_read_b64_tr_b16 v[78:79], v214 offset:512
    v_mfma_f32_16x16x32_bf16 v[124:127], v[112:115], v[88:91], v[124:127]
    ds_read_b64_tr_b16 v[80:81], v215 offset:0
    ds_read_b64_tr_b16 v[82:83], v215 offset:512
    v_mfma_f32_16x16x32_bf16 v[128:131], v[108:111], v[92:95], v[128:131]
    ds_read_b128 v[56:59], v212 offset:0
    ds_read_b128 v[60:63], v212 offset:2048
    v_mfma_f32_16x16x32_bf16 v[132:135], v[112:115], v[92:95], v[132:135]
    s_barrier
    s_waitcnt lgkmcnt(0)
    v_mfma_f32_16x16x32_bf16 v[120:123], v[76:79], v[56:59], v[120:123]
    ds_read_b64_tr_b16 v[108:109], v214 offset:4096
    ds_read_b64_tr_b16 v[110:111], v214 offset:4608
    v_mfma_f32_16x16x32_bf16 v[124:127], v[80:83], v[56:59], v[124:127]
    ds_read_b64_tr_b16 v[112:113], v215 offset:4096
    ds_read_b64_tr_b16 v[114:115], v215 offset:4608
    v_mfma_f32_16x16x32_bf16 v[128:131], v[76:79], v[60:63], v[128:131]
    ds_read_b128 v[88:91], v213 offset:0
    ds_read_b128 v[92:95], v213 offset:2048
    v_mfma_f32_16x16x32_bf16 v[132:135], v[80:83], v[60:63], v[132:135]
    s_waitcnt lgkmcnt(0)
    v_mfma_f32_16x16x32_bf16 v[120:123], v[108:111], v[88:91], v[120:123]
    ds_read_b64_tr_b16 v[76:77], v219 offset:0
    ds_read_b64_tr_b16 v[78:79], v219 offset:512
    v_mfma_f32_16x16x32_bf16 v[124:127], v[112:115], v[88:91], v[124:127]
    ds_read_b64_tr_b16 v[80:81], v220 offset:0
    ds_read_b64_tr_b16 v[82:83], v220 offset:512
    v_mfma_f32_16x16x32_bf16 v[128:131], v[108:111], v[92:95], v[128:131]
    ds_read_b128 v[56:59], v217 offset:0
    ds_read_b128 v[60:63], v217 offset:2048
    v_mfma_f32_16x16x32_bf16 v[132:135], v[112:115], v[92:95], v[132:135]
    s_barrier
    s_waitcnt lgkmcnt(0)
    v_mfma_f32_16x16x32_bf16 v[120:123], v[76:79], v[56:59], v[120:123]
    ds_read_b64_tr_b16 v[108:109], v219 offset:4096
    ds_read_b64_tr_b16 v[110:111], v219 offset:4608
    v_mfma_f32_16x16x32_bf16 v[124:127], v[80:83], v[56:59], v[124:127]
    ds_read_b64_tr_b16 v[112:113], v220 offset:4096
    ds_read_b64_tr_b16 v[114:115], v220 offset:4608
    v_mfma_f32_16x16x32_bf16 v[128:131], v[76:79], v[60:63], v[128:131]
    ds_read_b128 v[88:91], v218 offset:0
    ds_read_b128 v[92:95], v218 offset:2048
    v_mfma_f32_16x16x32_bf16 v[132:135], v[80:83], v[60:63], v[132:135]
    s_waitcnt lgkmcnt(0)
    v_mfma_f32_16x16x32_bf16 v[120:123], v[108:111], v[88:91], v[120:123]
    ds_read_b64_tr_b16 v[76:77], v224 offset:0
    ds_read_b64_tr_b16 v[78:79], v224 offset:512
    v_mfma_f32_16x16x32_bf16 v[124:127], v[112:115], v[88:91], v[124:127]
    ds_read_b64_tr_b16 v[80:81], v225 offset:0
    ds_read_b64_tr_b16 v[82:83], v225 offset:512
    v_mfma_f32_16x16x32_bf16 v[128:131], v[108:111], v[92:95], v[128:131]
    ds_read_b128 v[56:59], v222 offset:0
    ds_read_b128 v[60:63], v222 offset:2048
    v_mfma_f32_16x16x32_bf16 v[132:135], v[112:115], v[92:95], v[132:135]
    s_barrier
    s_waitcnt lgkmcnt(0)
    v_mfma_f32_16x16x32_bf16 v[120:123], v[76:79], v[56:59], v[120:123]
    ds_read_b64_tr_b16 v[108:109], v224 offset:4096
    ds_read_b64_tr_b16 v[110:111], v224 offset:4608
    v_mfma_f32_16x16x32_bf16 v[124:127], v[80:83], v[56:59], v[124:127]
    ds_read_b64_tr_b16 v[112:113], v225 offset:4096
    ds_read_b64_tr_b16 v[114:115], v225 offset:4608
    v_mfma_f32_16x16x32_bf16 v[128:131], v[76:79], v[60:63], v[128:131]
    ds_read_b128 v[88:91], v223 offset:0
    ds_read_b128 v[92:95], v223 offset:2048
    v_mfma_f32_16x16x32_bf16 v[132:135], v[80:83], v[60:63], v[132:135]
    s_waitcnt lgkmcnt(0)
    v_mfma_f32_16x16x32_bf16 v[120:123], v[108:111], v[88:91], v[120:123]
    ds_read_b64_tr_b16 v[76:77], v229 offset:0
    ds_read_b64_tr_b16 v[78:79], v229 offset:512
    v_mfma_f32_16x16x32_bf16 v[124:127], v[112:115], v[88:91], v[124:127]
    ds_read_b64_tr_b16 v[80:81], v230 offset:0
    ds_read_b64_tr_b16 v[82:83], v230 offset:512
    v_mfma_f32_16x16x32_bf16 v[128:131], v[108:111], v[92:95], v[128:131]
    ds_read_b128 v[56:59], v227 offset:0
    ds_read_b128 v[60:63], v227 offset:2048
    v_mfma_f32_16x16x32_bf16 v[132:135], v[112:115], v[92:95], v[132:135]
    s_barrier
    s_waitcnt lgkmcnt(0)
    v_mfma_f32_16x16x32_bf16 v[120:123], v[76:79], v[56:59], v[120:123]
    ds_read_b64_tr_b16 v[108:109], v229 offset:4096
    ds_read_b64_tr_b16 v[110:111], v229 offset:4608
    v_mfma_f32_16x16x32_bf16 v[124:127], v[80:83], v[56:59], v[124:127]
    ds_read_b64_tr_b16 v[112:113], v230 offset:4096
    ds_read_b64_tr_b16 v[114:115], v230 offset:4608
    v_mfma_f32_16x16x32_bf16 v[128:131], v[76:79], v[60:63], v[128:131]
    ds_read_b128 v[88:91], v228 offset:0
    ds_read_b128 v[92:95], v228 offset:2048
    v_mfma_f32_16x16x32_bf16 v[132:135], v[80:83], v[60:63], v[132:135]
    s_waitcnt lgkmcnt(0)
    v_mfma_f32_16x16x32_bf16 v[120:123], v[108:111], v[88:91], v[120:123]
    v_mfma_f32_16x16x32_bf16 v[124:127], v[112:115], v[88:91], v[124:127]
    v_mfma_f32_16x16x32_bf16 v[128:131], v[108:111], v[92:95], v[128:131]
    v_mfma_f32_16x16x32_bf16 v[132:135], v[112:115], v[92:95], v[132:135]
    s_waitcnt vmcnt(0)
    s_nop 9
    v_cvt_pk_bf16_f32 v56, v120, v121
    v_lshlrev_b32 v120, 16, v56
    v_and_b32 v121, 0xffff0000, v56
    v_lshlrev_b32 v57, 16, v40
    v_and_b32 v58, 0xffff0000, v40
    v_add_f32 v120, v120, v57
    v_add_f32 v121, v121, v58
    v_cvt_pk_bf16_f32 v56, v122, v123
    v_lshlrev_b32 v122, 16, v56
    v_and_b32 v123, 0xffff0000, v56
    v_lshlrev_b32 v57, 16, v41
    v_and_b32 v58, 0xffff0000, v41
    v_add_f32 v122, v122, v57
    v_add_f32 v123, v123, v58
    v_cvt_pk_bf16_f32 v120, v120, v121
    v_cvt_pk_bf16_f32 v121, v122, v123
    buffer_store_dwordx2 v[120:121], v20, s[52:55], 0 offen offset:0
    v_cvt_pk_bf16_f32 v56, v124, v125
    v_lshlrev_b32 v124, 16, v56
    v_and_b32 v125, 0xffff0000, v56
    v_lshlrev_b32 v57, 16, v42
    v_and_b32 v58, 0xffff0000, v42
    v_add_f32 v124, v124, v57
    v_add_f32 v125, v125, v58
    v_cvt_pk_bf16_f32 v56, v126, v127
    v_lshlrev_b32 v126, 16, v56
    v_and_b32 v127, 0xffff0000, v56
    v_lshlrev_b32 v57, 16, v43
    v_and_b32 v58, 0xffff0000, v43
    v_add_f32 v126, v126, v57
    v_add_f32 v127, v127, v58
    v_cvt_pk_bf16_f32 v124, v124, v125
    v_cvt_pk_bf16_f32 v125, v126, v127
    buffer_store_dwordx2 v[124:125], v20, s[52:55], 0 offen offset:32
    v_cvt_pk_bf16_f32 v56, v128, v129
    v_lshlrev_b32 v128, 16, v56
    v_and_b32 v129, 0xffff0000, v56
    v_lshlrev_b32 v57, 16, v44
    v_and_b32 v58, 0xffff0000, v44
    v_add_f32 v128, v128, v57
    v_add_f32 v129, v129, v58
    v_cvt_pk_bf16_f32 v56, v130, v131
    v_lshlrev_b32 v130, 16, v56
    v_and_b32 v131, 0xffff0000, v56
    v_lshlrev_b32 v57, 16, v45
    v_and_b32 v58, 0xffff0000, v45
    v_add_f32 v130, v130, v57
    v_add_f32 v131, v131, v58
    v_cvt_pk_bf16_f32 v128, v128, v129
    v_cvt_pk_bf16_f32 v129, v130, v131
    buffer_store_dwordx2 v[128:129], v21, s[52:55], 0 offen offset:0
    v_cvt_pk_bf16_f32 v56, v132, v133
    v_lshlrev_b32 v132, 16, v56
    v_and_b32 v133, 0xffff0000, v56
    v_lshlrev_b32 v57, 16, v46
    v_and_b32 v58, 0xffff0000, v46
    v_add_f32 v132, v132, v57
    v_add_f32 v133, v133, v58
    v_cvt_pk_bf16_f32 v56, v134, v135
    v_lshlrev_b32 v134, 16, v56
    v_and_b32 v135, 0xffff0000, v56
    v_lshlrev_b32 v57, 16, v47
    v_and_b32 v58, 0xffff0000, v47
    v_add_f32 v134, v134, v57
    v_add_f32 v135, v135, v58
    v_cvt_pk_bf16_f32 v132, v132, v133
    v_cvt_pk_bf16_f32 v133, v134, v135
    buffer_store_dwordx2 v[132:133], v21, s[52:55], 0 offen offset:32
L_end_g5r1_kernel:
    s_endpgm
.section .rodata,"a"
.p2align 6
.amdhsa_kernel g1a0_kernel
  .amdhsa_next_free_vgpr 256
  .amdhsa_next_free_sgpr 96
  .amdhsa_accum_offset 256
  .amdhsa_group_segment_fixed_size 0
  .amdhsa_kernarg_size 88
  .amdhsa_user_sgpr_count 2
  .amdhsa_user_sgpr_kernarg_segment_ptr 1
  .amdhsa_system_sgpr_workgroup_id_x 1
.end_amdhsa_kernel
.p2align 6
.amdhsa_kernel g2r0_kernel
  .amdhsa_next_free_vgpr 248
  .amdhsa_next_free_sgpr 96
  .amdhsa_accum_offset 248
  .amdhsa_group_segment_fixed_size 0
  .amdhsa_kernarg_size 88
  .amdhsa_user_sgpr_count 2
  .amdhsa_user_sgpr_kernarg_segment_ptr 1
  .amdhsa_system_sgpr_workgroup_id_x 1
.end_amdhsa_kernel
.p2align 6
.amdhsa_kernel g3_kernel
  .amdhsa_next_free_vgpr 248
  .amdhsa_next_free_sgpr 96
  .amdhsa_accum_offset 248
  .amdhsa_group_segment_fixed_size 0
  .amdhsa_kernarg_size 88
  .amdhsa_user_sgpr_count 2
  .amdhsa_user_sgpr_kernarg_segment_ptr 1
  .amdhsa_system_sgpr_workgroup_id_x 1
.end_amdhsa_kernel
.p2align 6
.amdhsa_kernel ln2_kernel
  .amdhsa_next_free_vgpr 64
  .amdhsa_next_free_sgpr 96
  .amdhsa_accum_offset 64
  .amdhsa_group_segment_fixed_size 0
  .amdhsa_kernarg_size 88
  .amdhsa_user_sgpr_count 2
  .amdhsa_user_sgpr_kernarg_segment_ptr 1
  .amdhsa_system_sgpr_workgroup_id_x 1
.end_amdhsa_kernel
.p2align 6
.amdhsa_kernel g4_kernel
  .amdhsa_next_free_vgpr 248
  .amdhsa_next_free_sgpr 96
  .amdhsa_accum_offset 248
  .amdhsa_group_segment_fixed_size 0
  .amdhsa_kernarg_size 88
  .amdhsa_user_sgpr_count 2
  .amdhsa_user_sgpr_kernarg_segment_ptr 1
  .amdhsa_system_sgpr_workgroup_id_x 1
.end_amdhsa_kernel
.p2align 6
.amdhsa_kernel g5r0_kernel
  .amdhsa_next_free_vgpr 248
  .amdhsa_next_free_sgpr 96
  .amdhsa_accum_offset 248
  .amdhsa_group_segment_fixed_size 0
  .amdhsa_kernarg_size 88
  .amdhsa_user_sgpr_count 2
  .amdhsa_user_sgpr_kernarg_segment_ptr 1
  .amdhsa_system_sgpr_workgroup_id_x 1
.end_amdhsa_kernel
.p2align 6
.amdhsa_kernel g1a1_kernel
  .amdhsa_next_free_vgpr 248
  .amdhsa_next_free_sgpr 96
  .amdhsa_accum_offset 248
  .amdhsa_group_segment_fixed_size 0
  .amdhsa_kernarg_size 88
  .amdhsa_user_sgpr_count 2
  .amdhsa_user_sgpr_kernarg_segment_ptr 1
  .amdhsa_system_sgpr_workgroup_id_x 1
.end_amdhsa_kernel
.p2align 6
.amdhsa_kernel g2r1_kernel
  .amdhsa_next_free_vgpr 248
  .amdhsa_next_free_sgpr 96
  .amdhsa_accum_offset 248
  .amdhsa_group_segment_fixed_size 0
  .amdhsa_kernarg_size 88
  .amdhsa_user_sgpr_count 2
  .amdhsa_user_sgpr_kernarg_segment_ptr 1
  .amdhsa_system_sgpr_workgroup_id_x 1
.end_amdhsa_kernel
.p2align 6
.amdhsa_kernel g5r1_kernel
  .amdhsa_next_free_vgpr 248
  .amdhsa_next_free_sgpr 96
  .amdhsa_accum_offset 248
  .amdhsa_group_segment_fixed_size 0
  .amdhsa_kernarg_size 88
  .amdhsa_user_sgpr_count 2
  .amdhsa_user_sgpr_kernarg_segment_ptr 1
  .amdhsa_system_sgpr_workgroup_id_x 1
.end_amdhsa_kernel
```
